```python
import torch

def _softmax(x, axis=-1):
    return torch.softmax(x, dim=axis)
def _gelu(x):
    return torch.nn.functional.gelu(x, approximate="tanh")
def _silu(x):
    return torch.nn.functional.silu(x)
def _sigmoid(x):
    return torch.sigmoid(x)
def _layernorm(x, axis=-1, eps=1e-5):
    m = x.mean(dim=axis, keepdim=True)
    v = x.var(dim=axis, keepdim=True, unbiased=False)
    return (x - m) / torch.sqrt(v + eps)
def _scatter_add(tgt, idx, src, axis=0):
    return tgt.clone().index_add_(axis, idx, src)
def _segment_sum(src, seg, n):
    out = torch.zeros((n,) + src.shape[1:], dtype=src.dtype)
    return out.index_add_(0, seg, src)
def _pad(x, pw):
    flat = tuple(v for pair in reversed(pw) for v in pair)
    return torch.nn.functional.pad(x, flat)

kernel_name = 'concat_heads__linear_attn_block__sliding_block__prompt'

def setup_inputs():

    _w = (lambda a: (lambda t: t.to(torch.bfloat16) if t.is_floating_point() else t)(torch.as_tensor(a)))
    def _A_setup():
        B, S, D = 1, 2048, 1024
        return {
            "x": _w((lambda *s: torch.randn(*s, dtype=torch.bfloat16) * 0.05)(B, S, D)),
            "wqkv": _w((lambda *s: torch.randn(*s, dtype=torch.bfloat16) * 1.6)(D, 3 * D)),
            "wo": _w((lambda *s: torch.randn(*s, dtype=torch.bfloat16) * 0.8)(D, D)),
        }
    _A_in = _A_setup()

    def _B_setup():
        B, S, D = 1, 2048, 1024
        return {
            "x": _w((lambda *s: torch.randn(*s, dtype=torch.bfloat16) * 0.2)(B, S, D)),
            "wqkv": _w((lambda *s: torch.randn(*s, dtype=torch.bfloat16) * 0.2)(D, 3 * D)),
            "wo": _w((lambda *s: torch.randn(*s, dtype=torch.bfloat16) * 0.05)(D, D)),
        }
    _B_in = _B_setup()

    return {
        "A_x": _A_in["x"],
        "A_wqkv": _A_in["wqkv"],
        "A_wo": _A_in["wo"],
        "B_x": _B_in["x"],
        "B_wqkv": _B_in["wqkv"],
        "B_wo": _B_in["wo"],
    }

def reference(A_x, A_wqkv, A_wo, B_x, B_wqkv, B_wo):
    def _A_ref(x, wqkv, wo):
        B, S, D = x.shape
        H = 32; Dh = D // H
        qkv = (lambda x, *d: x.permute(*d))((x @ wqkv).reshape(B, S, 3, H, Dh), 2, 0, 3, 1, 4)
        q, k, v = qkv[0], qkv[1], qkv[2]
        phi = lambda t: torch.where(t > 0, t + 1, torch.exp(t)) + 1e-6
        pq, pk = phi(q), phi(k)
        kv = torch.einsum("bhsd,bhse->bhde", pk, v)
        z = torch.einsum("bhsd->bhd", pk)
        num = torch.einsum("bhqd,bhde->bhqe", pq, kv)
        den = torch.einsum("bhqd,bhd->bhq", pq, z)[..., None] + 1e-6
        o = num / den
        return (lambda x, *d: x.permute(*d))(o, 0, 2, 1, 3).reshape(B, S, D) @ wo

    def _B_ref(x, wqkv, wo):
        B, S, D = x.shape
        H = 32; Dh = D // H; W = 256
        qkv = (lambda x, *d: x.permute(*d))((x @ wqkv).reshape(B, S, 3, H, Dh), 2, 0, 3, 1, 4)
        q, k, v = qkv[0], qkv[1], qkv[2]
        scores = torch.einsum("bhqd,bhkd->bhqk", q, k) * (Dh ** -0.5)
        idx = torch.arange(S)
        mask = (idx[:, None] - idx[None, :] >= 0) & (idx[:, None] - idx[None, :] < W)
        scores = torch.where(mask[None, None], scores, -1e9)
        p = _softmax(scores, axis=-1)
        o = torch.einsum("bhqk,bhkd->bhqd", p, v)
        return (lambda x, *d: x.permute(*d))(o, 0, 2, 1, 3).reshape(B, S, D) @ wo

    a = _A_ref(A_x, A_wqkv, A_wo)
    b = _B_ref(B_x, B_wqkv, B_wo)
    return torch.concatenate([a, b], axis=-1)
```

```asm
; @launch grid=(256,1,1) block=(256,1,1) lds=163840
.amdgcn_target "amdgcn-amd-amdhsa--gfx950"
.text
.globl concat_heads__linear_attn_block__sliding_block__prompt_kernel
.p2align 8
.type concat_heads__linear_attn_block__sliding_block__prompt_kernel,@function
concat_heads__linear_attn_block__sliding_block__prompt_kernel:
s_load_dwordx4 s[16:19], s[0:1], 0
s_load_dwordx4 s[20:23], s[0:1], 24
s_load_dwordx4 s[60:63], s[0:1], 56
s_cmp_ge_u32 s2, 256
s_cbranch_scc1 .Lconcat_heads__linear_attn_block__sliding_block__prompt_kernel_done
v_lshrrev_b32 v1, 6, v0
v_and_b32 v0, 63, v0
s_and_b32 s24, s2, 7
v_readfirstlane_b32 s46, v1
s_lshr_b32 s25, s2, 3
s_and_b32 s43, s24, 1
s_bfe_u32 s27, s24, 0x10001
s_lshr_b32 s28, s24, 2
s_lshl_b32 s27, s27, 2
s_and_b32 s29, s25, 3
s_add_u32 s44, s27, s29
s_lshl_b32 s28, s28, 3
s_lshr_b32 s29, s25, 2
s_add_u32 s45, s28, s29
v_lshrrev_b32 v20, 3, v0
v_lshrrev_b32 v21, 4, v0
v_and_b32 v22, 7, v0
v_xor_b32 v23, v22, v21
v_lshlrev_b32 v23, 4, v23
v_lshl_add_u32 v24, v20, 11, v23
s_lshl_b32 s25, s46, 17
v_add_u32 v13, s25, v24
v_xor_b32 v14, 64, v13
s_lshl_b32 s26, s46, 13
s_movk_i32 s64, 15360
s_add_u32 s65, s64, s64
s_add_u32 s66, s65, s64
s_lshl_b32 s67, 1, 16
s_add_u32 s68, s67, s64
s_add_u32 s69, s67, s65
s_add_u32 s70, s67, s66

s_getpc_b64 s[28:29]
.Lpc_early:
v_lshlrev_b32 v15, 7, v0
global_load_dword v12, v15, s[28:29]
s_cmp_eq_u32 s43, 0
s_cselect_b32 s30, .Lv_A0-.Lpc_early, 0
s_cselect_b32 s31, .Lv_A3-.Lpc_early, 0
s_cselect_b32 s32, 0, .Lv_B0-.Lpc_early
s_cselect_b32 s33, 0, .Lv_B3-.Lpc_early
s_add_u32 s30, s30, s32
s_add_u32 s31, s31, s33
s_cmp_eq_u32 s46, 3
s_cselect_b32 s30, s31, s30
s_add_u32 s28, s28, s30
s_addc_u32 s29, s29, 0
global_load_dword v12, v15, s[28:29]
v_add_u32 v15, 0x2000, v15
v_min_u32 v15, 0x2400, v15
global_load_dword v12, v15, s[28:29]

s_cmp_eq_u32 s43, 0
s_waitcnt lgkmcnt(0)
s_cselect_b32 s16, s16, s20
s_cselect_b32 s17, s17, s21
s_cselect_b32 s18, s18, s22

s_cselect_b32 s19, s19, s23
s_lshl_b32 s27, s44, 19
s_add_u32 s4, s16, s27
s_addc_u32 s5, s17, 0
s_sub_u32 s6, 0x400000, s27
s_mov_b32 s7, 0x20000
s_mov_b32 m0, s26

s_nop 0
buffer_load_dwordx4 v13, s[4:7], 0 offen lds
buffer_load_dwordx4 v14, s[4:7], s64 offen offset:1024 lds
buffer_load_dwordx4 v13, s[4:7], s65 offen offset:2048 lds
buffer_load_dwordx4 v14, s[4:7], s66 offen offset:3072 lds
s_add_u32 m0, s26, 4096
s_nop 0
buffer_load_dwordx4 v13, s[4:7], s67 offen lds
buffer_load_dwordx4 v14, s[4:7], s68 offen offset:1024 lds
buffer_load_dwordx4 v13, s[4:7], s69 offen offset:2048 lds
buffer_load_dwordx4 v14, s[4:7], s70 offen offset:3072 lds
s_mul_i32 s24, s46, 6
s_lshl_b32 s40, s24, 10
s_lshl_b32 s25, s24, 14
s_add_u32 s25, s25, 128
v_add_u32 v2, s25, v24
v_xor_b32 v3, 64, v2
v_and_b32 v23, 1, v21
v_lshlrev_b32 v23, 1, v23
v_xor_b32 v23, v22, v23
v_lshlrev_b32 v23, 4, v23
v_mul_u32_u24 v24, 6144, v20
s_lshl_b32 s41, s46, 13
s_lshl_b32 s25, s46, 11
v_add3_u32 v4, v24, v23, s25
v_xor_b32 v5, 64, v4
s_lshl_b32 s24, s45, 7
s_add_u32 s8, s18, s24
s_addc_u32 s9, s19, 0
s_sub_u32 s10, 0x600000, s24
s_mov_b32 s11, 0x20000
s_mov_b32 s80, 48128
s_add_u32 s81, s80, s80
s_add_u32 s82, s81, s80
s_lshl_b32 s83, 3, 16
s_add_u32 s84, s83, s80
s_add_u32 s85, s83, s81
s_add_u32 s86, s83, s82
s_add_u32 s88, s40, 65536
s_mov_b32 s89, s40
s_add_u32 s40, s40, 32768
s_mov_b32 s87, s40

s_cmp_eq_u32 s46, 3
s_cbranch_scc1 .Lp3
s_add_u32 m0, s41, 98304
s_nop 0
buffer_load_dwordx4 v4, s[8:11], 0 offen lds
buffer_load_dwordx4 v5, s[8:11], s80 offen offset:1024 lds
buffer_load_dwordx4 v4, s[8:11], s81 offen offset:2048 lds
buffer_load_dwordx4 v5, s[8:11], s82 offen offset:3072 lds
s_add_u32 m0, s41, 102400
s_nop 0
buffer_load_dwordx4 v4, s[8:11], s83 offen lds
buffer_load_dwordx4 v5, s[8:11], s84 offen offset:1024 lds
buffer_load_dwordx4 v4, s[8:11], s85 offen offset:2048 lds
buffer_load_dwordx4 v5, s[8:11], s86 offen offset:3072 lds
s_add_u32 s8, s8, 393216
s_addc_u32 s9, s9, 0
s_sub_u32 s10, s10, 393216
s_mov_b32 s71, 131072
s_mov_b32 s72, 146432
s_mov_b32 s73, 161792
s_mov_b32 s74, 177152
s_mov_b32 s75, 196608
s_mov_b32 s76, 211968
s_mov_b32 s92, 32768
s_mov_b32 s93, 32768
s_mov_b32 s94, -65536
s_mov_b32 s99, 393216

s_mov_b32 s12, s62
s_mov_b32 s13, s63
s_mov_b32 s14, 0x10000000
s_mov_b32 s15, 0x20000
v_and_b32 v13, 7, v0
v_and_b32 v14, 1, v0
s_sub_u32 s24, s44, 1
s_max_i32 s24, s24, 0
v_mov_b32 v15, s24
v_mov_b32 v16, s44
v_cmp_eq_u32 vcc, 0, v14
s_cmp_eq_u32 s43, 0
s_cselect_b32 s25, 0x4000, 0
v_cndmask_b32 v15, v15, v16, vcc
s_cselect_b64 vcc, -1, 0
s_lshl_b32 s26, s45, 7
s_add_u32 s25, s25, s26
s_add_u32 s25, s25, 29360128
v_cndmask_b32 v15, v15, v13, vcc
v_lshlrev_b32 v15, 11, v15
v_bfe_u32 v14, v0, 1, 1
v_lshlrev_b32 v14, 15, v14
v_cndmask_b32 v14, v14, 0, vcc
v_add3_u32 v63, s25, v15, v14
buffer_load_dword v62, v63, s[12:15], 0 offen sc1

s_lshl_b32 s24, s43, 3
s_add_u32 s24, s24, s44
s_lshl_b32 s24, s24, 11
s_add_u32 s24, s24, 29409280
v_and_b32 v61, 15, v0
v_lshlrev_b32 v61, 7, v61
v_add_u32 v61, s24, v61
buffer_load_dword v60, v61, s[12:15], 0 offen sc1

s_add_u32 m0, s41, 122880
s_nop 0
buffer_load_dwordx4 v4, s[8:11], 0 offen lds
buffer_load_dwordx4 v5, s[8:11], s80 offen offset:1024 lds
buffer_load_dwordx4 v4, s[8:11], s81 offen offset:2048 lds
buffer_load_dwordx4 v5, s[8:11], s82 offen offset:3072 lds
s_add_u32 m0, s41, 126976
s_nop 0
buffer_load_dwordx4 v4, s[8:11], s83 offen lds
buffer_load_dwordx4 v5, s[8:11], s84 offen offset:1024 lds
buffer_load_dwordx4 v4, s[8:11], s85 offen offset:2048 lds
buffer_load_dwordx4 v5, s[8:11], s86 offen offset:3072 lds
s_add_u32 s8, s8, 393216
s_addc_u32 s9, s9, 0
s_sub_u32 s10, s10, 393216
s_add_u32 m0, s40, 0
s_nop 0
buffer_load_dwordx4 v2, s[4:7], 0 offen lds
buffer_load_dwordx4 v3, s[4:7], s64 offen offset:1024 lds
buffer_load_dwordx4 v2, s[4:7], s65 offen offset:2048 lds
buffer_load_dwordx4 v3, s[4:7], s66 offen offset:3072 lds
s_add_u32 m0, s40, 4096
s_nop 0
buffer_load_dwordx4 v2, s[4:7], s67 offen lds
buffer_load_dwordx4 v3, s[4:7], s68 offen offset:1024 lds
v_add_u32 v2, 0x80, v2
v_add_u32 v3, 0x80, v3
s_mov_b32 s16, s87
s_mov_b32 s87, s88
s_mov_b32 s88, s89
s_mov_b32 s89, s16
s_mov_b32 s40, s87
s_mov_b32 s62, 256
s_mov_b32 s63, 0x20000
s_mov_b32 s97, -65536
s_mov_b32 s96, 32768
s_mov_b32 s39, 0
s_mov_b32 s47, 0
v_lshrrev_b32 v21, 4, v0
v_and_b32 v20, 15, v0
v_bfe_u32 v22, v0, 1, 3
v_xor_b32 v22, v22, v21
s_lshr_b32 s16, s46, 1
s_lshl_b32 s16, s16, 7
v_add_u32 v23, s16, v20
v_lshlrev_b32 v23, 7, v23

v_xor_b32 v24, 0, v22
v_lshlrev_b32 v24, 4, v24
v_add_u32 v6, v23, v24
v_xor_b32 v24, 4, v22
v_lshlrev_b32 v24, 4, v24
v_add_u32 v7, v23, v24
v_bfe_u32 v20, v0, 2, 2
v_lshlrev_b32 v22, 3, v21
v_add_u32 v22, v22, v20
v_lshlrev_b32 v22, 7, v22
v_bfe_u32 v23, v0, 3, 1
v_and_b32 v24, 1, v21
v_lshlrev_b32 v24, 1, v24
v_or_b32 v23, v23, v24
s_and_b32 s16, s46, 1
s_lshl_b32 s16, s16, 1
v_xor_b32 v23, s16, v23
v_lshlrev_b32 v23, 5, v23
v_add_u32 v22, v22, v23
v_and_b32 v23, 3, v0
v_lshlrev_b32 v23, 3, v23
v_add_u32 v22, v22, v23
v_add_u32 v8, 98304, v22
v_xor_b32 v9, 32, v8

s_waitcnt vmcnt(16)
s_barrier
s_cmp_eq_u32 s43, 0
s_cbranch_scc1 .Lmain_A0
.Lv_B0:
ds_read_b128 a[0:3], v6 offset:0
ds_read_b64_tr_b16 a[32:33], v8 offset:0
ds_read_b64_tr_b16 a[34:35], v8 offset:512
ds_read_b64_tr_b16 a[36:37], v9 offset:0
ds_read_b64_tr_b16 a[38:39], v9 offset:512
ds_read_b64_tr_b16 a[40:41], v8 offset:8192
ds_read_b64_tr_b16 a[42:43], v8 offset:8704
ds_read_b64_tr_b16 a[44:45], v9 offset:8192
ds_read_b64_tr_b16 a[46:47], v9 offset:8704
ds_read_b64_tr_b16 a[48:49], v8 offset:16384
ds_read_b64_tr_b16 a[50:51], v8 offset:16896
ds_read_b64_tr_b16 a[52:53], v9 offset:16384
ds_read_b64_tr_b16 a[54:55], v9 offset:16896
ds_read_b128 a[4:7], v6 offset:2048
ds_read_b128 a[8:11], v6 offset:4096
ds_read_b128 a[12:15], v6 offset:6144
ds_read_b128 a[16:19], v6 offset:8192
ds_read_b128 a[20:23], v6 offset:10240
ds_read_b128 a[24:27], v6 offset:12288
ds_read_b128 a[28:31], v6 offset:14336
s_mov_b32 s42, 0
s_waitcnt lgkmcnt(15)
v_mfma_f32_16x16x32_bf16 v[64:67], a[32:35], a[0:3], 0
ds_read_b128 a[64:67], v7 offset:0
v_mfma_f32_16x16x32_bf16 v[68:71], a[36:39], a[0:3], 0
s_add_u32 m0, s40, 0
s_nop 0
buffer_load_dwordx4 v2, s[4:7], 0 offen lds
s_waitcnt lgkmcnt(14)
v_mfma_f32_16x16x32_bf16 v[72:75], a[40:43], a[0:3], 0
ds_read_b64_tr_b16 a[96:97], v8 offset:4096
s_waitcnt lgkmcnt(13)
v_mfma_f32_16x16x32_bf16 v[76:79], a[44:47], a[0:3], 0
s_waitcnt lgkmcnt(11)
v_mfma_f32_16x16x32_bf16 v[80:83], a[0:3], a[48:51], 0
ds_read_b64_tr_b16 a[98:99], v8 offset:4608
s_waitcnt lgkmcnt(10)
v_mfma_f32_16x16x32_bf16 v[84:87], a[0:3], a[52:55], 0
buffer_load_dwordx4 v3, s[4:7], s64 offen offset:1024 lds
s_waitcnt lgkmcnt(9)
v_mfma_f32_16x16x32_bf16 v[88:91], a[32:35], a[4:7], 0
ds_read_b64_tr_b16 a[100:101], v9 offset:4096
v_mfma_f32_16x16x32_bf16 v[92:95], a[36:39], a[4:7], 0
v_mfma_f32_16x16x32_bf16 v[96:99], a[40:43], a[4:7], 0
ds_read_b64_tr_b16 a[102:103], v9 offset:4608
v_mfma_f32_16x16x32_bf16 v[100:103], a[44:47], a[4:7], 0
buffer_load_dwordx4 v2, s[4:7], s65 offen offset:2048 lds
v_mfma_f32_16x16x32_bf16 v[104:107], a[4:7], a[48:51], 0
ds_read_b64_tr_b16 a[104:105], v8 offset:12288
v_mfma_f32_16x16x32_bf16 v[108:111], a[4:7], a[52:55], 0
s_waitcnt lgkmcnt(3)
v_mfma_f32_16x16x32_bf16 v[112:115], a[32:35], a[8:11], 0
ds_read_b64_tr_b16 a[106:107], v8 offset:12800
v_mfma_f32_16x16x32_bf16 v[116:119], a[36:39], a[8:11], 0
buffer_load_dwordx4 v3, s[4:7], s66 offen offset:3072 lds
v_mfma_f32_16x16x32_bf16 v[120:123], a[40:43], a[8:11], 0
ds_read_b64_tr_b16 a[108:109], v9 offset:12288
v_mfma_f32_16x16x32_bf16 v[124:127], a[44:47], a[8:11], 0
v_mfma_f32_16x16x32_bf16 v[128:131], a[8:11], a[48:51], 0
ds_read_b64_tr_b16 a[110:111], v9 offset:12800
v_mfma_f32_16x16x32_bf16 v[132:135], a[8:11], a[52:55], 0
s_add_u32 m0, s40, 4096
s_nop 0
buffer_load_dwordx4 v2, s[4:7], s67 offen lds
v_mfma_f32_16x16x32_bf16 v[136:139], a[32:35], a[12:15], 0
ds_read_b64_tr_b16 a[112:113], v8 offset:20480
v_mfma_f32_16x16x32_bf16 v[140:143], a[36:39], a[12:15], 0
v_mfma_f32_16x16x32_bf16 v[144:147], a[40:43], a[12:15], 0
ds_read_b64_tr_b16 a[114:115], v8 offset:20992
v_mfma_f32_16x16x32_bf16 v[148:151], a[44:47], a[12:15], 0
buffer_load_dwordx4 v3, s[4:7], s68 offen offset:1024 lds
v_mfma_f32_16x16x32_bf16 v[152:155], a[12:15], a[48:51], 0
ds_read_b64_tr_b16 a[116:117], v9 offset:20480
v_add_u32 v2, 0x80, v2
v_mfma_f32_16x16x32_bf16 v[156:159], a[12:15], a[52:55], 0
v_add_u32 v3, 0x80, v3
v_mfma_f32_16x16x32_bf16 v[160:163], a[32:35], a[16:19], 0
ds_read_b64_tr_b16 a[118:119], v9 offset:20992
s_mov_b32 s16, s87
v_mfma_f32_16x16x32_bf16 v[164:167], a[36:39], a[16:19], 0
s_mov_b32 s87, s88
v_mfma_f32_16x16x32_bf16 v[168:171], a[40:43], a[16:19], 0
ds_read_b128 a[68:71], v7 offset:2048
s_mov_b32 s88, s89
v_mfma_f32_16x16x32_bf16 v[172:175], a[44:47], a[16:19], 0
s_mov_b32 s89, s16
v_mfma_f32_16x16x32_bf16 v[176:179], a[16:19], a[48:51], 0
ds_read_b128 a[72:75], v7 offset:4096
s_mov_b32 s40, s87
v_mfma_f32_16x16x32_bf16 v[180:183], a[16:19], a[52:55], 0
v_mfma_f32_16x16x32_bf16 v[184:187], a[32:35], a[20:23], 0
ds_read_b128 a[76:79], v7 offset:6144
v_mfma_f32_16x16x32_bf16 v[188:191], a[36:39], a[20:23], 0
v_mfma_f32_16x16x32_bf16 v[192:195], a[40:43], a[20:23], 0
ds_read_b128 a[80:83], v7 offset:8192
v_mfma_f32_16x16x32_bf16 v[196:199], a[44:47], a[20:23], 0
v_mfma_f32_16x16x32_bf16 v[200:203], a[20:23], a[48:51], 0
ds_read_b128 a[84:87], v7 offset:10240
v_mfma_f32_16x16x32_bf16 v[204:207], a[20:23], a[52:55], 0
v_mfma_f32_16x16x32_bf16 v[208:211], a[32:35], a[24:27], 0
ds_read_b128 a[88:91], v7 offset:12288
v_mfma_f32_16x16x32_bf16 v[212:215], a[36:39], a[24:27], 0
v_mfma_f32_16x16x32_bf16 v[216:219], a[40:43], a[24:27], 0
ds_read_b128 a[92:95], v7 offset:14336
v_mfma_f32_16x16x32_bf16 v[220:223], a[44:47], a[24:27], 0
v_mfma_f32_16x16x32_bf16 v[224:227], a[24:27], a[48:51], 0
v_add_u32 v7, s92, v7
v_mfma_f32_16x16x32_bf16 v[228:231], a[24:27], a[52:55], 0
v_add_u32 v6, s92, v6
v_mfma_f32_16x16x32_bf16 v[232:235], a[32:35], a[28:31], 0
s_mov_b32 s17, s92
v_mfma_f32_16x16x32_bf16 v[236:239], a[36:39], a[28:31], 0
s_mov_b32 s92, s93
v_mfma_f32_16x16x32_bf16 v[240:243], a[40:43], a[28:31], 0
s_mov_b32 s93, s94
v_mfma_f32_16x16x32_bf16 v[244:247], a[44:47], a[28:31], 0
s_mov_b32 s94, s17
v_mfma_f32_16x16x32_bf16 v[248:251], a[28:31], a[48:51], 0
v_mfma_f32_16x16x32_bf16 v[252:255], a[28:31], a[52:55], 0
s_waitcnt lgkmcnt(0)
v_mfma_f32_16x16x32_bf16 v[64:67], a[96:99], a[64:67], v[64:67]
s_waitcnt vmcnt(6)
s_barrier
v_mfma_f32_16x16x32_bf16 v[68:71], a[100:103], a[64:67], v[68:71]
s_add_u32 m0, s41, 98304
s_nop 0
buffer_load_dwordx4 v4, s[8:11], 0 offen lds
v_mfma_f32_16x16x32_bf16 v[72:75], a[104:107], a[64:67], v[72:75]
ds_read_b128 a[0:3], v6 offset:0
v_mfma_f32_16x16x32_bf16 v[76:79], a[108:111], a[64:67], v[76:79]
s_cmp_eq_u32 s43, 0
s_cselect_b32 s24, s44, 0
s_cselect_b32 s25, 0x4000, 0
v_readlane_b32 s30, v62, s24
v_readlane_b32 s31, v62, 1
v_readlane_b32 s33, v63, 1
v_readlane_b32 s3, v62, 2
v_readlane_b32 s34, v62, 3
s_lshl_b32 s24, s44, 4
s_add_u32 s24, s24, s45
s_lshl_b32 s24, s24, 7
s_add_u32 s32, s24, s25
s_add_u32 s32, s32, 29360128

v_accvgpr_write_b32 a252, v60
v_accvgpr_write_b32 a253, v61
v_mfma_f32_16x16x32_bf16 v[80:83], a[64:67], a[112:115], v[80:83]
ds_read_b64_tr_b16 a[32:33], v8 offset:24576
v_mfma_f32_16x16x32_bf16 v[84:87], a[64:67], a[116:119], v[84:87]
buffer_load_dwordx4 v5, s[8:11], s80 offen offset:1024 lds
v_mfma_f32_16x16x32_bf16 v[88:91], a[96:99], a[68:71], v[88:91]
ds_read_b64_tr_b16 a[34:35], v8 offset:25088
v_mfma_f32_16x16x32_bf16 v[92:95], a[100:103], a[68:71], v[92:95]
v_mfma_f32_16x16x32_bf16 v[96:99], a[104:107], a[68:71], v[96:99]
ds_read_b64_tr_b16 a[36:37], v9 offset:24576
v_mfma_f32_16x16x32_bf16 v[100:103], a[108:111], a[68:71], v[100:103]
buffer_load_dwordx4 v4, s[8:11], s81 offen offset:2048 lds
v_mfma_f32_16x16x32_bf16 v[104:107], a[68:71], a[112:115], v[104:107]
ds_read_b64_tr_b16 a[38:39], v9 offset:25088
v_mfma_f32_16x16x32_bf16 v[108:111], a[68:71], a[116:119], v[108:111]
v_mfma_f32_16x16x32_bf16 v[112:115], a[96:99], a[72:75], v[112:115]
ds_read_b64_tr_b16 a[40:41], v8 offset:32768
v_mfma_f32_16x16x32_bf16 v[116:119], a[100:103], a[72:75], v[116:119]
buffer_load_dwordx4 v5, s[8:11], s82 offen offset:3072 lds
v_mfma_f32_16x16x32_bf16 v[120:123], a[104:107], a[72:75], v[120:123]
ds_read_b64_tr_b16 a[42:43], v8 offset:33280
v_mfma_f32_16x16x32_bf16 v[124:127], a[108:111], a[72:75], v[124:127]
v_mfma_f32_16x16x32_bf16 v[128:131], a[72:75], a[112:115], v[128:131]
ds_read_b64_tr_b16 a[44:45], v9 offset:32768
v_mfma_f32_16x16x32_bf16 v[132:135], a[72:75], a[116:119], v[132:135]
s_add_u32 m0, s41, 102400
s_nop 0
buffer_load_dwordx4 v4, s[8:11], s83 offen lds
v_mfma_f32_16x16x32_bf16 v[136:139], a[96:99], a[76:79], v[136:139]
ds_read_b64_tr_b16 a[46:47], v9 offset:33280
v_mfma_f32_16x16x32_bf16 v[140:143], a[100:103], a[76:79], v[140:143]
v_mfma_f32_16x16x32_bf16 v[144:147], a[104:107], a[76:79], v[144:147]
ds_read_b64_tr_b16 a[48:49], v8 offset:40960
v_mfma_f32_16x16x32_bf16 v[148:151], a[108:111], a[76:79], v[148:151]
buffer_load_dwordx4 v5, s[8:11], s84 offen offset:1024 lds
v_mfma_f32_16x16x32_bf16 v[152:155], a[76:79], a[112:115], v[152:155]
ds_read_b64_tr_b16 a[50:51], v8 offset:41472
v_mfma_f32_16x16x32_bf16 v[156:159], a[76:79], a[116:119], v[156:159]
v_mfma_f32_16x16x32_bf16 v[160:163], a[96:99], a[80:83], v[160:163]
ds_read_b64_tr_b16 a[52:53], v9 offset:40960
v_mfma_f32_16x16x32_bf16 v[164:167], a[100:103], a[80:83], v[164:167]
buffer_load_dwordx4 v4, s[8:11], s85 offen offset:2048 lds
v_mfma_f32_16x16x32_bf16 v[168:171], a[104:107], a[80:83], v[168:171]
ds_read_b64_tr_b16 a[54:55], v9 offset:41472
v_mfma_f32_16x16x32_bf16 v[172:175], a[108:111], a[80:83], v[172:175]
v_mfma_f32_16x16x32_bf16 v[176:179], a[80:83], a[112:115], v[176:179]
ds_read_b128 a[4:7], v6 offset:2048
v_mfma_f32_16x16x32_bf16 v[180:183], a[80:83], a[116:119], v[180:183]
buffer_load_dwordx4 v5, s[8:11], s86 offen offset:3072 lds
v_mfma_f32_16x16x32_bf16 v[184:187], a[96:99], a[84:87], v[184:187]
ds_read_b128 a[8:11], v6 offset:4096
v_mfma_f32_16x16x32_bf16 v[188:191], a[100:103], a[84:87], v[188:191]
s_add_u32 s8, s8, 393216
s_addc_u32 s9, s9, 0
v_mfma_f32_16x16x32_bf16 v[192:195], a[104:107], a[84:87], v[192:195]
ds_read_b128 a[12:15], v6 offset:6144
v_mfma_f32_16x16x32_bf16 v[196:199], a[108:111], a[84:87], v[196:199]
s_add_u32 m0, s40, 0
s_nop 0
buffer_load_dwordx4 v2, s[4:7], 0 offen lds
v_mfma_f32_16x16x32_bf16 v[200:203], a[84:87], a[112:115], v[200:203]
ds_read_b128 a[16:19], v6 offset:8192
v_mfma_f32_16x16x32_bf16 v[204:207], a[84:87], a[116:119], v[204:207]
s_sub_u32 s10, s10, 393216
v_mfma_f32_16x16x32_bf16 v[208:211], a[96:99], a[88:91], v[208:211]
ds_read_b128 a[20:23], v6 offset:10240
v_mfma_f32_16x16x32_bf16 v[212:215], a[100:103], a[88:91], v[212:215]
buffer_load_dwordx4 v3, s[4:7], s64 offen offset:1024 lds
v_mfma_f32_16x16x32_bf16 v[216:219], a[104:107], a[88:91], v[216:219]
ds_read_b128 a[24:27], v6 offset:12288
v_mfma_f32_16x16x32_bf16 v[220:223], a[108:111], a[88:91], v[220:223]
v_mfma_f32_16x16x32_bf16 v[224:227], a[88:91], a[112:115], v[224:227]
ds_read_b128 a[28:31], v6 offset:14336
v_mfma_f32_16x16x32_bf16 v[228:231], a[88:91], a[116:119], v[228:231]
buffer_load_dwordx4 v2, s[4:7], s65 offen offset:2048 lds
v_mfma_f32_16x16x32_bf16 v[232:235], a[96:99], a[92:95], v[232:235]
v_mfma_f32_16x16x32_bf16 v[236:239], a[100:103], a[92:95], v[236:239]
v_mfma_f32_16x16x32_bf16 v[240:243], a[104:107], a[92:95], v[240:243]
v_mfma_f32_16x16x32_bf16 v[244:247], a[108:111], a[92:95], v[244:247]
buffer_load_dwordx4 v3, s[4:7], s66 offen offset:3072 lds
v_mfma_f32_16x16x32_bf16 v[248:251], a[92:95], a[112:115], v[248:251]
v_mfma_f32_16x16x32_bf16 v[252:255], a[92:95], a[116:119], v[252:255]
.p2align 6
.LB0_loop:
s_waitcnt lgkmcnt(0)
v_mfma_f32_16x16x32_bf16 v[64:67], a[32:35], a[0:3], v[64:67]
ds_read_b128 a[64:67], v7 offset:0
v_mfma_f32_16x16x32_bf16 v[68:71], a[36:39], a[0:3], v[68:71]
s_add_u32 m0, s40, 4096
s_nop 0
buffer_load_dwordx4 v2, s[4:7], s67 offen lds
v_mfma_f32_16x16x32_bf16 v[72:75], a[40:43], a[0:3], v[72:75]
ds_read_b64_tr_b16 a[96:97], v8 offset:28672
v_mfma_f32_16x16x32_bf16 v[76:79], a[44:47], a[0:3], v[76:79]
v_mfma_f32_16x16x32_bf16 v[80:83], a[0:3], a[48:51], v[80:83]
ds_read_b64_tr_b16 a[98:99], v8 offset:29184
v_mfma_f32_16x16x32_bf16 v[84:87], a[0:3], a[52:55], v[84:87]
buffer_load_dwordx4 v3, s[4:7], s68 offen offset:1024 lds
v_mfma_f32_16x16x32_bf16 v[88:91], a[32:35], a[4:7], v[88:91]
ds_read_b64_tr_b16 a[100:101], v9 offset:28672
v_mfma_f32_16x16x32_bf16 v[92:95], a[36:39], a[4:7], v[92:95]
v_add_u32 v2, 0x80, v2
v_mfma_f32_16x16x32_bf16 v[96:99], a[40:43], a[4:7], v[96:99]
ds_read_b64_tr_b16 a[102:103], v9 offset:29184
v_mfma_f32_16x16x32_bf16 v[100:103], a[44:47], a[4:7], v[100:103]
v_mfma_f32_16x16x32_bf16 v[104:107], a[4:7], a[48:51], v[104:107]
ds_read_b64_tr_b16 a[104:105], v8 offset:36864
v_mfma_f32_16x16x32_bf16 v[108:111], a[4:7], a[52:55], v[108:111]
v_add_u32 v3, 0x80, v3
v_mfma_f32_16x16x32_bf16 v[112:115], a[32:35], a[8:11], v[112:115]
ds_read_b64_tr_b16 a[106:107], v8 offset:37376
v_mfma_f32_16x16x32_bf16 v[116:119], a[36:39], a[8:11], v[116:119]
v_mfma_f32_16x16x32_bf16 v[120:123], a[40:43], a[8:11], v[120:123]
ds_read_b64_tr_b16 a[108:109], v9 offset:36864
v_mfma_f32_16x16x32_bf16 v[124:127], a[44:47], a[8:11], v[124:127]
s_mov_b32 s16, s87
v_mfma_f32_16x16x32_bf16 v[128:131], a[8:11], a[48:51], v[128:131]
ds_read_b64_tr_b16 a[110:111], v9 offset:37376
v_mfma_f32_16x16x32_bf16 v[132:135], a[8:11], a[52:55], v[132:135]
v_mfma_f32_16x16x32_bf16 v[136:139], a[32:35], a[12:15], v[136:139]
ds_read_b64_tr_b16 a[112:113], v8 offset:45056
v_mfma_f32_16x16x32_bf16 v[140:143], a[36:39], a[12:15], v[140:143]
s_mov_b32 s87, s88
v_mfma_f32_16x16x32_bf16 v[144:147], a[40:43], a[12:15], v[144:147]
ds_read_b64_tr_b16 a[114:115], v8 offset:45568
v_mfma_f32_16x16x32_bf16 v[148:151], a[44:47], a[12:15], v[148:151]
v_mfma_f32_16x16x32_bf16 v[152:155], a[12:15], a[48:51], v[152:155]
ds_read_b64_tr_b16 a[116:117], v9 offset:45056
v_mfma_f32_16x16x32_bf16 v[156:159], a[12:15], a[52:55], v[156:159]
s_mov_b32 s88, s89
v_mfma_f32_16x16x32_bf16 v[160:163], a[32:35], a[16:19], v[160:163]
ds_read_b64_tr_b16 a[118:119], v9 offset:45568
v_mfma_f32_16x16x32_bf16 v[164:167], a[36:39], a[16:19], v[164:167]
v_mfma_f32_16x16x32_bf16 v[168:171], a[40:43], a[16:19], v[168:171]
ds_read_b128 a[68:71], v7 offset:2048
v_mfma_f32_16x16x32_bf16 v[172:175], a[44:47], a[16:19], v[172:175]
s_mov_b32 s89, s16
v_mfma_f32_16x16x32_bf16 v[176:179], a[16:19], a[48:51], v[176:179]
ds_read_b128 a[72:75], v7 offset:4096
v_mfma_f32_16x16x32_bf16 v[180:183], a[16:19], a[52:55], v[180:183]
v_mfma_f32_16x16x32_bf16 v[184:187], a[32:35], a[20:23], v[184:187]
ds_read_b128 a[76:79], v7 offset:6144
v_mfma_f32_16x16x32_bf16 v[188:191], a[36:39], a[20:23], v[188:191]
s_mov_b32 s40, s87
v_mfma_f32_16x16x32_bf16 v[192:195], a[40:43], a[20:23], v[192:195]
ds_read_b128 a[80:83], v7 offset:8192
v_mfma_f32_16x16x32_bf16 v[196:199], a[44:47], a[20:23], v[196:199]
v_mfma_f32_16x16x32_bf16 v[200:203], a[20:23], a[48:51], v[200:203]
ds_read_b128 a[84:87], v7 offset:10240
v_mfma_f32_16x16x32_bf16 v[204:207], a[20:23], a[52:55], v[204:207]
v_mfma_f32_16x16x32_bf16 v[208:211], a[32:35], a[24:27], v[208:211]
ds_read_b128 a[88:91], v7 offset:12288
v_mfma_f32_16x16x32_bf16 v[212:215], a[36:39], a[24:27], v[212:215]
v_mfma_f32_16x16x32_bf16 v[216:219], a[40:43], a[24:27], v[216:219]
ds_read_b128 a[92:95], v7 offset:14336
v_mfma_f32_16x16x32_bf16 v[220:223], a[44:47], a[24:27], v[220:223]
v_mfma_f32_16x16x32_bf16 v[224:227], a[24:27], a[48:51], v[224:227]
v_add_u32 v7, s92, v7
v_mfma_f32_16x16x32_bf16 v[228:231], a[24:27], a[52:55], v[228:231]
v_add_u32 v6, s92, v6
v_mfma_f32_16x16x32_bf16 v[232:235], a[32:35], a[28:31], v[232:235]
s_mov_b32 s17, s92
v_mfma_f32_16x16x32_bf16 v[236:239], a[36:39], a[28:31], v[236:239]
s_mov_b32 s92, s93
v_mfma_f32_16x16x32_bf16 v[240:243], a[40:43], a[28:31], v[240:243]
s_mov_b32 s93, s94
v_mfma_f32_16x16x32_bf16 v[244:247], a[44:47], a[28:31], v[244:247]
s_mov_b32 s94, s17
v_mfma_f32_16x16x32_bf16 v[248:251], a[28:31], a[48:51], v[248:251]
v_mfma_f32_16x16x32_bf16 v[252:255], a[28:31], a[52:55], v[252:255]
s_waitcnt lgkmcnt(0)
v_mfma_f32_16x16x32_bf16 v[64:67], a[96:99], a[64:67], v[64:67]
s_waitcnt vmcnt(6)
s_barrier
v_mfma_f32_16x16x32_bf16 v[68:71], a[100:103], a[64:67], v[68:71]
s_add_u32 m0, s41, 122880
s_nop 0
buffer_load_dwordx4 v4, s[8:11], 0 offen lds
v_mfma_f32_16x16x32_bf16 v[72:75], a[104:107], a[64:67], v[72:75]
ds_read_b128 a[0:3], v6 offset:0
v_mfma_f32_16x16x32_bf16 v[76:79], a[108:111], a[64:67], v[76:79]
v_mfma_f32_16x16x32_bf16 v[80:83], a[64:67], a[112:115], v[80:83]
ds_read_b64_tr_b16 a[32:33], v8 offset:0
v_mfma_f32_16x16x32_bf16 v[84:87], a[64:67], a[116:119], v[84:87]
buffer_load_dwordx4 v5, s[8:11], s80 offen offset:1024 lds
v_mfma_f32_16x16x32_bf16 v[88:91], a[96:99], a[68:71], v[88:91]
ds_read_b64_tr_b16 a[34:35], v8 offset:512
v_mfma_f32_16x16x32_bf16 v[92:95], a[100:103], a[68:71], v[92:95]
v_mfma_f32_16x16x32_bf16 v[96:99], a[104:107], a[68:71], v[96:99]
ds_read_b64_tr_b16 a[36:37], v9 offset:0
v_mfma_f32_16x16x32_bf16 v[100:103], a[108:111], a[68:71], v[100:103]
buffer_load_dwordx4 v4, s[8:11], s81 offen offset:2048 lds
v_mfma_f32_16x16x32_bf16 v[104:107], a[68:71], a[112:115], v[104:107]
ds_read_b64_tr_b16 a[38:39], v9 offset:512
v_mfma_f32_16x16x32_bf16 v[108:111], a[68:71], a[116:119], v[108:111]
v_mfma_f32_16x16x32_bf16 v[112:115], a[96:99], a[72:75], v[112:115]
ds_read_b64_tr_b16 a[40:41], v8 offset:8192
v_mfma_f32_16x16x32_bf16 v[116:119], a[100:103], a[72:75], v[116:119]
buffer_load_dwordx4 v5, s[8:11], s82 offen offset:3072 lds
v_mfma_f32_16x16x32_bf16 v[120:123], a[104:107], a[72:75], v[120:123]
ds_read_b64_tr_b16 a[42:43], v8 offset:8704
v_mfma_f32_16x16x32_bf16 v[124:127], a[108:111], a[72:75], v[124:127]
v_mfma_f32_16x16x32_bf16 v[128:131], a[72:75], a[112:115], v[128:131]
ds_read_b64_tr_b16 a[44:45], v9 offset:8192
v_mfma_f32_16x16x32_bf16 v[132:135], a[72:75], a[116:119], v[132:135]
s_add_u32 m0, s41, 126976
s_nop 0
buffer_load_dwordx4 v4, s[8:11], s83 offen lds
v_mfma_f32_16x16x32_bf16 v[136:139], a[96:99], a[76:79], v[136:139]
ds_read_b64_tr_b16 a[46:47], v9 offset:8704
v_mfma_f32_16x16x32_bf16 v[140:143], a[100:103], a[76:79], v[140:143]
v_mfma_f32_16x16x32_bf16 v[144:147], a[104:107], a[76:79], v[144:147]
ds_read_b64_tr_b16 a[48:49], v8 offset:16384
v_mfma_f32_16x16x32_bf16 v[148:151], a[108:111], a[76:79], v[148:151]
buffer_load_dwordx4 v5, s[8:11], s84 offen offset:1024 lds
v_mfma_f32_16x16x32_bf16 v[152:155], a[76:79], a[112:115], v[152:155]
ds_read_b64_tr_b16 a[50:51], v8 offset:16896
v_mfma_f32_16x16x32_bf16 v[156:159], a[76:79], a[116:119], v[156:159]
v_mfma_f32_16x16x32_bf16 v[160:163], a[96:99], a[80:83], v[160:163]
ds_read_b64_tr_b16 a[52:53], v9 offset:16384
v_mfma_f32_16x16x32_bf16 v[164:167], a[100:103], a[80:83], v[164:167]
buffer_load_dwordx4 v4, s[8:11], s85 offen offset:2048 lds
v_mfma_f32_16x16x32_bf16 v[168:171], a[104:107], a[80:83], v[168:171]
ds_read_b64_tr_b16 a[54:55], v9 offset:16896
v_mfma_f32_16x16x32_bf16 v[172:175], a[108:111], a[80:83], v[172:175]
v_mfma_f32_16x16x32_bf16 v[176:179], a[80:83], a[112:115], v[176:179]
ds_read_b128 a[4:7], v6 offset:2048
v_mfma_f32_16x16x32_bf16 v[180:183], a[80:83], a[116:119], v[180:183]
buffer_load_dwordx4 v5, s[8:11], s86 offen offset:3072 lds
v_mfma_f32_16x16x32_bf16 v[184:187], a[96:99], a[84:87], v[184:187]
ds_read_b128 a[8:11], v6 offset:4096
v_mfma_f32_16x16x32_bf16 v[188:191], a[100:103], a[84:87], v[188:191]
s_add_u32 s8, s8, 393216
s_addc_u32 s9, s9, 0
v_mfma_f32_16x16x32_bf16 v[192:195], a[104:107], a[84:87], v[192:195]
ds_read_b128 a[12:15], v6 offset:6144
v_mfma_f32_16x16x32_bf16 v[196:199], a[108:111], a[84:87], v[196:199]
s_add_u32 m0, s40, 0
s_nop 0
buffer_load_dwordx4 v2, s[4:7], 0 offen lds
v_mfma_f32_16x16x32_bf16 v[200:203], a[84:87], a[112:115], v[200:203]
ds_read_b128 a[16:19], v6 offset:8192
v_mfma_f32_16x16x32_bf16 v[204:207], a[84:87], a[116:119], v[204:207]
s_sub_u32 s10, s10, 393216
v_mfma_f32_16x16x32_bf16 v[208:211], a[96:99], a[88:91], v[208:211]
ds_read_b128 a[20:23], v6 offset:10240
v_mfma_f32_16x16x32_bf16 v[212:215], a[100:103], a[88:91], v[212:215]
buffer_load_dwordx4 v3, s[4:7], s64 offen offset:1024 lds
v_mfma_f32_16x16x32_bf16 v[216:219], a[104:107], a[88:91], v[216:219]
ds_read_b128 a[24:27], v6 offset:12288
v_mfma_f32_16x16x32_bf16 v[220:223], a[108:111], a[88:91], v[220:223]
v_mfma_f32_16x16x32_bf16 v[224:227], a[88:91], a[112:115], v[224:227]
ds_read_b128 a[28:31], v6 offset:14336
v_mfma_f32_16x16x32_bf16 v[228:231], a[88:91], a[116:119], v[228:231]
buffer_load_dwordx4 v2, s[4:7], s65 offen offset:2048 lds
v_mfma_f32_16x16x32_bf16 v[232:235], a[96:99], a[92:95], v[232:235]
v_mfma_f32_16x16x32_bf16 v[236:239], a[100:103], a[92:95], v[236:239]
v_mfma_f32_16x16x32_bf16 v[240:243], a[104:107], a[92:95], v[240:243]
v_mfma_f32_16x16x32_bf16 v[244:247], a[108:111], a[92:95], v[244:247]
buffer_load_dwordx4 v3, s[4:7], s66 offen offset:3072 lds
v_mfma_f32_16x16x32_bf16 v[248:251], a[92:95], a[112:115], v[248:251]
v_mfma_f32_16x16x32_bf16 v[252:255], a[92:95], a[116:119], v[252:255]
s_waitcnt lgkmcnt(0)
v_mfma_f32_16x16x32_bf16 v[64:67], a[32:35], a[0:3], v[64:67]
ds_read_b128 a[64:67], v7 offset:0
v_mfma_f32_16x16x32_bf16 v[68:71], a[36:39], a[0:3], v[68:71]
s_add_u32 m0, s40, 4096
s_nop 0
buffer_load_dwordx4 v2, s[4:7], s67 offen lds
v_mfma_f32_16x16x32_bf16 v[72:75], a[40:43], a[0:3], v[72:75]
ds_read_b64_tr_b16 a[96:97], v8 offset:4096
v_mfma_f32_16x16x32_bf16 v[76:79], a[44:47], a[0:3], v[76:79]
v_mfma_f32_16x16x32_bf16 v[80:83], a[0:3], a[48:51], v[80:83]
ds_read_b64_tr_b16 a[98:99], v8 offset:4608
v_mfma_f32_16x16x32_bf16 v[84:87], a[0:3], a[52:55], v[84:87]
buffer_load_dwordx4 v3, s[4:7], s68 offen offset:1024 lds
v_mfma_f32_16x16x32_bf16 v[88:91], a[32:35], a[4:7], v[88:91]
ds_read_b64_tr_b16 a[100:101], v9 offset:4096
v_mfma_f32_16x16x32_bf16 v[92:95], a[36:39], a[4:7], v[92:95]
v_add_u32 v2, 0x80, v2
v_mfma_f32_16x16x32_bf16 v[96:99], a[40:43], a[4:7], v[96:99]
ds_read_b64_tr_b16 a[102:103], v9 offset:4608
v_mfma_f32_16x16x32_bf16 v[100:103], a[44:47], a[4:7], v[100:103]
v_mfma_f32_16x16x32_bf16 v[104:107], a[4:7], a[48:51], v[104:107]
ds_read_b64_tr_b16 a[104:105], v8 offset:12288
v_mfma_f32_16x16x32_bf16 v[108:111], a[4:7], a[52:55], v[108:111]
v_add_u32 v3, 0x80, v3
v_mfma_f32_16x16x32_bf16 v[112:115], a[32:35], a[8:11], v[112:115]
ds_read_b64_tr_b16 a[106:107], v8 offset:12800
v_mfma_f32_16x16x32_bf16 v[116:119], a[36:39], a[8:11], v[116:119]
v_mfma_f32_16x16x32_bf16 v[120:123], a[40:43], a[8:11], v[120:123]
ds_read_b64_tr_b16 a[108:109], v9 offset:12288
v_mfma_f32_16x16x32_bf16 v[124:127], a[44:47], a[8:11], v[124:127]
s_mov_b32 s16, s87
v_mfma_f32_16x16x32_bf16 v[128:131], a[8:11], a[48:51], v[128:131]
ds_read_b64_tr_b16 a[110:111], v9 offset:12800
v_mfma_f32_16x16x32_bf16 v[132:135], a[8:11], a[52:55], v[132:135]
v_mfma_f32_16x16x32_bf16 v[136:139], a[32:35], a[12:15], v[136:139]
ds_read_b64_tr_b16 a[112:113], v8 offset:20480
v_mfma_f32_16x16x32_bf16 v[140:143], a[36:39], a[12:15], v[140:143]
s_mov_b32 s87, s88
v_mfma_f32_16x16x32_bf16 v[144:147], a[40:43], a[12:15], v[144:147]
ds_read_b64_tr_b16 a[114:115], v8 offset:20992
v_mfma_f32_16x16x32_bf16 v[148:151], a[44:47], a[12:15], v[148:151]
v_mfma_f32_16x16x32_bf16 v[152:155], a[12:15], a[48:51], v[152:155]
ds_read_b64_tr_b16 a[116:117], v9 offset:20480
v_mfma_f32_16x16x32_bf16 v[156:159], a[12:15], a[52:55], v[156:159]
s_mov_b32 s88, s89
v_mfma_f32_16x16x32_bf16 v[160:163], a[32:35], a[16:19], v[160:163]
ds_read_b64_tr_b16 a[118:119], v9 offset:20992
v_mfma_f32_16x16x32_bf16 v[164:167], a[36:39], a[16:19], v[164:167]
v_mfma_f32_16x16x32_bf16 v[168:171], a[40:43], a[16:19], v[168:171]
ds_read_b128 a[68:71], v7 offset:2048
v_mfma_f32_16x16x32_bf16 v[172:175], a[44:47], a[16:19], v[172:175]
s_mov_b32 s89, s16
v_mfma_f32_16x16x32_bf16 v[176:179], a[16:19], a[48:51], v[176:179]
ds_read_b128 a[72:75], v7 offset:4096
v_mfma_f32_16x16x32_bf16 v[180:183], a[16:19], a[52:55], v[180:183]
v_mfma_f32_16x16x32_bf16 v[184:187], a[32:35], a[20:23], v[184:187]
ds_read_b128 a[76:79], v7 offset:6144
v_mfma_f32_16x16x32_bf16 v[188:191], a[36:39], a[20:23], v[188:191]
s_mov_b32 s40, s87
v_mfma_f32_16x16x32_bf16 v[192:195], a[40:43], a[20:23], v[192:195]
ds_read_b128 a[80:83], v7 offset:8192
v_mfma_f32_16x16x32_bf16 v[196:199], a[44:47], a[20:23], v[196:199]
v_mfma_f32_16x16x32_bf16 v[200:203], a[20:23], a[48:51], v[200:203]
ds_read_b128 a[84:87], v7 offset:10240
v_mfma_f32_16x16x32_bf16 v[204:207], a[20:23], a[52:55], v[204:207]
v_mfma_f32_16x16x32_bf16 v[208:211], a[32:35], a[24:27], v[208:211]
ds_read_b128 a[88:91], v7 offset:12288
v_mfma_f32_16x16x32_bf16 v[212:215], a[36:39], a[24:27], v[212:215]
v_mfma_f32_16x16x32_bf16 v[216:219], a[40:43], a[24:27], v[216:219]
ds_read_b128 a[92:95], v7 offset:14336
v_mfma_f32_16x16x32_bf16 v[220:223], a[44:47], a[24:27], v[220:223]
v_mfma_f32_16x16x32_bf16 v[224:227], a[24:27], a[48:51], v[224:227]
v_add_u32 v7, s92, v7
v_mfma_f32_16x16x32_bf16 v[228:231], a[24:27], a[52:55], v[228:231]
v_add_u32 v6, s92, v6
v_mfma_f32_16x16x32_bf16 v[232:235], a[32:35], a[28:31], v[232:235]
s_mov_b32 s17, s92
v_mfma_f32_16x16x32_bf16 v[236:239], a[36:39], a[28:31], v[236:239]
s_mov_b32 s92, s93
v_mfma_f32_16x16x32_bf16 v[240:243], a[40:43], a[28:31], v[240:243]
s_mov_b32 s93, s94
v_mfma_f32_16x16x32_bf16 v[244:247], a[44:47], a[28:31], v[244:247]
s_mov_b32 s94, s17
v_mfma_f32_16x16x32_bf16 v[248:251], a[28:31], a[48:51], v[248:251]
v_mfma_f32_16x16x32_bf16 v[252:255], a[28:31], a[52:55], v[252:255]
s_waitcnt lgkmcnt(0)
v_mfma_f32_16x16x32_bf16 v[64:67], a[96:99], a[64:67], v[64:67]
s_waitcnt vmcnt(6)
s_barrier
v_mfma_f32_16x16x32_bf16 v[68:71], a[100:103], a[64:67], v[68:71]
s_add_u32 m0, s41, 98304
s_nop 0
buffer_load_dwordx4 v4, s[8:11], 0 offen lds
v_mfma_f32_16x16x32_bf16 v[72:75], a[104:107], a[64:67], v[72:75]
ds_read_b128 a[0:3], v6 offset:0
v_mfma_f32_16x16x32_bf16 v[76:79], a[108:111], a[64:67], v[76:79]
v_mfma_f32_16x16x32_bf16 v[80:83], a[64:67], a[112:115], v[80:83]
ds_read_b64_tr_b16 a[32:33], v8 offset:24576
v_mfma_f32_16x16x32_bf16 v[84:87], a[64:67], a[116:119], v[84:87]
buffer_load_dwordx4 v5, s[8:11], s80 offen offset:1024 lds
v_mfma_f32_16x16x32_bf16 v[88:91], a[96:99], a[68:71], v[88:91]
ds_read_b64_tr_b16 a[34:35], v8 offset:25088
v_mfma_f32_16x16x32_bf16 v[92:95], a[100:103], a[68:71], v[92:95]
v_mfma_f32_16x16x32_bf16 v[96:99], a[104:107], a[68:71], v[96:99]
ds_read_b64_tr_b16 a[36:37], v9 offset:24576
v_mfma_f32_16x16x32_bf16 v[100:103], a[108:111], a[68:71], v[100:103]
buffer_load_dwordx4 v4, s[8:11], s81 offen offset:2048 lds
v_mfma_f32_16x16x32_bf16 v[104:107], a[68:71], a[112:115], v[104:107]
ds_read_b64_tr_b16 a[38:39], v9 offset:25088
v_mfma_f32_16x16x32_bf16 v[108:111], a[68:71], a[116:119], v[108:111]
v_mfma_f32_16x16x32_bf16 v[112:115], a[96:99], a[72:75], v[112:115]
ds_read_b64_tr_b16 a[40:41], v8 offset:32768
v_mfma_f32_16x16x32_bf16 v[116:119], a[100:103], a[72:75], v[116:119]
buffer_load_dwordx4 v5, s[8:11], s82 offen offset:3072 lds
v_mfma_f32_16x16x32_bf16 v[120:123], a[104:107], a[72:75], v[120:123]
ds_read_b64_tr_b16 a[42:43], v8 offset:33280
v_mfma_f32_16x16x32_bf16 v[124:127], a[108:111], a[72:75], v[124:127]
v_mfma_f32_16x16x32_bf16 v[128:131], a[72:75], a[112:115], v[128:131]
ds_read_b64_tr_b16 a[44:45], v9 offset:32768
v_mfma_f32_16x16x32_bf16 v[132:135], a[72:75], a[116:119], v[132:135]
s_add_u32 m0, s41, 102400
s_nop 0
buffer_load_dwordx4 v4, s[8:11], s83 offen lds
v_mfma_f32_16x16x32_bf16 v[136:139], a[96:99], a[76:79], v[136:139]
ds_read_b64_tr_b16 a[46:47], v9 offset:33280
v_mfma_f32_16x16x32_bf16 v[140:143], a[100:103], a[76:79], v[140:143]
v_mfma_f32_16x16x32_bf16 v[144:147], a[104:107], a[76:79], v[144:147]
ds_read_b64_tr_b16 a[48:49], v8 offset:40960
v_mfma_f32_16x16x32_bf16 v[148:151], a[108:111], a[76:79], v[148:151]
buffer_load_dwordx4 v5, s[8:11], s84 offen offset:1024 lds
v_mfma_f32_16x16x32_bf16 v[152:155], a[76:79], a[112:115], v[152:155]
ds_read_b64_tr_b16 a[50:51], v8 offset:41472
v_mfma_f32_16x16x32_bf16 v[156:159], a[76:79], a[116:119], v[156:159]
v_mfma_f32_16x16x32_bf16 v[160:163], a[96:99], a[80:83], v[160:163]
ds_read_b64_tr_b16 a[52:53], v9 offset:40960
v_mfma_f32_16x16x32_bf16 v[164:167], a[100:103], a[80:83], v[164:167]
buffer_load_dwordx4 v4, s[8:11], s85 offen offset:2048 lds
v_mfma_f32_16x16x32_bf16 v[168:171], a[104:107], a[80:83], v[168:171]
ds_read_b64_tr_b16 a[54:55], v9 offset:41472
v_mfma_f32_16x16x32_bf16 v[172:175], a[108:111], a[80:83], v[172:175]
v_mfma_f32_16x16x32_bf16 v[176:179], a[80:83], a[112:115], v[176:179]
ds_read_b128 a[4:7], v6 offset:2048
v_mfma_f32_16x16x32_bf16 v[180:183], a[80:83], a[116:119], v[180:183]
buffer_load_dwordx4 v5, s[8:11], s86 offen offset:3072 lds
v_mfma_f32_16x16x32_bf16 v[184:187], a[96:99], a[84:87], v[184:187]
ds_read_b128 a[8:11], v6 offset:4096
v_mfma_f32_16x16x32_bf16 v[188:191], a[100:103], a[84:87], v[188:191]
s_add_u32 s8, s8, 393216
s_addc_u32 s9, s9, 0
v_mfma_f32_16x16x32_bf16 v[192:195], a[104:107], a[84:87], v[192:195]
ds_read_b128 a[12:15], v6 offset:6144
v_mfma_f32_16x16x32_bf16 v[196:199], a[108:111], a[84:87], v[196:199]
s_add_u32 m0, s40, 0
s_nop 0
buffer_load_dwordx4 v2, s[4:7], 0 offen lds
v_mfma_f32_16x16x32_bf16 v[200:203], a[84:87], a[112:115], v[200:203]
ds_read_b128 a[16:19], v6 offset:8192
v_mfma_f32_16x16x32_bf16 v[204:207], a[84:87], a[116:119], v[204:207]
s_sub_u32 s10, s10, 393216
v_mfma_f32_16x16x32_bf16 v[208:211], a[96:99], a[88:91], v[208:211]
ds_read_b128 a[20:23], v6 offset:10240
v_mfma_f32_16x16x32_bf16 v[212:215], a[100:103], a[88:91], v[212:215]
buffer_load_dwordx4 v3, s[4:7], s64 offen offset:1024 lds
v_mfma_f32_16x16x32_bf16 v[216:219], a[104:107], a[88:91], v[216:219]
ds_read_b128 a[24:27], v6 offset:12288
v_mfma_f32_16x16x32_bf16 v[220:223], a[108:111], a[88:91], v[220:223]
v_mfma_f32_16x16x32_bf16 v[224:227], a[88:91], a[112:115], v[224:227]
ds_read_b128 a[28:31], v6 offset:14336
v_mfma_f32_16x16x32_bf16 v[228:231], a[88:91], a[116:119], v[228:231]
buffer_load_dwordx4 v2, s[4:7], s65 offen offset:2048 lds
v_mfma_f32_16x16x32_bf16 v[232:235], a[96:99], a[92:95], v[232:235]
v_mfma_f32_16x16x32_bf16 v[236:239], a[100:103], a[92:95], v[236:239]
v_mfma_f32_16x16x32_bf16 v[240:243], a[104:107], a[92:95], v[240:243]
v_mfma_f32_16x16x32_bf16 v[244:247], a[108:111], a[92:95], v[244:247]
buffer_load_dwordx4 v3, s[4:7], s66 offen offset:3072 lds
v_mfma_f32_16x16x32_bf16 v[248:251], a[92:95], a[112:115], v[248:251]
v_mfma_f32_16x16x32_bf16 v[252:255], a[92:95], a[116:119], v[252:255]
s_add_u32 s42, s42, 1
s_cmp_lt_u32 s42, 6
s_cbranch_scc1 .LB0_loop
.Ltail_B0:
s_waitcnt lgkmcnt(0)
v_mfma_f32_16x16x32_bf16 v[64:67], a[32:35], a[0:3], v[64:67]
ds_read_b128 a[64:67], v7 offset:0
v_mfma_f32_16x16x32_bf16 v[68:71], a[36:39], a[0:3], v[68:71]
s_add_u32 m0, s40, 4096
s_nop 0
buffer_load_dwordx4 v2, s[4:7], s67 offen lds
v_and_b32 v13, 15, v0
v_lshrrev_b32 v14, 4, v0
v_mfma_f32_16x16x32_bf16 v[72:75], a[40:43], a[0:3], v[72:75]
ds_read_b64_tr_b16 a[96:97], v8 offset:28672
v_mfma_f32_16x16x32_bf16 v[76:79], a[44:47], a[0:3], v[76:79]
s_and_b32 s24, s46, 1
s_lshr_b32 s25, s46, 1
v_mfma_f32_16x16x32_bf16 v[80:83], a[0:3], a[48:51], v[80:83]
ds_read_b64_tr_b16 a[98:99], v8 offset:29184
v_mfma_f32_16x16x32_bf16 v[84:87], a[0:3], a[52:55], v[84:87]
buffer_load_dwordx4 v3, s[4:7], s68 offen offset:1024 lds
s_lshl_b32 s26, s24, 15
s_lshl_b32 s27, s25, 13
v_mfma_f32_16x16x32_bf16 v[88:91], a[32:35], a[4:7], v[88:91]
ds_read_b64_tr_b16 a[100:101], v9 offset:28672
v_mfma_f32_16x16x32_bf16 v[92:95], a[36:39], a[4:7], v[92:95]
v_add_u32 v2, 0x80, v2
s_add_u32 s26, s26, s27
s_add_u32 s26, s26, 16384
v_mfma_f32_16x16x32_bf16 v[96:99], a[40:43], a[4:7], v[96:99]
ds_read_b64_tr_b16 a[102:103], v9 offset:29184
v_mfma_f32_16x16x32_bf16 v[100:103], a[44:47], a[4:7], v[100:103]
v_lshrrev_b32 v16, 1, v14
v_lshlrev_b32 v16, 9, v16
v_mfma_f32_16x16x32_bf16 v[104:107], a[4:7], a[48:51], v[104:107]
ds_read_b64_tr_b16 a[104:105], v8 offset:36864
v_mfma_f32_16x16x32_bf16 v[108:111], a[4:7], a[52:55], v[108:111]
v_add_u32 v3, 0x80, v3
v_lshlrev_b32 v17, 4, v13
v_add_u32 v16, v16, v17
v_mfma_f32_16x16x32_bf16 v[112:115], a[32:35], a[8:11], v[112:115]
ds_read_b64_tr_b16 a[106:107], v8 offset:37376
v_mfma_f32_16x16x32_bf16 v[116:119], a[36:39], a[8:11], v[116:119]
v_and_b32 v18, 1, v14
v_lshlrev_b32 v18, 10, v18
v_mfma_f32_16x16x32_bf16 v[120:123], a[40:43], a[8:11], v[120:123]
ds_read_b64_tr_b16 a[108:109], v9 offset:36864
v_mfma_f32_16x16x32_bf16 v[124:127], a[44:47], a[8:11], v[124:127]
s_mov_b32 s16, s87
v_add_u32 v16, v16, v18
v_add_u32 v24, s26, v16
v_mfma_f32_16x16x32_bf16 v[128:131], a[8:11], a[48:51], v[128:131]
ds_read_b64_tr_b16 a[110:111], v9 offset:37376
v_mfma_f32_16x16x32_bf16 v[132:135], a[8:11], a[52:55], v[132:135]
s_lshl_b32 s28, s24, 14
s_add_u32 s28, s28, s27
v_mfma_f32_16x16x32_bf16 v[136:139], a[32:35], a[12:15], v[136:139]
ds_read_b64_tr_b16 a[112:113], v8 offset:45056
v_mfma_f32_16x16x32_bf16 v[140:143], a[36:39], a[12:15], v[140:143]
s_mov_b32 s87, s88
v_add_u32 v19, s28, v16
s_add_u32 s28, s28, 131072
v_mfma_f32_16x16x32_bf16 v[144:147], a[40:43], a[12:15], v[144:147]
ds_read_b64_tr_b16 a[114:115], v8 offset:45568
v_mfma_f32_16x16x32_bf16 v[148:151], a[44:47], a[12:15], v[148:151]
v_add_u32 v26, s28, v16
v_and_b32 v16, 1, v14
v_mfma_f32_16x16x32_bf16 v[152:155], a[12:15], a[48:51], v[152:155]
ds_read_b64_tr_b16 a[116:117], v9 offset:45056
v_mfma_f32_16x16x32_bf16 v[156:159], a[12:15], a[52:55], v[156:159]
s_mov_b32 s88, s89
v_lshlrev_b32 v16, 9, v16
v_add_u32 v16, v16, v17
v_mfma_f32_16x16x32_bf16 v[160:163], a[32:35], a[16:19], v[160:163]
ds_read_b64_tr_b16 a[118:119], v9 offset:45568
v_mfma_f32_16x16x32_bf16 v[164:167], a[36:39], a[16:19], v[164:167]
v_lshrrev_b32 v18, 1, v14
v_lshlrev_b32 v18, 8, v18
v_mfma_f32_16x16x32_bf16 v[168:171], a[40:43], a[16:19], v[168:171]
ds_read_b128 a[68:71], v7 offset:2048
v_mfma_f32_16x16x32_bf16 v[172:175], a[44:47], a[16:19], v[172:175]
s_mov_b32 s89, s16
v_add_u32 v16, v16, v18
s_add_u32 s26, s26, 65536
v_mfma_f32_16x16x32_bf16 v[176:179], a[16:19], a[48:51], v[176:179]
ds_read_b128 a[72:75], v7 offset:4096
v_mfma_f32_16x16x32_bf16 v[180:183], a[16:19], a[52:55], v[180:183]
v_add_u32 v25, s26, v16
s_sub_u32 s28, s28, 98304
v_mfma_f32_16x16x32_bf16 v[184:187], a[32:35], a[20:23], v[184:187]
ds_read_b128 a[76:79], v7 offset:6144
v_mfma_f32_16x16x32_bf16 v[188:191], a[36:39], a[20:23], v[188:191]
s_mov_b32 s40, s87
v_add_u32 v1, s28, v16
v_accvgpr_write_b32 a250, v19
v_mfma_f32_16x16x32_bf16 v[192:195], a[40:43], a[20:23], v[192:195]
ds_read_b128 a[80:83], v7 offset:8192
v_mfma_f32_16x16x32_bf16 v[196:199], a[44:47], a[20:23], v[196:199]
v_accvgpr_write_b32 a251, v1
v_lshlrev_b32 v27, 4, v0
v_mfma_f32_16x16x32_bf16 v[200:203], a[20:23], a[48:51], v[200:203]
ds_read_b128 a[84:87], v7 offset:10240
v_mfma_f32_16x16x32_bf16 v[204:207], a[20:23], a[52:55], v[204:207]
s_lshl_b32 s26, s24, 15
s_lshl_b32 s27, s25, 11
v_mfma_f32_16x16x32_bf16 v[208:211], a[32:35], a[24:27], v[208:211]
ds_read_b128 a[88:91], v7 offset:12288
v_mfma_f32_16x16x32_bf16 v[212:215], a[36:39], a[24:27], v[212:215]
s_add_u32 s26, s26, s27
v_add_u32 v28, s26, v27
v_mfma_f32_16x16x32_bf16 v[216:219], a[40:43], a[24:27], v[216:219]
ds_read_b128 a[92:95], v7 offset:14336
v_mfma_f32_16x16x32_bf16 v[220:223], a[44:47], a[24:27], v[220:223]
v_add_u32 v29, 65536, v28
s_lshl_b32 s26, s24, 14
v_mfma_f32_16x16x32_bf16 v[224:227], a[24:27], a[48:51], v[224:227]
v_add_u32 v7, s92, v7
s_add_u32 s26, s26, s27
v_mfma_f32_16x16x32_bf16 v[228:231], a[24:27], a[52:55], v[228:231]
v_add_u32 v6, s92, v6
s_add_u32 s26, s26, 131072
v_add_u32 v31, s26, v27
v_mfma_f32_16x16x32_bf16 v[232:235], a[32:35], a[28:31], v[232:235]
s_mov_b32 s17, s92
v_bfe_u32 v16, v0, 4, 1
v_mfma_f32_16x16x32_bf16 v[236:239], a[36:39], a[28:31], v[236:239]
s_mov_b32 s92, s93
v_lshlrev_b32 v16, 15, v16
v_lshrrev_b32 v17, 5, v0
v_mfma_f32_16x16x32_bf16 v[240:243], a[40:43], a[28:31], v[240:243]
s_mov_b32 s93, s94
v_lshlrev_b32 v18, 8, v17
v_mfma_f32_16x16x32_bf16 v[244:247], a[44:47], a[28:31], v[244:247]
s_mov_b32 s94, s17
v_add_u32 v16, v16, v18
v_and_b32 v18, 15, v0
v_mfma_f32_16x16x32_bf16 v[248:251], a[28:31], a[48:51], v[248:251]
v_lshlrev_b32 v18, 4, v18
v_mfma_f32_16x16x32_bf16 v[252:255], a[28:31], a[52:55], v[252:255]
v_add_u32 v30, v16, v18
v_and_b32 v16, 31, v0
s_waitcnt lgkmcnt(0)
v_mfma_f32_16x16x32_bf16 v[64:67], a[96:99], a[64:67], v[64:67]
s_waitcnt vmcnt(6)
s_barrier
v_mfma_f32_16x16x32_bf16 v[68:71], a[100:103], a[64:67], v[68:71]
s_add_u32 m0, s41, 122880
s_nop 0
buffer_load_dwordx4 v4, s[8:11], 0 offen lds
v_lshlrev_b32 v17, 2, v17
v_sub_u32 v15, v16, v17
v_mfma_f32_16x16x32_bf16 v[72:75], a[104:107], a[64:67], v[72:75]
ds_read_b128 a[0:3], v6 offset:0
v_mfma_f32_16x16x32_bf16 v[76:79], a[108:111], a[64:67], v[76:79]
v_mov_b32 v13, 0xffff
v_mov_b32 v14, 0xffff0000
v_mfma_f32_16x16x32_bf16 v[80:83], a[64:67], a[112:115], v[80:83]
ds_read_b64_tr_b16 a[32:33], v8 offset:0
v_mfma_f32_16x16x32_bf16 v[84:87], a[64:67], a[116:119], v[84:87]
buffer_load_dwordx4 v5, s[8:11], s80 offen offset:1024 lds
v_cmp_le_i32 vcc, 0, v15
v_cmp_le_i32 s[28:29], 1, v15
v_mfma_f32_16x16x32_bf16 v[88:91], a[96:99], a[68:71], v[88:91]
ds_read_b64_tr_b16 a[34:35], v8 offset:512
v_mfma_f32_16x16x32_bf16 v[92:95], a[100:103], a[68:71], v[92:95]
s_nop 0
v_cndmask_b32 v1, 0, v13, vcc
v_mfma_f32_16x16x32_bf16 v[96:99], a[104:107], a[68:71], v[96:99]
ds_read_b64_tr_b16 a[36:37], v9 offset:0
v_mfma_f32_16x16x32_bf16 v[100:103], a[108:111], a[68:71], v[100:103]
buffer_load_dwordx4 v4, s[8:11], s81 offen offset:2048 lds
v_cndmask_b32 v16, 0, v14, s[28:29]
v_or_b32 v16, v16, v1
v_mfma_f32_16x16x32_bf16 v[104:107], a[68:71], a[112:115], v[104:107]
ds_read_b64_tr_b16 a[38:39], v9 offset:512
v_mfma_f32_16x16x32_bf16 v[108:111], a[68:71], a[116:119], v[108:111]
v_cmp_le_i32 vcc, 2, v15
v_cmp_le_i32 s[28:29], 3, v15
v_mfma_f32_16x16x32_bf16 v[112:115], a[96:99], a[72:75], v[112:115]
ds_read_b64_tr_b16 a[40:41], v8 offset:8192
v_mfma_f32_16x16x32_bf16 v[116:119], a[100:103], a[72:75], v[116:119]
buffer_load_dwordx4 v5, s[8:11], s82 offen offset:3072 lds
s_nop 0
v_cndmask_b32 v1, 0, v13, vcc
v_mfma_f32_16x16x32_bf16 v[120:123], a[104:107], a[72:75], v[120:123]
ds_read_b64_tr_b16 a[42:43], v8 offset:8704
v_mfma_f32_16x16x32_bf16 v[124:127], a[108:111], a[72:75], v[124:127]
v_cndmask_b32 v17, 0, v14, s[28:29]
v_or_b32 v17, v17, v1
v_mfma_f32_16x16x32_bf16 v[128:131], a[72:75], a[112:115], v[128:131]
ds_read_b64_tr_b16 a[44:45], v9 offset:8192
v_mfma_f32_16x16x32_bf16 v[132:135], a[72:75], a[116:119], v[132:135]
s_add_u32 m0, s41, 126976
s_nop 0
buffer_load_dwordx4 v4, s[8:11], s83 offen lds
v_cmp_le_i32 vcc, 8, v15
v_cmp_le_i32 s[28:29], 9, v15
v_mfma_f32_16x16x32_bf16 v[136:139], a[96:99], a[76:79], v[136:139]
ds_read_b64_tr_b16 a[46:47], v9 offset:8704
v_mfma_f32_16x16x32_bf16 v[140:143], a[100:103], a[76:79], v[140:143]
s_nop 0
v_cndmask_b32 v1, 0, v13, vcc
v_mfma_f32_16x16x32_bf16 v[144:147], a[104:107], a[76:79], v[144:147]
ds_read_b64_tr_b16 a[48:49], v8 offset:16384
v_mfma_f32_16x16x32_bf16 v[148:151], a[108:111], a[76:79], v[148:151]
buffer_load_dwordx4 v5, s[8:11], s84 offen offset:1024 lds
v_cndmask_b32 v18, 0, v14, s[28:29]
v_or_b32 v18, v18, v1
v_mfma_f32_16x16x32_bf16 v[152:155], a[76:79], a[112:115], v[152:155]
ds_read_b64_tr_b16 a[50:51], v8 offset:16896
v_mfma_f32_16x16x32_bf16 v[156:159], a[76:79], a[116:119], v[156:159]
v_cmp_le_i32 vcc, 10, v15
v_cmp_le_i32 s[28:29], 11, v15
v_mfma_f32_16x16x32_bf16 v[160:163], a[96:99], a[80:83], v[160:163]
ds_read_b64_tr_b16 a[52:53], v9 offset:16384
v_mfma_f32_16x16x32_bf16 v[164:167], a[100:103], a[80:83], v[164:167]
buffer_load_dwordx4 v4, s[8:11], s85 offen offset:2048 lds
s_nop 0
v_cndmask_b32 v1, 0, v13, vcc
v_mfma_f32_16x16x32_bf16 v[168:171], a[104:107], a[80:83], v[168:171]
ds_read_b64_tr_b16 a[54:55], v9 offset:16896
v_mfma_f32_16x16x32_bf16 v[172:175], a[108:111], a[80:83], v[172:175]
v_cndmask_b32 v19, 0, v14, s[28:29]
v_or_b32 v19, v19, v1
v_mfma_f32_16x16x32_bf16 v[176:179], a[80:83], a[112:115], v[176:179]
ds_read_b128 a[4:7], v6 offset:2048
v_mfma_f32_16x16x32_bf16 v[180:183], a[80:83], a[116:119], v[180:183]
buffer_load_dwordx4 v5, s[8:11], s86 offen offset:3072 lds
v_cmp_le_i32 vcc, 16, v15
v_cmp_le_i32 s[28:29], 17, v15
v_mfma_f32_16x16x32_bf16 v[184:187], a[96:99], a[84:87], v[184:187]
ds_read_b128 a[8:11], v6 offset:4096
v_mfma_f32_16x16x32_bf16 v[188:191], a[100:103], a[84:87], v[188:191]
s_add_u32 s8, s8, 393216
s_addc_u32 s9, s9, 0
s_nop 0
v_cndmask_b32 v1, 0, v13, vcc
v_mfma_f32_16x16x32_bf16 v[192:195], a[104:107], a[84:87], v[192:195]
ds_read_b128 a[12:15], v6 offset:6144
v_mfma_f32_16x16x32_bf16 v[196:199], a[108:111], a[84:87], v[196:199]
v_cndmask_b32 v20, 0, v14, s[28:29]
v_or_b32 v20, v20, v1
v_mfma_f32_16x16x32_bf16 v[200:203], a[84:87], a[112:115], v[200:203]
ds_read_b128 a[16:19], v6 offset:8192
v_mfma_f32_16x16x32_bf16 v[204:207], a[84:87], a[116:119], v[204:207]
s_sub_u32 s10, s10, 393216
v_cmp_le_i32 vcc, 18, v15
v_cmp_le_i32 s[28:29], 19, v15
v_mfma_f32_16x16x32_bf16 v[208:211], a[96:99], a[88:91], v[208:211]
ds_read_b128 a[20:23], v6 offset:10240
v_mfma_f32_16x16x32_bf16 v[212:215], a[100:103], a[88:91], v[212:215]
s_nop 0
v_cndmask_b32 v1, 0, v13, vcc
v_mfma_f32_16x16x32_bf16 v[216:219], a[104:107], a[88:91], v[216:219]
ds_read_b128 a[24:27], v6 offset:12288
v_mfma_f32_16x16x32_bf16 v[220:223], a[108:111], a[88:91], v[220:223]
v_cndmask_b32 v21, 0, v14, s[28:29]
v_or_b32 v21, v21, v1
v_mfma_f32_16x16x32_bf16 v[224:227], a[88:91], a[112:115], v[224:227]
ds_read_b128 a[28:31], v6 offset:14336
v_cmp_le_i32 vcc, 24, v15
v_mfma_f32_16x16x32_bf16 v[228:231], a[88:91], a[116:119], v[228:231]
v_cmp_le_i32 s[28:29], 25, v15
s_nop 0
v_mfma_f32_16x16x32_bf16 v[232:235], a[96:99], a[92:95], v[232:235]
v_cndmask_b32 v1, 0, v13, vcc
v_mfma_f32_16x16x32_bf16 v[236:239], a[100:103], a[92:95], v[236:239]
v_cndmask_b32 v22, 0, v14, s[28:29]
v_or_b32 v22, v22, v1
v_mfma_f32_16x16x32_bf16 v[240:243], a[104:107], a[92:95], v[240:243]
v_cmp_le_i32 vcc, 26, v15
v_mfma_f32_16x16x32_bf16 v[244:247], a[108:111], a[92:95], v[244:247]
v_cmp_le_i32 s[28:29], 27, v15
s_nop 0
v_mfma_f32_16x16x32_bf16 v[248:251], a[92:95], a[112:115], v[248:251]
v_cndmask_b32 v1, 0, v13, vcc
v_mfma_f32_16x16x32_bf16 v[252:255], a[92:95], a[116:119], v[252:255]
v_cndmask_b32 v23, 0, v14, s[28:29]
v_or_b32 v23, v23, v1
s_waitcnt lgkmcnt(0)
v_mfma_f32_16x16x32_bf16 v[64:67], a[32:35], a[0:3], v[64:67]
ds_read_b128 a[64:67], v7 offset:0
v_mfma_f32_16x16x32_bf16 v[68:71], a[36:39], a[0:3], v[68:71]
s_cmp_eq_u32 s44, 0
s_cselect_b32 s24, 4048155338, 0
s_cmp_lt_u32 s46, 2
s_cselect_b32 s25, s24, 0
v_mfma_f32_16x16x32_bf16 v[72:75], a[40:43], a[0:3], v[72:75]
ds_read_b64_tr_b16 a[96:97], v8 offset:4096
v_mfma_f32_16x16x32_bf16 v[76:79], a[44:47], a[0:3], v[76:79]
v_mov_b32 v32, s25
v_mov_b32 v48, s24
v_mfma_f32_16x16x32_bf16 v[80:83], a[0:3], a[48:51], v[80:83]
ds_read_b64_tr_b16 a[98:99], v8 offset:4608
v_mfma_f32_16x16x32_bf16 v[84:87], a[0:3], a[52:55], v[84:87]
v_mov_b32 v33, s25
v_mov_b32 v49, s24
v_mfma_f32_16x16x32_bf16 v[88:91], a[32:35], a[4:7], v[88:91]
ds_read_b64_tr_b16 a[100:101], v9 offset:4096
v_mfma_f32_16x16x32_bf16 v[92:95], a[36:39], a[4:7], v[92:95]
v_mov_b32 v34, s25
v_mov_b32 v50, s24
v_mfma_f32_16x16x32_bf16 v[96:99], a[40:43], a[4:7], v[96:99]
ds_read_b64_tr_b16 a[102:103], v9 offset:4608
v_mfma_f32_16x16x32_bf16 v[100:103], a[44:47], a[4:7], v[100:103]
v_mov_b32 v35, s25
v_mov_b32 v51, s24
v_mfma_f32_16x16x32_bf16 v[104:107], a[4:7], a[48:51], v[104:107]
ds_read_b64_tr_b16 a[104:105], v8 offset:12288
v_mfma_f32_16x16x32_bf16 v[108:111], a[4:7], a[52:55], v[108:111]
v_mov_b32 v36, s25
v_mov_b32 v52, s24
v_mfma_f32_16x16x32_bf16 v[112:115], a[32:35], a[8:11], v[112:115]
ds_read_b64_tr_b16 a[106:107], v8 offset:12800
v_mfma_f32_16x16x32_bf16 v[116:119], a[36:39], a[8:11], v[116:119]
v_mov_b32 v37, s25
v_mov_b32 v53, s24
v_mfma_f32_16x16x32_bf16 v[120:123], a[40:43], a[8:11], v[120:123]
ds_read_b64_tr_b16 a[108:109], v9 offset:12288
v_mfma_f32_16x16x32_bf16 v[124:127], a[44:47], a[8:11], v[124:127]
v_mov_b32 v38, s25
v_mov_b32 v54, s24
v_mfma_f32_16x16x32_bf16 v[128:131], a[8:11], a[48:51], v[128:131]
ds_read_b64_tr_b16 a[110:111], v9 offset:12800
v_mfma_f32_16x16x32_bf16 v[132:135], a[8:11], a[52:55], v[132:135]
v_mov_b32 v39, s25
v_mov_b32 v55, s24
v_mfma_f32_16x16x32_bf16 v[136:139], a[32:35], a[12:15], v[136:139]
ds_read_b64_tr_b16 a[112:113], v8 offset:20480
v_mfma_f32_16x16x32_bf16 v[140:143], a[36:39], a[12:15], v[140:143]
v_mov_b32 v40, s25
v_mov_b32 v56, s24
v_mfma_f32_16x16x32_bf16 v[144:147], a[40:43], a[12:15], v[144:147]
ds_read_b64_tr_b16 a[114:115], v8 offset:20992
v_mfma_f32_16x16x32_bf16 v[148:151], a[44:47], a[12:15], v[148:151]
v_mov_b32 v41, s25
v_mov_b32 v57, s24
v_mfma_f32_16x16x32_bf16 v[152:155], a[12:15], a[48:51], v[152:155]
ds_read_b64_tr_b16 a[116:117], v9 offset:20480
v_mfma_f32_16x16x32_bf16 v[156:159], a[12:15], a[52:55], v[156:159]
v_mov_b32 v42, s25
v_mov_b32 v58, s24
v_mfma_f32_16x16x32_bf16 v[160:163], a[32:35], a[16:19], v[160:163]
ds_read_b64_tr_b16 a[118:119], v9 offset:20992
v_mfma_f32_16x16x32_bf16 v[164:167], a[36:39], a[16:19], v[164:167]
v_mov_b32 v43, s25
v_mov_b32 v59, s24
v_mfma_f32_16x16x32_bf16 v[168:171], a[40:43], a[16:19], v[168:171]
ds_read_b128 a[68:71], v7 offset:2048
v_mfma_f32_16x16x32_bf16 v[172:175], a[44:47], a[16:19], v[172:175]
v_mov_b32 v44, s25
v_mov_b32 v60, s24
v_mfma_f32_16x16x32_bf16 v[176:179], a[16:19], a[48:51], v[176:179]
ds_read_b128 a[72:75], v7 offset:4096
v_mfma_f32_16x16x32_bf16 v[180:183], a[16:19], a[52:55], v[180:183]
v_mov_b32 v45, s25
v_mov_b32 v61, s24
v_mfma_f32_16x16x32_bf16 v[184:187], a[32:35], a[20:23], v[184:187]
ds_read_b128 a[76:79], v7 offset:6144
v_mfma_f32_16x16x32_bf16 v[188:191], a[36:39], a[20:23], v[188:191]
v_mov_b32 v46, s25
v_mov_b32 v62, s24
v_mfma_f32_16x16x32_bf16 v[192:195], a[40:43], a[20:23], v[192:195]
ds_read_b128 a[80:83], v7 offset:8192
v_mfma_f32_16x16x32_bf16 v[196:199], a[44:47], a[20:23], v[196:199]
v_mov_b32 v47, s25
v_mov_b32 v63, s24
v_mfma_f32_16x16x32_bf16 v[200:203], a[20:23], a[48:51], v[200:203]
ds_read_b128 a[84:87], v7 offset:10240
v_mfma_f32_16x16x32_bf16 v[204:207], a[20:23], a[52:55], v[204:207]
s_lshl_b32 s36, s44, 4
s_add_u32 s36, s36, s45
v_mfma_f32_16x16x32_bf16 v[208:211], a[32:35], a[24:27], v[208:211]
ds_read_b128 a[88:91], v7 offset:12288
v_mfma_f32_16x16x32_bf16 v[212:215], a[36:39], a[24:27], v[212:215]
s_lshl_b32 s36, s36, 16
s_add_u32 s36, s36, 16777216
v_mfma_f32_16x16x32_bf16 v[216:219], a[40:43], a[24:27], v[216:219]
ds_read_b128 a[92:95], v7 offset:14336
v_mfma_f32_16x16x32_bf16 v[220:223], a[44:47], a[24:27], v[220:223]
v_accvgpr_read_b32 v2, a250
v_accvgpr_read_b32 v3, a251
v_mfma_f32_16x16x32_bf16 v[224:227], a[24:27], a[48:51], v[224:227]
v_add_u32 v7, s92, v7
s_mov_b32 s22, 1048744942
v_mfma_f32_16x16x32_bf16 v[228:231], a[24:27], a[52:55], v[228:231]
v_add_u32 v6, s92, v6
s_mov_b32 s23, 1048744942
s_mov_b32 s24, s12
v_mfma_f32_16x16x32_bf16 v[232:235], a[32:35], a[28:31], v[232:235]
s_mov_b32 s17, s92
s_mov_b32 s25, s13
v_mfma_f32_16x16x32_bf16 v[236:239], a[36:39], a[28:31], v[236:239]
s_mov_b32 s92, s93
s_mov_b32 s27, 0x20000
s_cmp_ge_u32 s46, 2
s_cselect_b32 s26, 0x10000000, 0
v_mfma_f32_16x16x32_bf16 v[240:243], a[40:43], a[28:31], v[240:243]
s_mov_b32 s93, s94
s_add_u32 s4, s36, 0
v_mfma_f32_16x16x32_bf16 v[244:247], a[44:47], a[28:31], v[244:247]
s_mov_b32 s94, s17
s_add_u32 s5, s36, 2048
s_add_u32 s6, s36, 4096
v_mfma_f32_16x16x32_bf16 v[248:251], a[28:31], a[48:51], v[248:251]
s_add_u32 s7, s36, 6144
v_mfma_f32_16x16x32_bf16 v[252:255], a[28:31], a[52:55], v[252:255]
s_waitcnt lgkmcnt(0)
v_mfma_f32_16x16x32_bf16 v[64:67], a[96:99], a[64:67], v[64:67]
s_waitcnt vmcnt(0)
s_barrier
v_mfma_f32_16x16x32_bf16 v[68:71], a[100:103], a[64:67], v[68:71]
v_mfma_f32_16x16x32_bf16 v[72:75], a[104:107], a[64:67], v[72:75]
ds_read_b128 a[0:3], v6 offset:0
v_mfma_f32_16x16x32_bf16 v[76:79], a[108:111], a[64:67], v[76:79]
v_mfma_f32_16x16x32_bf16 v[80:83], a[64:67], a[112:115], v[80:83]
ds_read_b64_tr_b16 a[32:33], v8 offset:24576
v_mfma_f32_16x16x32_bf16 v[84:87], a[64:67], a[116:119], v[84:87]
v_mfma_f32_16x16x32_bf16 v[88:91], a[96:99], a[68:71], v[88:91]
ds_read_b64_tr_b16 a[34:35], v8 offset:25088
v_mfma_f32_16x16x32_bf16 v[92:95], a[100:103], a[68:71], v[92:95]
v_mfma_f32_16x16x32_bf16 v[96:99], a[104:107], a[68:71], v[96:99]
ds_read_b64_tr_b16 a[36:37], v9 offset:24576
v_mfma_f32_16x16x32_bf16 v[100:103], a[108:111], a[68:71], v[100:103]
v_mfma_f32_16x16x32_bf16 v[104:107], a[68:71], a[112:115], v[104:107]
ds_read_b64_tr_b16 a[38:39], v9 offset:25088
v_mfma_f32_16x16x32_bf16 v[108:111], a[68:71], a[116:119], v[108:111]
v_mfma_f32_16x16x32_bf16 v[112:115], a[96:99], a[72:75], v[112:115]
ds_read_b64_tr_b16 a[40:41], v8 offset:32768
v_mfma_f32_16x16x32_bf16 v[116:119], a[100:103], a[72:75], v[116:119]
v_mfma_f32_16x16x32_bf16 v[120:123], a[104:107], a[72:75], v[120:123]
ds_read_b64_tr_b16 a[42:43], v8 offset:33280
v_mfma_f32_16x16x32_bf16 v[124:127], a[108:111], a[72:75], v[124:127]
v_mfma_f32_16x16x32_bf16 v[128:131], a[72:75], a[112:115], v[128:131]
ds_read_b64_tr_b16 a[44:45], v9 offset:32768
v_mfma_f32_16x16x32_bf16 v[132:135], a[72:75], a[116:119], v[132:135]
v_mfma_f32_16x16x32_bf16 v[136:139], a[96:99], a[76:79], v[136:139]
ds_read_b64_tr_b16 a[46:47], v9 offset:33280
v_mfma_f32_16x16x32_bf16 v[140:143], a[100:103], a[76:79], v[140:143]
v_mfma_f32_16x16x32_bf16 v[144:147], a[104:107], a[76:79], v[144:147]
ds_read_b64_tr_b16 a[48:49], v8 offset:40960
v_mfma_f32_16x16x32_bf16 v[148:151], a[108:111], a[76:79], v[148:151]
v_mfma_f32_16x16x32_bf16 v[152:155], a[76:79], a[112:115], v[152:155]
ds_read_b64_tr_b16 a[50:51], v8 offset:41472
v_mfma_f32_16x16x32_bf16 v[156:159], a[76:79], a[116:119], v[156:159]
v_mfma_f32_16x16x32_bf16 v[160:163], a[96:99], a[80:83], v[160:163]
ds_read_b64_tr_b16 a[52:53], v9 offset:40960
v_mfma_f32_16x16x32_bf16 v[164:167], a[100:103], a[80:83], v[164:167]
v_mfma_f32_16x16x32_bf16 v[168:171], a[104:107], a[80:83], v[168:171]
ds_read_b64_tr_b16 a[54:55], v9 offset:41472
v_mfma_f32_16x16x32_bf16 v[172:175], a[108:111], a[80:83], v[172:175]
v_mfma_f32_16x16x32_bf16 v[176:179], a[80:83], a[112:115], v[176:179]
ds_read_b128 a[4:7], v6 offset:2048
v_mfma_f32_16x16x32_bf16 v[180:183], a[80:83], a[116:119], v[180:183]
v_mfma_f32_16x16x32_bf16 v[184:187], a[96:99], a[84:87], v[184:187]
ds_read_b128 a[8:11], v6 offset:4096
v_mfma_f32_16x16x32_bf16 v[188:191], a[100:103], a[84:87], v[188:191]
v_mfma_f32_16x16x32_bf16 v[192:195], a[104:107], a[84:87], v[192:195]
ds_read_b128 a[12:15], v6 offset:6144
v_mfma_f32_16x16x32_bf16 v[196:199], a[108:111], a[84:87], v[196:199]
v_mfma_f32_16x16x32_bf16 v[200:203], a[84:87], a[112:115], v[200:203]
ds_read_b128 a[16:19], v6 offset:8192
v_mfma_f32_16x16x32_bf16 v[204:207], a[84:87], a[116:119], v[204:207]
v_mfma_f32_16x16x32_bf16 v[208:211], a[96:99], a[88:91], v[208:211]
ds_read_b128 a[20:23], v6 offset:10240
v_mfma_f32_16x16x32_bf16 v[212:215], a[100:103], a[88:91], v[212:215]
v_mfma_f32_16x16x32_bf16 v[216:219], a[104:107], a[88:91], v[216:219]
ds_read_b128 a[24:27], v6 offset:12288
v_mfma_f32_16x16x32_bf16 v[220:223], a[108:111], a[88:91], v[220:223]
v_mfma_f32_16x16x32_bf16 v[224:227], a[88:91], a[112:115], v[224:227]
ds_read_b128 a[28:31], v6 offset:14336
v_mfma_f32_16x16x32_bf16 v[228:231], a[88:91], a[116:119], v[228:231]
v_mfma_f32_16x16x32_bf16 v[232:235], a[96:99], a[92:95], v[232:235]
v_mfma_f32_16x16x32_bf16 v[236:239], a[100:103], a[92:95], v[236:239]
v_mfma_f32_16x16x32_bf16 v[240:243], a[104:107], a[92:95], v[240:243]
v_mfma_f32_16x16x32_bf16 v[244:247], a[108:111], a[92:95], v[244:247]
v_mfma_f32_16x16x32_bf16 v[248:251], a[92:95], a[112:115], v[248:251]
v_mfma_f32_16x16x32_bf16 v[252:255], a[92:95], a[116:119], v[252:255]
s_waitcnt lgkmcnt(0)
v_mfma_f32_16x16x32_bf16 v[64:67], a[32:35], a[0:3], v[64:67]
ds_read_b128 a[64:67], v7 offset:0
v_mfma_f32_16x16x32_bf16 v[68:71], a[36:39], a[0:3], v[68:71]
v_mfma_f32_16x16x32_bf16 v[72:75], a[40:43], a[0:3], v[72:75]
ds_read_b64_tr_b16 a[96:97], v8 offset:28672
v_mfma_f32_16x16x32_bf16 v[76:79], a[44:47], a[0:3], v[76:79]
v_mfma_f32_16x16x32_bf16 v[80:83], a[0:3], a[48:51], v[80:83]
ds_read_b64_tr_b16 a[98:99], v8 offset:29184
v_mfma_f32_16x16x32_bf16 v[84:87], a[0:3], a[52:55], v[84:87]
v_mfma_f32_16x16x32_bf16 v[88:91], a[32:35], a[4:7], v[88:91]
ds_read_b64_tr_b16 a[100:101], v9 offset:28672
v_mfma_f32_16x16x32_bf16 v[92:95], a[36:39], a[4:7], v[92:95]
v_mfma_f32_16x16x32_bf16 v[96:99], a[40:43], a[4:7], v[96:99]
ds_read_b64_tr_b16 a[102:103], v9 offset:29184
v_mfma_f32_16x16x32_bf16 v[100:103], a[44:47], a[4:7], v[100:103]
v_mfma_f32_16x16x32_bf16 v[104:107], a[4:7], a[48:51], v[104:107]
ds_read_b64_tr_b16 a[104:105], v8 offset:36864
v_mfma_f32_16x16x32_bf16 v[108:111], a[4:7], a[52:55], v[108:111]
v_mfma_f32_16x16x32_bf16 v[112:115], a[32:35], a[8:11], v[112:115]
ds_read_b64_tr_b16 a[106:107], v8 offset:37376
v_mfma_f32_16x16x32_bf16 v[116:119], a[36:39], a[8:11], v[116:119]
v_mfma_f32_16x16x32_bf16 v[120:123], a[40:43], a[8:11], v[120:123]
ds_read_b64_tr_b16 a[108:109], v9 offset:36864
v_mfma_f32_16x16x32_bf16 v[124:127], a[44:47], a[8:11], v[124:127]
v_mfma_f32_16x16x32_bf16 v[128:131], a[8:11], a[48:51], v[128:131]
ds_read_b64_tr_b16 a[110:111], v9 offset:37376
v_mfma_f32_16x16x32_bf16 v[132:135], a[8:11], a[52:55], v[132:135]
v_mfma_f32_16x16x32_bf16 v[136:139], a[32:35], a[12:15], v[136:139]
ds_read_b64_tr_b16 a[112:113], v8 offset:45056
v_mfma_f32_16x16x32_bf16 v[140:143], a[36:39], a[12:15], v[140:143]
v_mfma_f32_16x16x32_bf16 v[144:147], a[40:43], a[12:15], v[144:147]
ds_read_b64_tr_b16 a[114:115], v8 offset:45568
v_mfma_f32_16x16x32_bf16 v[148:151], a[44:47], a[12:15], v[148:151]
v_mfma_f32_16x16x32_bf16 v[152:155], a[12:15], a[48:51], v[152:155]
ds_read_b64_tr_b16 a[116:117], v9 offset:45056
v_mfma_f32_16x16x32_bf16 v[156:159], a[12:15], a[52:55], v[156:159]
v_mfma_f32_16x16x32_bf16 v[160:163], a[32:35], a[16:19], v[160:163]
ds_read_b64_tr_b16 a[118:119], v9 offset:45568
v_mfma_f32_16x16x32_bf16 v[164:167], a[36:39], a[16:19], v[164:167]
v_mfma_f32_16x16x32_bf16 v[168:171], a[40:43], a[16:19], v[168:171]
ds_read_b128 a[68:71], v7 offset:2048
v_mfma_f32_16x16x32_bf16 v[172:175], a[44:47], a[16:19], v[172:175]
v_mfma_f32_16x16x32_bf16 v[176:179], a[16:19], a[48:51], v[176:179]
ds_read_b128 a[72:75], v7 offset:4096
v_mfma_f32_16x16x32_bf16 v[180:183], a[16:19], a[52:55], v[180:183]
v_mfma_f32_16x16x32_bf16 v[184:187], a[32:35], a[20:23], v[184:187]
ds_read_b128 a[76:79], v7 offset:6144
v_mfma_f32_16x16x32_bf16 v[188:191], a[36:39], a[20:23], v[188:191]
v_mfma_f32_16x16x32_bf16 v[192:195], a[40:43], a[20:23], v[192:195]
ds_read_b128 a[80:83], v7 offset:8192
v_mfma_f32_16x16x32_bf16 v[196:199], a[44:47], a[20:23], v[196:199]
v_mfma_f32_16x16x32_bf16 v[200:203], a[20:23], a[48:51], v[200:203]
ds_read_b128 a[84:87], v7 offset:10240
v_mfma_f32_16x16x32_bf16 v[204:207], a[20:23], a[52:55], v[204:207]
v_mfma_f32_16x16x32_bf16 v[208:211], a[32:35], a[24:27], v[208:211]
ds_read_b128 a[88:91], v7 offset:12288
v_mfma_f32_16x16x32_bf16 v[212:215], a[36:39], a[24:27], v[212:215]
v_mfma_f32_16x16x32_bf16 v[216:219], a[40:43], a[24:27], v[216:219]
ds_read_b128 a[92:95], v7 offset:14336
v_mfma_f32_16x16x32_bf16 v[220:223], a[44:47], a[24:27], v[220:223]
v_mfma_f32_16x16x32_bf16 v[224:227], a[24:27], a[48:51], v[224:227]
v_add_u32 v7, s92, v7
v_mfma_f32_16x16x32_bf16 v[228:231], a[24:27], a[52:55], v[228:231]
v_add_u32 v6, s92, v6
v_mfma_f32_16x16x32_bf16 v[232:235], a[32:35], a[28:31], v[232:235]
s_mov_b32 s17, s92
v_mfma_f32_16x16x32_bf16 v[236:239], a[36:39], a[28:31], v[236:239]
s_mov_b32 s92, s93
v_mfma_f32_16x16x32_bf16 v[240:243], a[40:43], a[28:31], v[240:243]
s_mov_b32 s93, s94
v_mfma_f32_16x16x32_bf16 v[244:247], a[44:47], a[28:31], v[244:247]
s_mov_b32 s94, s17
v_mfma_f32_16x16x32_bf16 v[248:251], a[28:31], a[48:51], v[248:251]
v_mfma_f32_16x16x32_bf16 v[252:255], a[28:31], a[52:55], v[252:255]
s_waitcnt lgkmcnt(0)
v_mfma_f32_16x16x32_bf16 v[232:235], a[96:99], a[92:95], v[232:235]
s_barrier
v_mfma_f32_16x16x32_bf16 v[236:239], a[100:103], a[92:95], v[236:239]
v_mfma_f32_16x16x32_bf16 v[240:243], a[104:107], a[92:95], v[240:243]
v_mfma_f32_16x16x32_bf16 v[244:247], a[108:111], a[92:95], v[244:247]
v_mfma_f32_16x16x32_bf16 v[248:251], a[92:95], a[112:115], v[248:251]
v_mfma_f32_16x16x32_bf16 v[252:255], a[92:95], a[116:119], v[252:255]
v_mfma_f32_16x16x32_bf16 v[208:211], a[96:99], a[88:91], v[208:211]
v_mfma_f32_16x16x32_bf16 v[212:215], a[100:103], a[88:91], v[212:215]
v_mfma_f32_16x16x32_bf16 v[216:219], a[104:107], a[88:91], v[216:219]
v_mfma_f32_16x16x32_bf16 v[220:223], a[108:111], a[88:91], v[220:223]
v_mfma_f32_16x16x32_bf16 v[224:227], a[88:91], a[112:115], v[224:227]
v_mfma_f32_16x16x32_bf16 v[228:231], a[88:91], a[116:119], v[228:231]
v_mfma_f32_16x16x32_bf16 v[184:187], a[96:99], a[84:87], v[184:187]
v_cvt_pk_bf16_f32 v240, v240, v241
v_cvt_pk_bf16_f32 v241, v242, v243
v_mfma_f32_16x16x32_bf16 v[188:191], a[100:103], a[84:87], v[188:191]
v_cvt_pk_bf16_f32 v242, v244, v245
v_cvt_pk_bf16_f32 v243, v246, v247
v_mfma_f32_16x16x32_bf16 v[192:195], a[104:107], a[84:87], v[192:195]
v_cvt_pk_bf16_f32 v248, v248, v249
v_cvt_pk_bf16_f32 v249, v250, v251
v_mfma_f32_16x16x32_bf16 v[196:199], a[108:111], a[84:87], v[196:199]
v_cvt_pk_bf16_f32 v250, v252, v253
v_cvt_pk_bf16_f32 v251, v254, v255
v_mfma_f32_16x16x32_bf16 v[200:203], a[84:87], a[112:115], v[200:203]
v_permlane16_swap_b32 v240, v242
v_permlane16_swap_b32 v241, v243
v_mfma_f32_16x16x32_bf16 v[204:207], a[84:87], a[116:119], v[204:207]
buffer_store_dwordx4 v[240:243], v2, s[24:27], s7 offen offset:256 sc1
ds_write_b128 v24, v[240:243] offset:6400
v_mfma_f32_16x16x32_bf16 v[160:163], a[96:99], a[80:83], v[160:163]
v_cvt_pk_bf16_f32 v216, v216, v217
v_cvt_pk_bf16_f32 v217, v218, v219
v_mfma_f32_16x16x32_bf16 v[164:167], a[100:103], a[80:83], v[164:167]
v_cvt_pk_bf16_f32 v218, v220, v221
v_cvt_pk_bf16_f32 v219, v222, v223
v_mfma_f32_16x16x32_bf16 v[168:171], a[104:107], a[80:83], v[168:171]
v_permlane32_swap_b32 v248, v250
v_permlane32_swap_b32 v249, v251
v_mfma_f32_16x16x32_bf16 v[172:175], a[108:111], a[80:83], v[172:175]
buffer_store_dwordx4 v[248:251], v3, s[24:27], s7 offen offset:1024 sc1
ds_write_b128 v25, v[248:251] offset:7168
v_mfma_f32_16x16x32_bf16 v[176:179], a[80:83], a[112:115], v[176:179]
v_cvt_pk_bf16_f32 v224, v224, v225
v_cvt_pk_bf16_f32 v225, v226, v227
v_mfma_f32_16x16x32_bf16 v[180:183], a[80:83], a[116:119], v[180:183]
v_cvt_pk_bf16_f32 v226, v228, v229
v_cvt_pk_bf16_f32 v227, v230, v231
v_mfma_f32_16x16x32_bf16 v[136:139], a[96:99], a[76:79], v[136:139]
v_permlane16_swap_b32 v216, v218
v_permlane16_swap_b32 v217, v219
v_mfma_f32_16x16x32_bf16 v[140:143], a[100:103], a[76:79], v[140:143]
buffer_store_dwordx4 v[216:219], v2, s[24:27], s7 offen offset:0 sc1
ds_write_b128 v24, v[216:219] offset:6144
v_mfma_f32_16x16x32_bf16 v[144:147], a[104:107], a[76:79], v[144:147]
v_cvt_pk_bf16_f32 v192, v192, v193
v_cvt_pk_bf16_f32 v193, v194, v195
v_mfma_f32_16x16x32_bf16 v[148:151], a[108:111], a[76:79], v[148:151]
v_cvt_pk_bf16_f32 v194, v196, v197
v_cvt_pk_bf16_f32 v195, v198, v199
v_mfma_f32_16x16x32_bf16 v[152:155], a[76:79], a[112:115], v[152:155]
v_permlane32_swap_b32 v224, v226
v_permlane32_swap_b32 v225, v227
v_mfma_f32_16x16x32_bf16 v[156:159], a[76:79], a[116:119], v[156:159]
buffer_store_dwordx4 v[224:227], v3, s[24:27], s7 offen offset:0 sc1
ds_write_b128 v25, v[224:227] offset:6144
v_mfma_f32_16x16x32_bf16 v[112:115], a[96:99], a[72:75], v[112:115]
v_cvt_pk_bf16_f32 v200, v200, v201
v_cvt_pk_bf16_f32 v201, v202, v203
v_mfma_f32_16x16x32_bf16 v[116:119], a[100:103], a[72:75], v[116:119]
v_cvt_pk_bf16_f32 v202, v204, v205
v_cvt_pk_bf16_f32 v203, v206, v207
v_mfma_f32_16x16x32_bf16 v[120:123], a[104:107], a[72:75], v[120:123]
v_permlane16_swap_b32 v192, v194
v_permlane16_swap_b32 v193, v195
v_mfma_f32_16x16x32_bf16 v[124:127], a[108:111], a[72:75], v[124:127]
buffer_store_dwordx4 v[192:195], v2, s[24:27], s6 offen offset:256 sc1
ds_write_b128 v24, v[192:195] offset:4352
v_mfma_f32_16x16x32_bf16 v[128:131], a[72:75], a[112:115], v[128:131]
v_cvt_pk_bf16_f32 v244, v168, v169
v_cvt_pk_bf16_f32 v245, v170, v171
v_mfma_f32_16x16x32_bf16 v[132:135], a[72:75], a[116:119], v[132:135]
v_cvt_pk_bf16_f32 v246, v172, v173
v_cvt_pk_bf16_f32 v247, v174, v175
v_mfma_f32_16x16x32_bf16 v[88:91], a[96:99], a[68:71], v[88:91]
v_permlane32_swap_b32 v200, v202
v_permlane32_swap_b32 v201, v203
v_mfma_f32_16x16x32_bf16 v[92:95], a[100:103], a[68:71], v[92:95]
buffer_store_dwordx4 v[200:203], v3, s[24:27], s6 offen offset:1024 sc1
ds_write_b128 v25, v[200:203] offset:5120
v_mfma_f32_16x16x32_bf16 v[96:99], a[104:107], a[68:71], v[96:99]
v_cvt_pk_bf16_f32 v252, v176, v177
v_cvt_pk_bf16_f32 v253, v178, v179
v_mfma_f32_16x16x32_bf16 v[100:103], a[108:111], a[68:71], v[100:103]
v_cvt_pk_bf16_f32 v254, v180, v181
v_cvt_pk_bf16_f32 v255, v182, v183
v_mfma_f32_16x16x32_bf16 v[104:107], a[68:71], a[112:115], v[104:107]
v_permlane16_swap_b32 v244, v246
v_permlane16_swap_b32 v245, v247
v_mfma_f32_16x16x32_bf16 v[108:111], a[68:71], a[116:119], v[108:111]
buffer_store_dwordx4 v[244:247], v2, s[24:27], s6 offen offset:0 sc1
ds_write_b128 v24, v[244:247] offset:4096
v_mfma_f32_16x16x32_bf16 v[64:67], a[96:99], a[64:67], v[64:67]
v_cvt_pk_bf16_f32 v220, v144, v145
v_cvt_pk_bf16_f32 v221, v146, v147
v_mfma_f32_16x16x32_bf16 v[68:71], a[100:103], a[64:67], v[68:71]
v_cvt_pk_bf16_f32 v222, v148, v149
v_cvt_pk_bf16_f32 v223, v150, v151
v_mfma_f32_16x16x32_bf16 v[72:75], a[104:107], a[64:67], v[72:75]
v_permlane32_swap_b32 v252, v254
v_permlane32_swap_b32 v253, v255
v_mfma_f32_16x16x32_bf16 v[76:79], a[108:111], a[64:67], v[76:79]
buffer_store_dwordx4 v[252:255], v3, s[24:27], s6 offen offset:0 sc1
ds_write_b128 v25, v[252:255] offset:4096
v_mfma_f32_16x16x32_bf16 v[80:83], a[64:67], a[112:115], v[80:83]
v_cvt_pk_bf16_f32 v228, v152, v153
v_cvt_pk_bf16_f32 v229, v154, v155
v_mfma_f32_16x16x32_bf16 v[84:87], a[64:67], a[116:119], v[84:87]
v_cvt_pk_bf16_f32 v230, v156, v157
v_cvt_pk_bf16_f32 v231, v158, v159
s_branch .Lph2_B
.Lmain_A0:
.Lv_A0:
ds_read_b128 a[0:3], v6 offset:0
ds_read_b64_tr_b16 a[32:33], v8 offset:0
ds_read_b64_tr_b16 a[34:35], v8 offset:512
ds_read_b64_tr_b16 a[36:37], v9 offset:0
ds_read_b64_tr_b16 a[38:39], v9 offset:512
ds_read_b64_tr_b16 a[40:41], v8 offset:8192
ds_read_b64_tr_b16 a[42:43], v8 offset:8704
ds_read_b64_tr_b16 a[44:45], v9 offset:8192
ds_read_b64_tr_b16 a[46:47], v9 offset:8704
ds_read_b64_tr_b16 a[48:49], v8 offset:16384
ds_read_b64_tr_b16 a[50:51], v8 offset:16896
ds_read_b64_tr_b16 a[52:53], v9 offset:16384
ds_read_b64_tr_b16 a[54:55], v9 offset:16896
ds_read_b128 a[4:7], v6 offset:2048
ds_read_b128 a[8:11], v6 offset:4096
ds_read_b128 a[12:15], v6 offset:6144
ds_read_b128 a[16:19], v6 offset:8192
ds_read_b128 a[20:23], v6 offset:10240
ds_read_b128 a[24:27], v6 offset:12288
ds_read_b128 a[28:31], v6 offset:14336
s_mov_b32 s42, 0
s_waitcnt lgkmcnt(15)
v_mfma_f32_16x16x32_bf16 v[64:67], a[32:35], a[0:3], 0
ds_read_b128 a[64:67], v7 offset:0
v_mfma_f32_16x16x32_bf16 v[68:71], a[36:39], a[0:3], 0
s_add_u32 m0, s40, 0
s_nop 0
buffer_load_dwordx4 v2, s[4:7], 0 offen lds
s_waitcnt lgkmcnt(14)
v_mfma_f32_16x16x32_bf16 v[72:75], a[0:3], a[40:43], 0
ds_read_b64_tr_b16 a[96:97], v8 offset:4096
s_waitcnt lgkmcnt(13)
v_mfma_f32_16x16x32_bf16 v[76:79], a[0:3], a[44:47], 0
s_waitcnt lgkmcnt(11)
v_mfma_f32_16x16x32_bf16 v[80:83], a[0:3], a[48:51], 0
ds_read_b64_tr_b16 a[98:99], v8 offset:4608
s_waitcnt lgkmcnt(10)
v_mfma_f32_16x16x32_bf16 v[84:87], a[0:3], a[52:55], 0
buffer_load_dwordx4 v3, s[4:7], s64 offen offset:1024 lds
s_waitcnt lgkmcnt(9)
v_mfma_f32_16x16x32_bf16 v[88:91], a[32:35], a[4:7], 0
ds_read_b64_tr_b16 a[100:101], v9 offset:4096
v_mfma_f32_16x16x32_bf16 v[92:95], a[36:39], a[4:7], 0
v_mfma_f32_16x16x32_bf16 v[96:99], a[4:7], a[40:43], 0
ds_read_b64_tr_b16 a[102:103], v9 offset:4608
v_mfma_f32_16x16x32_bf16 v[100:103], a[4:7], a[44:47], 0
buffer_load_dwordx4 v2, s[4:7], s65 offen offset:2048 lds
v_mfma_f32_16x16x32_bf16 v[104:107], a[4:7], a[48:51], 0
ds_read_b64_tr_b16 a[104:105], v8 offset:12288
v_mfma_f32_16x16x32_bf16 v[108:111], a[4:7], a[52:55], 0
s_waitcnt lgkmcnt(3)
v_mfma_f32_16x16x32_bf16 v[112:115], a[32:35], a[8:11], 0
ds_read_b64_tr_b16 a[106:107], v8 offset:12800
v_mfma_f32_16x16x32_bf16 v[116:119], a[36:39], a[8:11], 0
buffer_load_dwordx4 v3, s[4:7], s66 offen offset:3072 lds
v_mfma_f32_16x16x32_bf16 v[120:123], a[8:11], a[40:43], 0
ds_read_b64_tr_b16 a[108:109], v9 offset:12288
v_mfma_f32_16x16x32_bf16 v[124:127], a[8:11], a[44:47], 0
v_mfma_f32_16x16x32_bf16 v[128:131], a[8:11], a[48:51], 0
ds_read_b64_tr_b16 a[110:111], v9 offset:12800
v_mfma_f32_16x16x32_bf16 v[132:135], a[8:11], a[52:55], 0
s_add_u32 m0, s40, 4096
s_nop 0
buffer_load_dwordx4 v2, s[4:7], s67 offen lds
v_mfma_f32_16x16x32_bf16 v[136:139], a[32:35], a[12:15], 0
ds_read_b64_tr_b16 a[112:113], v8 offset:20480
v_mfma_f32_16x16x32_bf16 v[140:143], a[36:39], a[12:15], 0
v_mfma_f32_16x16x32_bf16 v[144:147], a[12:15], a[40:43], 0
ds_read_b64_tr_b16 a[114:115], v8 offset:20992
v_mfma_f32_16x16x32_bf16 v[148:151], a[12:15], a[44:47], 0
buffer_load_dwordx4 v3, s[4:7], s68 offen offset:1024 lds
v_mfma_f32_16x16x32_bf16 v[152:155], a[12:15], a[48:51], 0
ds_read_b64_tr_b16 a[116:117], v9 offset:20480
v_add_u32 v2, 0x80, v2
v_mfma_f32_16x16x32_bf16 v[156:159], a[12:15], a[52:55], 0
v_add_u32 v3, 0x80, v3
v_mfma_f32_16x16x32_bf16 v[160:163], a[32:35], a[16:19], 0
ds_read_b64_tr_b16 a[118:119], v9 offset:20992
s_mov_b32 s16, s87
v_mfma_f32_16x16x32_bf16 v[164:167], a[36:39], a[16:19], 0
s_mov_b32 s87, s88
v_mfma_f32_16x16x32_bf16 v[168:171], a[16:19], a[40:43], 0
ds_read_b128 a[68:71], v7 offset:2048
s_mov_b32 s88, s89
v_mfma_f32_16x16x32_bf16 v[172:175], a[16:19], a[44:47], 0
s_mov_b32 s89, s16
v_mfma_f32_16x16x32_bf16 v[176:179], a[16:19], a[48:51], 0
ds_read_b128 a[72:75], v7 offset:4096
s_mov_b32 s40, s87
v_mfma_f32_16x16x32_bf16 v[180:183], a[16:19], a[52:55], 0
v_mfma_f32_16x16x32_bf16 v[184:187], a[32:35], a[20:23], 0
ds_read_b128 a[76:79], v7 offset:6144
v_mfma_f32_16x16x32_bf16 v[188:191], a[36:39], a[20:23], 0
v_mfma_f32_16x16x32_bf16 v[192:195], a[20:23], a[40:43], 0
ds_read_b128 a[80:83], v7 offset:8192
v_mfma_f32_16x16x32_bf16 v[196:199], a[20:23], a[44:47], 0
v_mfma_f32_16x16x32_bf16 v[200:203], a[20:23], a[48:51], 0
ds_read_b128 a[84:87], v7 offset:10240
v_mfma_f32_16x16x32_bf16 v[204:207], a[20:23], a[52:55], 0
v_mfma_f32_16x16x32_bf16 v[208:211], a[32:35], a[24:27], 0
ds_read_b128 a[88:91], v7 offset:12288
v_mfma_f32_16x16x32_bf16 v[212:215], a[36:39], a[24:27], 0
v_mfma_f32_16x16x32_bf16 v[216:219], a[24:27], a[40:43], 0
ds_read_b128 a[92:95], v7 offset:14336
v_mfma_f32_16x16x32_bf16 v[220:223], a[24:27], a[44:47], 0
v_mfma_f32_16x16x32_bf16 v[224:227], a[24:27], a[48:51], 0
v_add_u32 v7, s92, v7
v_mfma_f32_16x16x32_bf16 v[228:231], a[24:27], a[52:55], 0
v_add_u32 v6, s92, v6
v_mfma_f32_16x16x32_bf16 v[232:235], a[32:35], a[28:31], 0
s_mov_b32 s17, s92
v_mfma_f32_16x16x32_bf16 v[236:239], a[36:39], a[28:31], 0
s_mov_b32 s92, s93
v_mfma_f32_16x16x32_bf16 v[240:243], a[28:31], a[40:43], 0
s_mov_b32 s93, s94
v_mfma_f32_16x16x32_bf16 v[244:247], a[28:31], a[44:47], 0
s_mov_b32 s94, s17
v_mfma_f32_16x16x32_bf16 v[248:251], a[28:31], a[48:51], 0
v_mfma_f32_16x16x32_bf16 v[252:255], a[28:31], a[52:55], 0
s_waitcnt lgkmcnt(0)
v_mfma_f32_16x16x32_bf16 v[64:67], a[96:99], a[64:67], v[64:67]
s_waitcnt vmcnt(6)
s_barrier
v_mfma_f32_16x16x32_bf16 v[68:71], a[100:103], a[64:67], v[68:71]
s_add_u32 m0, s41, 98304
s_nop 0
buffer_load_dwordx4 v4, s[8:11], 0 offen lds
v_mfma_f32_16x16x32_bf16 v[72:75], a[64:67], a[104:107], v[72:75]
ds_read_b128 a[0:3], v6 offset:0
v_mfma_f32_16x16x32_bf16 v[76:79], a[64:67], a[108:111], v[76:79]
s_cmp_eq_u32 s43, 0
s_cselect_b32 s24, s44, 0
s_cselect_b32 s25, 0x4000, 0
v_readlane_b32 s30, v62, s24
v_readlane_b32 s31, v62, 1
v_readlane_b32 s33, v63, 1
v_readlane_b32 s3, v62, 2
v_readlane_b32 s34, v62, 3
s_lshl_b32 s24, s44, 4
s_add_u32 s24, s24, s45
s_lshl_b32 s24, s24, 7
s_add_u32 s32, s24, s25
s_add_u32 s32, s32, 29360128

v_accvgpr_write_b32 a252, v60
v_accvgpr_write_b32 a253, v61
v_mfma_f32_16x16x32_bf16 v[80:83], a[64:67], a[112:115], v[80:83]
ds_read_b64_tr_b16 a[32:33], v8 offset:24576
v_mfma_f32_16x16x32_bf16 v[84:87], a[64:67], a[116:119], v[84:87]
buffer_load_dwordx4 v5, s[8:11], s80 offen offset:1024 lds
v_mfma_f32_16x16x32_bf16 v[88:91], a[96:99], a[68:71], v[88:91]
ds_read_b64_tr_b16 a[34:35], v8 offset:25088
v_mfma_f32_16x16x32_bf16 v[92:95], a[100:103], a[68:71], v[92:95]
v_mfma_f32_16x16x32_bf16 v[96:99], a[68:71], a[104:107], v[96:99]
ds_read_b64_tr_b16 a[36:37], v9 offset:24576
v_mfma_f32_16x16x32_bf16 v[100:103], a[68:71], a[108:111], v[100:103]
buffer_load_dwordx4 v4, s[8:11], s81 offen offset:2048 lds
v_mfma_f32_16x16x32_bf16 v[104:107], a[68:71], a[112:115], v[104:107]
ds_read_b64_tr_b16 a[38:39], v9 offset:25088
v_mfma_f32_16x16x32_bf16 v[108:111], a[68:71], a[116:119], v[108:111]
v_mfma_f32_16x16x32_bf16 v[112:115], a[96:99], a[72:75], v[112:115]
ds_read_b64_tr_b16 a[40:41], v8 offset:32768
v_mfma_f32_16x16x32_bf16 v[116:119], a[100:103], a[72:75], v[116:119]
buffer_load_dwordx4 v5, s[8:11], s82 offen offset:3072 lds
v_mfma_f32_16x16x32_bf16 v[120:123], a[72:75], a[104:107], v[120:123]
ds_read_b64_tr_b16 a[42:43], v8 offset:33280
v_mfma_f32_16x16x32_bf16 v[124:127], a[72:75], a[108:111], v[124:127]
v_mfma_f32_16x16x32_bf16 v[128:131], a[72:75], a[112:115], v[128:131]
ds_read_b64_tr_b16 a[44:45], v9 offset:32768
v_mfma_f32_16x16x32_bf16 v[132:135], a[72:75], a[116:119], v[132:135]
s_add_u32 m0, s41, 102400
s_nop 0
buffer_load_dwordx4 v4, s[8:11], s83 offen lds
v_mfma_f32_16x16x32_bf16 v[136:139], a[96:99], a[76:79], v[136:139]
ds_read_b64_tr_b16 a[46:47], v9 offset:33280
v_mfma_f32_16x16x32_bf16 v[140:143], a[100:103], a[76:79], v[140:143]
v_mfma_f32_16x16x32_bf16 v[144:147], a[76:79], a[104:107], v[144:147]
ds_read_b64_tr_b16 a[48:49], v8 offset:40960
v_mfma_f32_16x16x32_bf16 v[148:151], a[76:79], a[108:111], v[148:151]
buffer_load_dwordx4 v5, s[8:11], s84 offen offset:1024 lds
v_mfma_f32_16x16x32_bf16 v[152:155], a[76:79], a[112:115], v[152:155]
ds_read_b64_tr_b16 a[50:51], v8 offset:41472
v_mfma_f32_16x16x32_bf16 v[156:159], a[76:79], a[116:119], v[156:159]
v_mfma_f32_16x16x32_bf16 v[160:163], a[96:99], a[80:83], v[160:163]
ds_read_b64_tr_b16 a[52:53], v9 offset:40960
v_mfma_f32_16x16x32_bf16 v[164:167], a[100:103], a[80:83], v[164:167]
buffer_load_dwordx4 v4, s[8:11], s85 offen offset:2048 lds
v_mfma_f32_16x16x32_bf16 v[168:171], a[80:83], a[104:107], v[168:171]
ds_read_b64_tr_b16 a[54:55], v9 offset:41472
v_mfma_f32_16x16x32_bf16 v[172:175], a[80:83], a[108:111], v[172:175]
v_mfma_f32_16x16x32_bf16 v[176:179], a[80:83], a[112:115], v[176:179]
ds_read_b128 a[4:7], v6 offset:2048
v_mfma_f32_16x16x32_bf16 v[180:183], a[80:83], a[116:119], v[180:183]
buffer_load_dwordx4 v5, s[8:11], s86 offen offset:3072 lds
v_mfma_f32_16x16x32_bf16 v[184:187], a[96:99], a[84:87], v[184:187]
ds_read_b128 a[8:11], v6 offset:4096
v_mfma_f32_16x16x32_bf16 v[188:191], a[100:103], a[84:87], v[188:191]
s_add_u32 s8, s8, 393216
s_addc_u32 s9, s9, 0
v_mfma_f32_16x16x32_bf16 v[192:195], a[84:87], a[104:107], v[192:195]
ds_read_b128 a[12:15], v6 offset:6144
v_mfma_f32_16x16x32_bf16 v[196:199], a[84:87], a[108:111], v[196:199]
s_add_u32 m0, s40, 0
s_nop 0
buffer_load_dwordx4 v2, s[4:7], 0 offen lds
v_mfma_f32_16x16x32_bf16 v[200:203], a[84:87], a[112:115], v[200:203]
ds_read_b128 a[16:19], v6 offset:8192
v_mfma_f32_16x16x32_bf16 v[204:207], a[84:87], a[116:119], v[204:207]
s_sub_u32 s10, s10, 393216
v_mfma_f32_16x16x32_bf16 v[208:211], a[96:99], a[88:91], v[208:211]
ds_read_b128 a[20:23], v6 offset:10240
v_mfma_f32_16x16x32_bf16 v[212:215], a[100:103], a[88:91], v[212:215]
buffer_load_dwordx4 v3, s[4:7], s64 offen offset:1024 lds
v_mfma_f32_16x16x32_bf16 v[216:219], a[88:91], a[104:107], v[216:219]
ds_read_b128 a[24:27], v6 offset:12288
v_mfma_f32_16x16x32_bf16 v[220:223], a[88:91], a[108:111], v[220:223]
v_mfma_f32_16x16x32_bf16 v[224:227], a[88:91], a[112:115], v[224:227]
ds_read_b128 a[28:31], v6 offset:14336
v_mfma_f32_16x16x32_bf16 v[228:231], a[88:91], a[116:119], v[228:231]
buffer_load_dwordx4 v2, s[4:7], s65 offen offset:2048 lds
v_mfma_f32_16x16x32_bf16 v[232:235], a[96:99], a[92:95], v[232:235]
v_mfma_f32_16x16x32_bf16 v[236:239], a[100:103], a[92:95], v[236:239]
v_mfma_f32_16x16x32_bf16 v[240:243], a[92:95], a[104:107], v[240:243]
v_mfma_f32_16x16x32_bf16 v[244:247], a[92:95], a[108:111], v[244:247]
buffer_load_dwordx4 v3, s[4:7], s66 offen offset:3072 lds
v_mfma_f32_16x16x32_bf16 v[248:251], a[92:95], a[112:115], v[248:251]
v_mfma_f32_16x16x32_bf16 v[252:255], a[92:95], a[116:119], v[252:255]
.p2align 6
.LA0_loop:
s_waitcnt lgkmcnt(0)
v_mfma_f32_16x16x32_bf16 v[64:67], a[32:35], a[0:3], v[64:67]
ds_read_b128 a[64:67], v7 offset:0
v_mfma_f32_16x16x32_bf16 v[68:71], a[36:39], a[0:3], v[68:71]
s_add_u32 m0, s40, 4096
s_nop 0
buffer_load_dwordx4 v2, s[4:7], s67 offen lds
v_mfma_f32_16x16x32_bf16 v[72:75], a[0:3], a[40:43], v[72:75]
ds_read_b64_tr_b16 a[96:97], v8 offset:28672
v_mfma_f32_16x16x32_bf16 v[76:79], a[0:3], a[44:47], v[76:79]
v_mfma_f32_16x16x32_bf16 v[80:83], a[0:3], a[48:51], v[80:83]
ds_read_b64_tr_b16 a[98:99], v8 offset:29184
v_mfma_f32_16x16x32_bf16 v[84:87], a[0:3], a[52:55], v[84:87]
buffer_load_dwordx4 v3, s[4:7], s68 offen offset:1024 lds
v_mfma_f32_16x16x32_bf16 v[88:91], a[32:35], a[4:7], v[88:91]
ds_read_b64_tr_b16 a[100:101], v9 offset:28672
v_mfma_f32_16x16x32_bf16 v[92:95], a[36:39], a[4:7], v[92:95]
v_add_u32 v2, 0x80, v2
v_mfma_f32_16x16x32_bf16 v[96:99], a[4:7], a[40:43], v[96:99]
ds_read_b64_tr_b16 a[102:103], v9 offset:29184
v_mfma_f32_16x16x32_bf16 v[100:103], a[4:7], a[44:47], v[100:103]
v_mfma_f32_16x16x32_bf16 v[104:107], a[4:7], a[48:51], v[104:107]
ds_read_b64_tr_b16 a[104:105], v8 offset:36864
v_mfma_f32_16x16x32_bf16 v[108:111], a[4:7], a[52:55], v[108:111]
v_add_u32 v3, 0x80, v3
v_mfma_f32_16x16x32_bf16 v[112:115], a[32:35], a[8:11], v[112:115]
ds_read_b64_tr_b16 a[106:107], v8 offset:37376
v_mfma_f32_16x16x32_bf16 v[116:119], a[36:39], a[8:11], v[116:119]
v_mfma_f32_16x16x32_bf16 v[120:123], a[8:11], a[40:43], v[120:123]
ds_read_b64_tr_b16 a[108:109], v9 offset:36864
v_mfma_f32_16x16x32_bf16 v[124:127], a[8:11], a[44:47], v[124:127]
s_mov_b32 s16, s87
v_mfma_f32_16x16x32_bf16 v[128:131], a[8:11], a[48:51], v[128:131]
ds_read_b64_tr_b16 a[110:111], v9 offset:37376
v_mfma_f32_16x16x32_bf16 v[132:135], a[8:11], a[52:55], v[132:135]
v_mfma_f32_16x16x32_bf16 v[136:139], a[32:35], a[12:15], v[136:139]
ds_read_b64_tr_b16 a[112:113], v8 offset:45056
v_mfma_f32_16x16x32_bf16 v[140:143], a[36:39], a[12:15], v[140:143]
s_mov_b32 s87, s88
v_mfma_f32_16x16x32_bf16 v[144:147], a[12:15], a[40:43], v[144:147]
ds_read_b64_tr_b16 a[114:115], v8 offset:45568
v_mfma_f32_16x16x32_bf16 v[148:151], a[12:15], a[44:47], v[148:151]
v_mfma_f32_16x16x32_bf16 v[152:155], a[12:15], a[48:51], v[152:155]
ds_read_b64_tr_b16 a[116:117], v9 offset:45056
v_mfma_f32_16x16x32_bf16 v[156:159], a[12:15], a[52:55], v[156:159]
s_mov_b32 s88, s89
v_mfma_f32_16x16x32_bf16 v[160:163], a[32:35], a[16:19], v[160:163]
ds_read_b64_tr_b16 a[118:119], v9 offset:45568
v_mfma_f32_16x16x32_bf16 v[164:167], a[36:39], a[16:19], v[164:167]
v_mfma_f32_16x16x32_bf16 v[168:171], a[16:19], a[40:43], v[168:171]
ds_read_b128 a[68:71], v7 offset:2048
v_mfma_f32_16x16x32_bf16 v[172:175], a[16:19], a[44:47], v[172:175]
s_mov_b32 s89, s16
v_mfma_f32_16x16x32_bf16 v[176:179], a[16:19], a[48:51], v[176:179]
ds_read_b128 a[72:75], v7 offset:4096
v_mfma_f32_16x16x32_bf16 v[180:183], a[16:19], a[52:55], v[180:183]
v_mfma_f32_16x16x32_bf16 v[184:187], a[32:35], a[20:23], v[184:187]
ds_read_b128 a[76:79], v7 offset:6144
v_mfma_f32_16x16x32_bf16 v[188:191], a[36:39], a[20:23], v[188:191]
s_mov_b32 s40, s87
v_mfma_f32_16x16x32_bf16 v[192:195], a[20:23], a[40:43], v[192:195]
ds_read_b128 a[80:83], v7 offset:8192
v_mfma_f32_16x16x32_bf16 v[196:199], a[20:23], a[44:47], v[196:199]
v_mfma_f32_16x16x32_bf16 v[200:203], a[20:23], a[48:51], v[200:203]
ds_read_b128 a[84:87], v7 offset:10240
v_mfma_f32_16x16x32_bf16 v[204:207], a[20:23], a[52:55], v[204:207]
v_mfma_f32_16x16x32_bf16 v[208:211], a[32:35], a[24:27], v[208:211]
ds_read_b128 a[88:91], v7 offset:12288
v_mfma_f32_16x16x32_bf16 v[212:215], a[36:39], a[24:27], v[212:215]
v_mfma_f32_16x16x32_bf16 v[216:219], a[24:27], a[40:43], v[216:219]
ds_read_b128 a[92:95], v7 offset:14336
v_mfma_f32_16x16x32_bf16 v[220:223], a[24:27], a[44:47], v[220:223]
v_mfma_f32_16x16x32_bf16 v[224:227], a[24:27], a[48:51], v[224:227]
v_add_u32 v7, s92, v7
v_mfma_f32_16x16x32_bf16 v[228:231], a[24:27], a[52:55], v[228:231]
v_add_u32 v6, s92, v6
v_mfma_f32_16x16x32_bf16 v[232:235], a[32:35], a[28:31], v[232:235]
s_mov_b32 s17, s92
v_mfma_f32_16x16x32_bf16 v[236:239], a[36:39], a[28:31], v[236:239]
s_mov_b32 s92, s93
v_mfma_f32_16x16x32_bf16 v[240:243], a[28:31], a[40:43], v[240:243]
s_mov_b32 s93, s94
v_mfma_f32_16x16x32_bf16 v[244:247], a[28:31], a[44:47], v[244:247]
s_mov_b32 s94, s17
v_mfma_f32_16x16x32_bf16 v[248:251], a[28:31], a[48:51], v[248:251]
v_mfma_f32_16x16x32_bf16 v[252:255], a[28:31], a[52:55], v[252:255]
s_waitcnt lgkmcnt(0)
v_mfma_f32_16x16x32_bf16 v[64:67], a[96:99], a[64:67], v[64:67]
s_waitcnt vmcnt(6)
s_barrier
v_mfma_f32_16x16x32_bf16 v[68:71], a[100:103], a[64:67], v[68:71]
s_add_u32 m0, s41, 122880
s_nop 0
buffer_load_dwordx4 v4, s[8:11], 0 offen lds
v_mfma_f32_16x16x32_bf16 v[72:75], a[64:67], a[104:107], v[72:75]
ds_read_b128 a[0:3], v6 offset:0
v_mfma_f32_16x16x32_bf16 v[76:79], a[64:67], a[108:111], v[76:79]
v_mfma_f32_16x16x32_bf16 v[80:83], a[64:67], a[112:115], v[80:83]
ds_read_b64_tr_b16 a[32:33], v8 offset:0
v_mfma_f32_16x16x32_bf16 v[84:87], a[64:67], a[116:119], v[84:87]
buffer_load_dwordx4 v5, s[8:11], s80 offen offset:1024 lds
v_mfma_f32_16x16x32_bf16 v[88:91], a[96:99], a[68:71], v[88:91]
ds_read_b64_tr_b16 a[34:35], v8 offset:512
v_mfma_f32_16x16x32_bf16 v[92:95], a[100:103], a[68:71], v[92:95]
v_mfma_f32_16x16x32_bf16 v[96:99], a[68:71], a[104:107], v[96:99]
ds_read_b64_tr_b16 a[36:37], v9 offset:0
v_mfma_f32_16x16x32_bf16 v[100:103], a[68:71], a[108:111], v[100:103]
buffer_load_dwordx4 v4, s[8:11], s81 offen offset:2048 lds
v_mfma_f32_16x16x32_bf16 v[104:107], a[68:71], a[112:115], v[104:107]
ds_read_b64_tr_b16 a[38:39], v9 offset:512
v_mfma_f32_16x16x32_bf16 v[108:111], a[68:71], a[116:119], v[108:111]
v_mfma_f32_16x16x32_bf16 v[112:115], a[96:99], a[72:75], v[112:115]
ds_read_b64_tr_b16 a[40:41], v8 offset:8192
v_mfma_f32_16x16x32_bf16 v[116:119], a[100:103], a[72:75], v[116:119]
buffer_load_dwordx4 v5, s[8:11], s82 offen offset:3072 lds
v_mfma_f32_16x16x32_bf16 v[120:123], a[72:75], a[104:107], v[120:123]
ds_read_b64_tr_b16 a[42:43], v8 offset:8704
v_mfma_f32_16x16x32_bf16 v[124:127], a[72:75], a[108:111], v[124:127]
v_mfma_f32_16x16x32_bf16 v[128:131], a[72:75], a[112:115], v[128:131]
ds_read_b64_tr_b16 a[44:45], v9 offset:8192
v_mfma_f32_16x16x32_bf16 v[132:135], a[72:75], a[116:119], v[132:135]
s_add_u32 m0, s41, 126976
s_nop 0
buffer_load_dwordx4 v4, s[8:11], s83 offen lds
v_mfma_f32_16x16x32_bf16 v[136:139], a[96:99], a[76:79], v[136:139]
ds_read_b64_tr_b16 a[46:47], v9 offset:8704
v_mfma_f32_16x16x32_bf16 v[140:143], a[100:103], a[76:79], v[140:143]
v_mfma_f32_16x16x32_bf16 v[144:147], a[76:79], a[104:107], v[144:147]
ds_read_b64_tr_b16 a[48:49], v8 offset:16384
v_mfma_f32_16x16x32_bf16 v[148:151], a[76:79], a[108:111], v[148:151]
buffer_load_dwordx4 v5, s[8:11], s84 offen offset:1024 lds
v_mfma_f32_16x16x32_bf16 v[152:155], a[76:79], a[112:115], v[152:155]
ds_read_b64_tr_b16 a[50:51], v8 offset:16896
v_mfma_f32_16x16x32_bf16 v[156:159], a[76:79], a[116:119], v[156:159]
v_mfma_f32_16x16x32_bf16 v[160:163], a[96:99], a[80:83], v[160:163]
ds_read_b64_tr_b16 a[52:53], v9 offset:16384
v_mfma_f32_16x16x32_bf16 v[164:167], a[100:103], a[80:83], v[164:167]
buffer_load_dwordx4 v4, s[8:11], s85 offen offset:2048 lds
v_mfma_f32_16x16x32_bf16 v[168:171], a[80:83], a[104:107], v[168:171]
ds_read_b64_tr_b16 a[54:55], v9 offset:16896
v_mfma_f32_16x16x32_bf16 v[172:175], a[80:83], a[108:111], v[172:175]
v_mfma_f32_16x16x32_bf16 v[176:179], a[80:83], a[112:115], v[176:179]
ds_read_b128 a[4:7], v6 offset:2048
v_mfma_f32_16x16x32_bf16 v[180:183], a[80:83], a[116:119], v[180:183]
buffer_load_dwordx4 v5, s[8:11], s86 offen offset:3072 lds
v_mfma_f32_16x16x32_bf16 v[184:187], a[96:99], a[84:87], v[184:187]
ds_read_b128 a[8:11], v6 offset:4096
v_mfma_f32_16x16x32_bf16 v[188:191], a[100:103], a[84:87], v[188:191]
s_add_u32 s8, s8, 393216
s_addc_u32 s9, s9, 0
v_mfma_f32_16x16x32_bf16 v[192:195], a[84:87], a[104:107], v[192:195]
ds_read_b128 a[12:15], v6 offset:6144
v_mfma_f32_16x16x32_bf16 v[196:199], a[84:87], a[108:111], v[196:199]
s_add_u32 m0, s40, 0
s_nop 0
buffer_load_dwordx4 v2, s[4:7], 0 offen lds
v_mfma_f32_16x16x32_bf16 v[200:203], a[84:87], a[112:115], v[200:203]
ds_read_b128 a[16:19], v6 offset:8192
v_mfma_f32_16x16x32_bf16 v[204:207], a[84:87], a[116:119], v[204:207]
s_sub_u32 s10, s10, 393216
v_mfma_f32_16x16x32_bf16 v[208:211], a[96:99], a[88:91], v[208:211]
ds_read_b128 a[20:23], v6 offset:10240
v_mfma_f32_16x16x32_bf16 v[212:215], a[100:103], a[88:91], v[212:215]
buffer_load_dwordx4 v3, s[4:7], s64 offen offset:1024 lds
v_mfma_f32_16x16x32_bf16 v[216:219], a[88:91], a[104:107], v[216:219]
ds_read_b128 a[24:27], v6 offset:12288
v_mfma_f32_16x16x32_bf16 v[220:223], a[88:91], a[108:111], v[220:223]
v_mfma_f32_16x16x32_bf16 v[224:227], a[88:91], a[112:115], v[224:227]
ds_read_b128 a[28:31], v6 offset:14336
v_mfma_f32_16x16x32_bf16 v[228:231], a[88:91], a[116:119], v[228:231]
buffer_load_dwordx4 v2, s[4:7], s65 offen offset:2048 lds
v_mfma_f32_16x16x32_bf16 v[232:235], a[96:99], a[92:95], v[232:235]
v_mfma_f32_16x16x32_bf16 v[236:239], a[100:103], a[92:95], v[236:239]
v_mfma_f32_16x16x32_bf16 v[240:243], a[92:95], a[104:107], v[240:243]
v_mfma_f32_16x16x32_bf16 v[244:247], a[92:95], a[108:111], v[244:247]
buffer_load_dwordx4 v3, s[4:7], s66 offen offset:3072 lds
v_mfma_f32_16x16x32_bf16 v[248:251], a[92:95], a[112:115], v[248:251]
v_mfma_f32_16x16x32_bf16 v[252:255], a[92:95], a[116:119], v[252:255]
s_waitcnt lgkmcnt(0)
v_mfma_f32_16x16x32_bf16 v[64:67], a[32:35], a[0:3], v[64:67]
ds_read_b128 a[64:67], v7 offset:0
v_mfma_f32_16x16x32_bf16 v[68:71], a[36:39], a[0:3], v[68:71]
s_add_u32 m0, s40, 4096
s_nop 0
buffer_load_dwordx4 v2, s[4:7], s67 offen lds
v_mfma_f32_16x16x32_bf16 v[72:75], a[0:3], a[40:43], v[72:75]
ds_read_b64_tr_b16 a[96:97], v8 offset:4096
v_mfma_f32_16x16x32_bf16 v[76:79], a[0:3], a[44:47], v[76:79]
v_mfma_f32_16x16x32_bf16 v[80:83], a[0:3], a[48:51], v[80:83]
ds_read_b64_tr_b16 a[98:99], v8 offset:4608
v_mfma_f32_16x16x32_bf16 v[84:87], a[0:3], a[52:55], v[84:87]
buffer_load_dwordx4 v3, s[4:7], s68 offen offset:1024 lds
v_mfma_f32_16x16x32_bf16 v[88:91], a[32:35], a[4:7], v[88:91]
ds_read_b64_tr_b16 a[100:101], v9 offset:4096
v_mfma_f32_16x16x32_bf16 v[92:95], a[36:39], a[4:7], v[92:95]
v_add_u32 v2, 0x80, v2
v_mfma_f32_16x16x32_bf16 v[96:99], a[4:7], a[40:43], v[96:99]
ds_read_b64_tr_b16 a[102:103], v9 offset:4608
v_mfma_f32_16x16x32_bf16 v[100:103], a[4:7], a[44:47], v[100:103]
v_mfma_f32_16x16x32_bf16 v[104:107], a[4:7], a[48:51], v[104:107]
ds_read_b64_tr_b16 a[104:105], v8 offset:12288
v_mfma_f32_16x16x32_bf16 v[108:111], a[4:7], a[52:55], v[108:111]
v_add_u32 v3, 0x80, v3
v_mfma_f32_16x16x32_bf16 v[112:115], a[32:35], a[8:11], v[112:115]
ds_read_b64_tr_b16 a[106:107], v8 offset:12800
v_mfma_f32_16x16x32_bf16 v[116:119], a[36:39], a[8:11], v[116:119]
v_mfma_f32_16x16x32_bf16 v[120:123], a[8:11], a[40:43], v[120:123]
ds_read_b64_tr_b16 a[108:109], v9 offset:12288
v_mfma_f32_16x16x32_bf16 v[124:127], a[8:11], a[44:47], v[124:127]
s_mov_b32 s16, s87
v_mfma_f32_16x16x32_bf16 v[128:131], a[8:11], a[48:51], v[128:131]
ds_read_b64_tr_b16 a[110:111], v9 offset:12800
v_mfma_f32_16x16x32_bf16 v[132:135], a[8:11], a[52:55], v[132:135]
v_mfma_f32_16x16x32_bf16 v[136:139], a[32:35], a[12:15], v[136:139]
ds_read_b64_tr_b16 a[112:113], v8 offset:20480
v_mfma_f32_16x16x32_bf16 v[140:143], a[36:39], a[12:15], v[140:143]
s_mov_b32 s87, s88
v_mfma_f32_16x16x32_bf16 v[144:147], a[12:15], a[40:43], v[144:147]
ds_read_b64_tr_b16 a[114:115], v8 offset:20992
v_mfma_f32_16x16x32_bf16 v[148:151], a[12:15], a[44:47], v[148:151]
v_mfma_f32_16x16x32_bf16 v[152:155], a[12:15], a[48:51], v[152:155]
ds_read_b64_tr_b16 a[116:117], v9 offset:20480
v_mfma_f32_16x16x32_bf16 v[156:159], a[12:15], a[52:55], v[156:159]
s_mov_b32 s88, s89
v_mfma_f32_16x16x32_bf16 v[160:163], a[32:35], a[16:19], v[160:163]
ds_read_b64_tr_b16 a[118:119], v9 offset:20992
v_mfma_f32_16x16x32_bf16 v[164:167], a[36:39], a[16:19], v[164:167]
v_mfma_f32_16x16x32_bf16 v[168:171], a[16:19], a[40:43], v[168:171]
ds_read_b128 a[68:71], v7 offset:2048
v_mfma_f32_16x16x32_bf16 v[172:175], a[16:19], a[44:47], v[172:175]
s_mov_b32 s89, s16
v_mfma_f32_16x16x32_bf16 v[176:179], a[16:19], a[48:51], v[176:179]
ds_read_b128 a[72:75], v7 offset:4096
v_mfma_f32_16x16x32_bf16 v[180:183], a[16:19], a[52:55], v[180:183]
v_mfma_f32_16x16x32_bf16 v[184:187], a[32:35], a[20:23], v[184:187]
ds_read_b128 a[76:79], v7 offset:6144
v_mfma_f32_16x16x32_bf16 v[188:191], a[36:39], a[20:23], v[188:191]
s_mov_b32 s40, s87
v_mfma_f32_16x16x32_bf16 v[192:195], a[20:23], a[40:43], v[192:195]
ds_read_b128 a[80:83], v7 offset:8192
v_mfma_f32_16x16x32_bf16 v[196:199], a[20:23], a[44:47], v[196:199]
v_mfma_f32_16x16x32_bf16 v[200:203], a[20:23], a[48:51], v[200:203]
ds_read_b128 a[84:87], v7 offset:10240
v_mfma_f32_16x16x32_bf16 v[204:207], a[20:23], a[52:55], v[204:207]
v_mfma_f32_16x16x32_bf16 v[208:211], a[32:35], a[24:27], v[208:211]
ds_read_b128 a[88:91], v7 offset:12288
v_mfma_f32_16x16x32_bf16 v[212:215], a[36:39], a[24:27], v[212:215]
v_mfma_f32_16x16x32_bf16 v[216:219], a[24:27], a[40:43], v[216:219]
ds_read_b128 a[92:95], v7 offset:14336
v_mfma_f32_16x16x32_bf16 v[220:223], a[24:27], a[44:47], v[220:223]
v_mfma_f32_16x16x32_bf16 v[224:227], a[24:27], a[48:51], v[224:227]
v_add_u32 v7, s92, v7
v_mfma_f32_16x16x32_bf16 v[228:231], a[24:27], a[52:55], v[228:231]
v_add_u32 v6, s92, v6
v_mfma_f32_16x16x32_bf16 v[232:235], a[32:35], a[28:31], v[232:235]
s_mov_b32 s17, s92
v_mfma_f32_16x16x32_bf16 v[236:239], a[36:39], a[28:31], v[236:239]
s_mov_b32 s92, s93
v_mfma_f32_16x16x32_bf16 v[240:243], a[28:31], a[40:43], v[240:243]
s_mov_b32 s93, s94
v_mfma_f32_16x16x32_bf16 v[244:247], a[28:31], a[44:47], v[244:247]
s_mov_b32 s94, s17
v_mfma_f32_16x16x32_bf16 v[248:251], a[28:31], a[48:51], v[248:251]
v_mfma_f32_16x16x32_bf16 v[252:255], a[28:31], a[52:55], v[252:255]
s_waitcnt lgkmcnt(0)
v_mfma_f32_16x16x32_bf16 v[64:67], a[96:99], a[64:67], v[64:67]
s_waitcnt vmcnt(6)
s_barrier
v_mfma_f32_16x16x32_bf16 v[68:71], a[100:103], a[64:67], v[68:71]
s_add_u32 m0, s41, 98304
s_nop 0
buffer_load_dwordx4 v4, s[8:11], 0 offen lds
v_mfma_f32_16x16x32_bf16 v[72:75], a[64:67], a[104:107], v[72:75]
ds_read_b128 a[0:3], v6 offset:0
v_mfma_f32_16x16x32_bf16 v[76:79], a[64:67], a[108:111], v[76:79]
v_mfma_f32_16x16x32_bf16 v[80:83], a[64:67], a[112:115], v[80:83]
ds_read_b64_tr_b16 a[32:33], v8 offset:24576
v_mfma_f32_16x16x32_bf16 v[84:87], a[64:67], a[116:119], v[84:87]
buffer_load_dwordx4 v5, s[8:11], s80 offen offset:1024 lds
v_mfma_f32_16x16x32_bf16 v[88:91], a[96:99], a[68:71], v[88:91]
ds_read_b64_tr_b16 a[34:35], v8 offset:25088
v_mfma_f32_16x16x32_bf16 v[92:95], a[100:103], a[68:71], v[92:95]
v_mfma_f32_16x16x32_bf16 v[96:99], a[68:71], a[104:107], v[96:99]
ds_read_b64_tr_b16 a[36:37], v9 offset:24576
v_mfma_f32_16x16x32_bf16 v[100:103], a[68:71], a[108:111], v[100:103]
buffer_load_dwordx4 v4, s[8:11], s81 offen offset:2048 lds
v_mfma_f32_16x16x32_bf16 v[104:107], a[68:71], a[112:115], v[104:107]
ds_read_b64_tr_b16 a[38:39], v9 offset:25088
v_mfma_f32_16x16x32_bf16 v[108:111], a[68:71], a[116:119], v[108:111]
v_mfma_f32_16x16x32_bf16 v[112:115], a[96:99], a[72:75], v[112:115]
ds_read_b64_tr_b16 a[40:41], v8 offset:32768
v_mfma_f32_16x16x32_bf16 v[116:119], a[100:103], a[72:75], v[116:119]
buffer_load_dwordx4 v5, s[8:11], s82 offen offset:3072 lds
v_mfma_f32_16x16x32_bf16 v[120:123], a[72:75], a[104:107], v[120:123]
ds_read_b64_tr_b16 a[42:43], v8 offset:33280
v_mfma_f32_16x16x32_bf16 v[124:127], a[72:75], a[108:111], v[124:127]
v_mfma_f32_16x16x32_bf16 v[128:131], a[72:75], a[112:115], v[128:131]
ds_read_b64_tr_b16 a[44:45], v9 offset:32768
v_mfma_f32_16x16x32_bf16 v[132:135], a[72:75], a[116:119], v[132:135]
s_add_u32 m0, s41, 102400
s_nop 0
buffer_load_dwordx4 v4, s[8:11], s83 offen lds
v_mfma_f32_16x16x32_bf16 v[136:139], a[96:99], a[76:79], v[136:139]
ds_read_b64_tr_b16 a[46:47], v9 offset:33280
v_mfma_f32_16x16x32_bf16 v[140:143], a[100:103], a[76:79], v[140:143]
v_mfma_f32_16x16x32_bf16 v[144:147], a[76:79], a[104:107], v[144:147]
ds_read_b64_tr_b16 a[48:49], v8 offset:40960
v_mfma_f32_16x16x32_bf16 v[148:151], a[76:79], a[108:111], v[148:151]
buffer_load_dwordx4 v5, s[8:11], s84 offen offset:1024 lds
v_mfma_f32_16x16x32_bf16 v[152:155], a[76:79], a[112:115], v[152:155]
ds_read_b64_tr_b16 a[50:51], v8 offset:41472
v_mfma_f32_16x16x32_bf16 v[156:159], a[76:79], a[116:119], v[156:159]
v_mfma_f32_16x16x32_bf16 v[160:163], a[96:99], a[80:83], v[160:163]
ds_read_b64_tr_b16 a[52:53], v9 offset:40960
v_mfma_f32_16x16x32_bf16 v[164:167], a[100:103], a[80:83], v[164:167]
buffer_load_dwordx4 v4, s[8:11], s85 offen offset:2048 lds
v_mfma_f32_16x16x32_bf16 v[168:171], a[80:83], a[104:107], v[168:171]
ds_read_b64_tr_b16 a[54:55], v9 offset:41472
v_mfma_f32_16x16x32_bf16 v[172:175], a[80:83], a[108:111], v[172:175]
v_mfma_f32_16x16x32_bf16 v[176:179], a[80:83], a[112:115], v[176:179]
ds_read_b128 a[4:7], v6 offset:2048
v_mfma_f32_16x16x32_bf16 v[180:183], a[80:83], a[116:119], v[180:183]
buffer_load_dwordx4 v5, s[8:11], s86 offen offset:3072 lds
v_mfma_f32_16x16x32_bf16 v[184:187], a[96:99], a[84:87], v[184:187]
ds_read_b128 a[8:11], v6 offset:4096
v_mfma_f32_16x16x32_bf16 v[188:191], a[100:103], a[84:87], v[188:191]
s_add_u32 s8, s8, 393216
s_addc_u32 s9, s9, 0
v_mfma_f32_16x16x32_bf16 v[192:195], a[84:87], a[104:107], v[192:195]
ds_read_b128 a[12:15], v6 offset:6144
v_mfma_f32_16x16x32_bf16 v[196:199], a[84:87], a[108:111], v[196:199]
s_add_u32 m0, s40, 0
s_nop 0
buffer_load_dwordx4 v2, s[4:7], 0 offen lds
v_mfma_f32_16x16x32_bf16 v[200:203], a[84:87], a[112:115], v[200:203]
ds_read_b128 a[16:19], v6 offset:8192
v_mfma_f32_16x16x32_bf16 v[204:207], a[84:87], a[116:119], v[204:207]
s_sub_u32 s10, s10, 393216
v_mfma_f32_16x16x32_bf16 v[208:211], a[96:99], a[88:91], v[208:211]
ds_read_b128 a[20:23], v6 offset:10240
v_mfma_f32_16x16x32_bf16 v[212:215], a[100:103], a[88:91], v[212:215]
buffer_load_dwordx4 v3, s[4:7], s64 offen offset:1024 lds
v_mfma_f32_16x16x32_bf16 v[216:219], a[88:91], a[104:107], v[216:219]
ds_read_b128 a[24:27], v6 offset:12288
v_mfma_f32_16x16x32_bf16 v[220:223], a[88:91], a[108:111], v[220:223]
v_mfma_f32_16x16x32_bf16 v[224:227], a[88:91], a[112:115], v[224:227]
ds_read_b128 a[28:31], v6 offset:14336
v_mfma_f32_16x16x32_bf16 v[228:231], a[88:91], a[116:119], v[228:231]
buffer_load_dwordx4 v2, s[4:7], s65 offen offset:2048 lds
v_mfma_f32_16x16x32_bf16 v[232:235], a[96:99], a[92:95], v[232:235]
v_mfma_f32_16x16x32_bf16 v[236:239], a[100:103], a[92:95], v[236:239]
v_mfma_f32_16x16x32_bf16 v[240:243], a[92:95], a[104:107], v[240:243]
v_mfma_f32_16x16x32_bf16 v[244:247], a[92:95], a[108:111], v[244:247]
buffer_load_dwordx4 v3, s[4:7], s66 offen offset:3072 lds
v_mfma_f32_16x16x32_bf16 v[248:251], a[92:95], a[112:115], v[248:251]
v_mfma_f32_16x16x32_bf16 v[252:255], a[92:95], a[116:119], v[252:255]
s_add_u32 s42, s42, 1
s_cmp_lt_u32 s42, 6
s_cbranch_scc1 .LA0_loop
.Ltail_A0:
s_waitcnt lgkmcnt(0)
v_mfma_f32_16x16x32_bf16 v[64:67], a[32:35], a[0:3], v[64:67]
ds_read_b128 a[64:67], v7 offset:0
v_mfma_f32_16x16x32_bf16 v[68:71], a[36:39], a[0:3], v[68:71]
s_add_u32 m0, s40, 4096
s_nop 0
buffer_load_dwordx4 v2, s[4:7], s67 offen lds
v_mfma_f32_16x16x32_bf16 v[72:75], a[0:3], a[40:43], v[72:75]
ds_read_b64_tr_b16 a[96:97], v8 offset:28672
v_mfma_f32_16x16x32_bf16 v[76:79], a[0:3], a[44:47], v[76:79]
v_mfma_f32_16x16x32_bf16 v[80:83], a[0:3], a[48:51], v[80:83]
ds_read_b64_tr_b16 a[98:99], v8 offset:29184
v_mfma_f32_16x16x32_bf16 v[84:87], a[0:3], a[52:55], v[84:87]
buffer_load_dwordx4 v3, s[4:7], s68 offen offset:1024 lds
v_mfma_f32_16x16x32_bf16 v[88:91], a[32:35], a[4:7], v[88:91]
ds_read_b64_tr_b16 a[100:101], v9 offset:28672
v_mfma_f32_16x16x32_bf16 v[92:95], a[36:39], a[4:7], v[92:95]
v_add_u32 v2, 0x80, v2
v_mfma_f32_16x16x32_bf16 v[96:99], a[4:7], a[40:43], v[96:99]
ds_read_b64_tr_b16 a[102:103], v9 offset:29184
v_mfma_f32_16x16x32_bf16 v[100:103], a[4:7], a[44:47], v[100:103]
v_mfma_f32_16x16x32_bf16 v[104:107], a[4:7], a[48:51], v[104:107]
ds_read_b64_tr_b16 a[104:105], v8 offset:36864
v_mfma_f32_16x16x32_bf16 v[108:111], a[4:7], a[52:55], v[108:111]
v_add_u32 v3, 0x80, v3
v_mfma_f32_16x16x32_bf16 v[112:115], a[32:35], a[8:11], v[112:115]
ds_read_b64_tr_b16 a[106:107], v8 offset:37376
v_mfma_f32_16x16x32_bf16 v[116:119], a[36:39], a[8:11], v[116:119]
v_mfma_f32_16x16x32_bf16 v[120:123], a[8:11], a[40:43], v[120:123]
ds_read_b64_tr_b16 a[108:109], v9 offset:36864
v_mfma_f32_16x16x32_bf16 v[124:127], a[8:11], a[44:47], v[124:127]
s_mov_b32 s16, s87
v_mfma_f32_16x16x32_bf16 v[128:131], a[8:11], a[48:51], v[128:131]
ds_read_b64_tr_b16 a[110:111], v9 offset:37376
v_mfma_f32_16x16x32_bf16 v[132:135], a[8:11], a[52:55], v[132:135]
v_mfma_f32_16x16x32_bf16 v[136:139], a[32:35], a[12:15], v[136:139]
ds_read_b64_tr_b16 a[112:113], v8 offset:45056
v_mfma_f32_16x16x32_bf16 v[140:143], a[36:39], a[12:15], v[140:143]
s_mov_b32 s87, s88
v_mfma_f32_16x16x32_bf16 v[144:147], a[12:15], a[40:43], v[144:147]
ds_read_b64_tr_b16 a[114:115], v8 offset:45568
v_mfma_f32_16x16x32_bf16 v[148:151], a[12:15], a[44:47], v[148:151]
v_mfma_f32_16x16x32_bf16 v[152:155], a[12:15], a[48:51], v[152:155]
ds_read_b64_tr_b16 a[116:117], v9 offset:45056
v_mfma_f32_16x16x32_bf16 v[156:159], a[12:15], a[52:55], v[156:159]
s_mov_b32 s88, s89
v_mfma_f32_16x16x32_bf16 v[160:163], a[32:35], a[16:19], v[160:163]
ds_read_b64_tr_b16 a[118:119], v9 offset:45568
v_mfma_f32_16x16x32_bf16 v[164:167], a[36:39], a[16:19], v[164:167]
v_mfma_f32_16x16x32_bf16 v[168:171], a[16:19], a[40:43], v[168:171]
ds_read_b128 a[68:71], v7 offset:2048
v_mfma_f32_16x16x32_bf16 v[172:175], a[16:19], a[44:47], v[172:175]
s_mov_b32 s89, s16
v_mfma_f32_16x16x32_bf16 v[176:179], a[16:19], a[48:51], v[176:179]
ds_read_b128 a[72:75], v7 offset:4096
v_mfma_f32_16x16x32_bf16 v[180:183], a[16:19], a[52:55], v[180:183]
v_mfma_f32_16x16x32_bf16 v[184:187], a[32:35], a[20:23], v[184:187]
ds_read_b128 a[76:79], v7 offset:6144
v_mfma_f32_16x16x32_bf16 v[188:191], a[36:39], a[20:23], v[188:191]
s_mov_b32 s40, s87
v_mfma_f32_16x16x32_bf16 v[192:195], a[20:23], a[40:43], v[192:195]
ds_read_b128 a[80:83], v7 offset:8192
v_mfma_f32_16x16x32_bf16 v[196:199], a[20:23], a[44:47], v[196:199]
v_mfma_f32_16x16x32_bf16 v[200:203], a[20:23], a[48:51], v[200:203]
ds_read_b128 a[84:87], v7 offset:10240
v_mfma_f32_16x16x32_bf16 v[204:207], a[20:23], a[52:55], v[204:207]
v_mfma_f32_16x16x32_bf16 v[208:211], a[32:35], a[24:27], v[208:211]
ds_read_b128 a[88:91], v7 offset:12288
v_mfma_f32_16x16x32_bf16 v[212:215], a[36:39], a[24:27], v[212:215]
v_mfma_f32_16x16x32_bf16 v[216:219], a[24:27], a[40:43], v[216:219]
ds_read_b128 a[92:95], v7 offset:14336
v_mfma_f32_16x16x32_bf16 v[220:223], a[24:27], a[44:47], v[220:223]
v_mfma_f32_16x16x32_bf16 v[224:227], a[24:27], a[48:51], v[224:227]
v_add_u32 v7, s92, v7
v_mfma_f32_16x16x32_bf16 v[228:231], a[24:27], a[52:55], v[228:231]
v_add_u32 v6, s92, v6
v_mfma_f32_16x16x32_bf16 v[232:235], a[32:35], a[28:31], v[232:235]
s_mov_b32 s17, s92
v_mfma_f32_16x16x32_bf16 v[236:239], a[36:39], a[28:31], v[236:239]
s_mov_b32 s92, s93
v_mfma_f32_16x16x32_bf16 v[240:243], a[28:31], a[40:43], v[240:243]
s_mov_b32 s93, s94
v_mfma_f32_16x16x32_bf16 v[244:247], a[28:31], a[44:47], v[244:247]
s_mov_b32 s94, s17
v_mfma_f32_16x16x32_bf16 v[248:251], a[28:31], a[48:51], v[248:251]
v_mfma_f32_16x16x32_bf16 v[252:255], a[28:31], a[52:55], v[252:255]
s_waitcnt lgkmcnt(0)
v_mfma_f32_16x16x32_bf16 v[64:67], a[96:99], a[64:67], v[64:67]
s_waitcnt vmcnt(6)
s_barrier
v_mfma_f32_16x16x32_bf16 v[68:71], a[100:103], a[64:67], v[68:71]
s_add_u32 m0, s41, 122880
s_nop 0
buffer_load_dwordx4 v4, s[8:11], 0 offen lds
v_mfma_f32_16x16x32_bf16 v[72:75], a[64:67], a[104:107], v[72:75]
ds_read_b128 a[0:3], v6 offset:0
v_mfma_f32_16x16x32_bf16 v[76:79], a[64:67], a[108:111], v[76:79]
v_mfma_f32_16x16x32_bf16 v[80:83], a[64:67], a[112:115], v[80:83]
ds_read_b64_tr_b16 a[32:33], v8 offset:0
v_mfma_f32_16x16x32_bf16 v[84:87], a[64:67], a[116:119], v[84:87]
buffer_load_dwordx4 v5, s[8:11], s80 offen offset:1024 lds
v_mfma_f32_16x16x32_bf16 v[88:91], a[96:99], a[68:71], v[88:91]
ds_read_b64_tr_b16 a[34:35], v8 offset:512
v_mfma_f32_16x16x32_bf16 v[92:95], a[100:103], a[68:71], v[92:95]
v_mfma_f32_16x16x32_bf16 v[96:99], a[68:71], a[104:107], v[96:99]
ds_read_b64_tr_b16 a[36:37], v9 offset:0
v_mfma_f32_16x16x32_bf16 v[100:103], a[68:71], a[108:111], v[100:103]
buffer_load_dwordx4 v4, s[8:11], s81 offen offset:2048 lds
v_mfma_f32_16x16x32_bf16 v[104:107], a[68:71], a[112:115], v[104:107]
ds_read_b64_tr_b16 a[38:39], v9 offset:512
v_mfma_f32_16x16x32_bf16 v[108:111], a[68:71], a[116:119], v[108:111]
v_mfma_f32_16x16x32_bf16 v[112:115], a[96:99], a[72:75], v[112:115]
ds_read_b64_tr_b16 a[40:41], v8 offset:8192
v_mfma_f32_16x16x32_bf16 v[116:119], a[100:103], a[72:75], v[116:119]
buffer_load_dwordx4 v5, s[8:11], s82 offen offset:3072 lds
v_mfma_f32_16x16x32_bf16 v[120:123], a[72:75], a[104:107], v[120:123]
ds_read_b64_tr_b16 a[42:43], v8 offset:8704
v_mfma_f32_16x16x32_bf16 v[124:127], a[72:75], a[108:111], v[124:127]
v_mfma_f32_16x16x32_bf16 v[128:131], a[72:75], a[112:115], v[128:131]
ds_read_b64_tr_b16 a[44:45], v9 offset:8192
v_mfma_f32_16x16x32_bf16 v[132:135], a[72:75], a[116:119], v[132:135]
s_add_u32 m0, s41, 126976
s_nop 0
buffer_load_dwordx4 v4, s[8:11], s83 offen lds
v_mfma_f32_16x16x32_bf16 v[136:139], a[96:99], a[76:79], v[136:139]
ds_read_b64_tr_b16 a[46:47], v9 offset:8704
v_mfma_f32_16x16x32_bf16 v[140:143], a[100:103], a[76:79], v[140:143]
v_mfma_f32_16x16x32_bf16 v[144:147], a[76:79], a[104:107], v[144:147]
ds_read_b64_tr_b16 a[48:49], v8 offset:16384
v_mfma_f32_16x16x32_bf16 v[148:151], a[76:79], a[108:111], v[148:151]
buffer_load_dwordx4 v5, s[8:11], s84 offen offset:1024 lds
v_mfma_f32_16x16x32_bf16 v[152:155], a[76:79], a[112:115], v[152:155]
ds_read_b64_tr_b16 a[50:51], v8 offset:16896
v_mfma_f32_16x16x32_bf16 v[156:159], a[76:79], a[116:119], v[156:159]
v_mfma_f32_16x16x32_bf16 v[160:163], a[96:99], a[80:83], v[160:163]
ds_read_b64_tr_b16 a[52:53], v9 offset:16384
v_mfma_f32_16x16x32_bf16 v[164:167], a[100:103], a[80:83], v[164:167]
buffer_load_dwordx4 v4, s[8:11], s85 offen offset:2048 lds
v_mfma_f32_16x16x32_bf16 v[168:171], a[80:83], a[104:107], v[168:171]
ds_read_b64_tr_b16 a[54:55], v9 offset:16896
v_mfma_f32_16x16x32_bf16 v[172:175], a[80:83], a[108:111], v[172:175]
v_mfma_f32_16x16x32_bf16 v[176:179], a[80:83], a[112:115], v[176:179]
ds_read_b128 a[4:7], v6 offset:2048
v_mfma_f32_16x16x32_bf16 v[180:183], a[80:83], a[116:119], v[180:183]
buffer_load_dwordx4 v5, s[8:11], s86 offen offset:3072 lds
v_mfma_f32_16x16x32_bf16 v[184:187], a[96:99], a[84:87], v[184:187]
ds_read_b128 a[8:11], v6 offset:4096
v_mfma_f32_16x16x32_bf16 v[188:191], a[100:103], a[84:87], v[188:191]
s_add_u32 s8, s8, 393216
s_addc_u32 s9, s9, 0
v_mfma_f32_16x16x32_bf16 v[192:195], a[84:87], a[104:107], v[192:195]
ds_read_b128 a[12:15], v6 offset:6144
v_mfma_f32_16x16x32_bf16 v[196:199], a[84:87], a[108:111], v[196:199]
v_mfma_f32_16x16x32_bf16 v[200:203], a[84:87], a[112:115], v[200:203]
ds_read_b128 a[16:19], v6 offset:8192
v_mfma_f32_16x16x32_bf16 v[204:207], a[84:87], a[116:119], v[204:207]
s_sub_u32 s10, s10, 393216
v_mfma_f32_16x16x32_bf16 v[208:211], a[96:99], a[88:91], v[208:211]
ds_read_b128 a[20:23], v6 offset:10240
v_mfma_f32_16x16x32_bf16 v[212:215], a[100:103], a[88:91], v[212:215]
v_mfma_f32_16x16x32_bf16 v[216:219], a[88:91], a[104:107], v[216:219]
ds_read_b128 a[24:27], v6 offset:12288
v_mfma_f32_16x16x32_bf16 v[220:223], a[88:91], a[108:111], v[220:223]
v_mfma_f32_16x16x32_bf16 v[224:227], a[88:91], a[112:115], v[224:227]
ds_read_b128 a[28:31], v6 offset:14336
v_mfma_f32_16x16x32_bf16 v[228:231], a[88:91], a[116:119], v[228:231]
v_mfma_f32_16x16x32_bf16 v[232:235], a[96:99], a[92:95], v[232:235]
v_mfma_f32_16x16x32_bf16 v[236:239], a[100:103], a[92:95], v[236:239]
v_mfma_f32_16x16x32_bf16 v[240:243], a[92:95], a[104:107], v[240:243]
v_mfma_f32_16x16x32_bf16 v[244:247], a[92:95], a[108:111], v[244:247]
v_mfma_f32_16x16x32_bf16 v[248:251], a[92:95], a[112:115], v[248:251]
v_mfma_f32_16x16x32_bf16 v[252:255], a[92:95], a[116:119], v[252:255]
s_waitcnt lgkmcnt(0)
v_mfma_f32_16x16x32_bf16 v[64:67], a[32:35], a[0:3], v[64:67]
ds_read_b128 a[64:67], v7 offset:0
v_mfma_f32_16x16x32_bf16 v[68:71], a[36:39], a[0:3], v[68:71]
v_mfma_f32_16x16x32_bf16 v[72:75], a[0:3], a[40:43], v[72:75]
ds_read_b64_tr_b16 a[96:97], v8 offset:4096
v_mfma_f32_16x16x32_bf16 v[76:79], a[0:3], a[44:47], v[76:79]
v_mfma_f32_16x16x32_bf16 v[80:83], a[0:3], a[48:51], v[80:83]
ds_read_b64_tr_b16 a[98:99], v8 offset:4608
v_mfma_f32_16x16x32_bf16 v[84:87], a[0:3], a[52:55], v[84:87]
v_mfma_f32_16x16x32_bf16 v[88:91], a[32:35], a[4:7], v[88:91]
ds_read_b64_tr_b16 a[100:101], v9 offset:4096
v_mfma_f32_16x16x32_bf16 v[92:95], a[36:39], a[4:7], v[92:95]
v_mfma_f32_16x16x32_bf16 v[96:99], a[4:7], a[40:43], v[96:99]
ds_read_b64_tr_b16 a[102:103], v9 offset:4608
v_mfma_f32_16x16x32_bf16 v[100:103], a[4:7], a[44:47], v[100:103]
v_mfma_f32_16x16x32_bf16 v[104:107], a[4:7], a[48:51], v[104:107]
ds_read_b64_tr_b16 a[104:105], v8 offset:12288
v_mfma_f32_16x16x32_bf16 v[108:111], a[4:7], a[52:55], v[108:111]
v_mfma_f32_16x16x32_bf16 v[112:115], a[32:35], a[8:11], v[112:115]
ds_read_b64_tr_b16 a[106:107], v8 offset:12800
v_mfma_f32_16x16x32_bf16 v[116:119], a[36:39], a[8:11], v[116:119]
v_mfma_f32_16x16x32_bf16 v[120:123], a[8:11], a[40:43], v[120:123]
ds_read_b64_tr_b16 a[108:109], v9 offset:12288
v_mfma_f32_16x16x32_bf16 v[124:127], a[8:11], a[44:47], v[124:127]
v_mfma_f32_16x16x32_bf16 v[128:131], a[8:11], a[48:51], v[128:131]
ds_read_b64_tr_b16 a[110:111], v9 offset:12800
v_mfma_f32_16x16x32_bf16 v[132:135], a[8:11], a[52:55], v[132:135]
v_mfma_f32_16x16x32_bf16 v[136:139], a[32:35], a[12:15], v[136:139]
ds_read_b64_tr_b16 a[112:113], v8 offset:20480
v_mfma_f32_16x16x32_bf16 v[140:143], a[36:39], a[12:15], v[140:143]
v_mfma_f32_16x16x32_bf16 v[144:147], a[12:15], a[40:43], v[144:147]
ds_read_b64_tr_b16 a[114:115], v8 offset:20992
v_mfma_f32_16x16x32_bf16 v[148:151], a[12:15], a[44:47], v[148:151]
v_mfma_f32_16x16x32_bf16 v[152:155], a[12:15], a[48:51], v[152:155]
ds_read_b64_tr_b16 a[116:117], v9 offset:20480
v_mfma_f32_16x16x32_bf16 v[156:159], a[12:15], a[52:55], v[156:159]
v_mfma_f32_16x16x32_bf16 v[160:163], a[32:35], a[16:19], v[160:163]
ds_read_b64_tr_b16 a[118:119], v9 offset:20992
v_mfma_f32_16x16x32_bf16 v[164:167], a[36:39], a[16:19], v[164:167]
v_mfma_f32_16x16x32_bf16 v[168:171], a[16:19], a[40:43], v[168:171]
ds_read_b128 a[68:71], v7 offset:2048
v_mfma_f32_16x16x32_bf16 v[172:175], a[16:19], a[44:47], v[172:175]
v_mfma_f32_16x16x32_bf16 v[176:179], a[16:19], a[48:51], v[176:179]
ds_read_b128 a[72:75], v7 offset:4096
v_mfma_f32_16x16x32_bf16 v[180:183], a[16:19], a[52:55], v[180:183]
v_mfma_f32_16x16x32_bf16 v[184:187], a[32:35], a[20:23], v[184:187]
ds_read_b128 a[76:79], v7 offset:6144
v_mfma_f32_16x16x32_bf16 v[188:191], a[36:39], a[20:23], v[188:191]
v_mfma_f32_16x16x32_bf16 v[192:195], a[20:23], a[40:43], v[192:195]
ds_read_b128 a[80:83], v7 offset:8192
v_mfma_f32_16x16x32_bf16 v[196:199], a[20:23], a[44:47], v[196:199]
v_mfma_f32_16x16x32_bf16 v[200:203], a[20:23], a[48:51], v[200:203]
ds_read_b128 a[84:87], v7 offset:10240
v_mfma_f32_16x16x32_bf16 v[204:207], a[20:23], a[52:55], v[204:207]
v_mfma_f32_16x16x32_bf16 v[208:211], a[32:35], a[24:27], v[208:211]
ds_read_b128 a[88:91], v7 offset:12288
v_mfma_f32_16x16x32_bf16 v[212:215], a[36:39], a[24:27], v[212:215]
v_mfma_f32_16x16x32_bf16 v[216:219], a[24:27], a[40:43], v[216:219]
ds_read_b128 a[92:95], v7 offset:14336
v_mfma_f32_16x16x32_bf16 v[220:223], a[24:27], a[44:47], v[220:223]
v_mfma_f32_16x16x32_bf16 v[224:227], a[24:27], a[48:51], v[224:227]
v_add_u32 v7, s92, v7
v_mfma_f32_16x16x32_bf16 v[228:231], a[24:27], a[52:55], v[228:231]
v_add_u32 v6, s92, v6
v_mfma_f32_16x16x32_bf16 v[232:235], a[32:35], a[28:31], v[232:235]
s_mov_b32 s17, s92
v_mfma_f32_16x16x32_bf16 v[236:239], a[36:39], a[28:31], v[236:239]
s_mov_b32 s92, s93
v_mfma_f32_16x16x32_bf16 v[240:243], a[28:31], a[40:43], v[240:243]
s_mov_b32 s93, s94
v_mfma_f32_16x16x32_bf16 v[244:247], a[28:31], a[44:47], v[244:247]
s_mov_b32 s94, s17
v_mfma_f32_16x16x32_bf16 v[248:251], a[28:31], a[48:51], v[248:251]
v_mfma_f32_16x16x32_bf16 v[252:255], a[28:31], a[52:55], v[252:255]
s_waitcnt lgkmcnt(0)
v_mfma_f32_16x16x32_bf16 v[64:67], a[96:99], a[64:67], v[64:67]
s_waitcnt vmcnt(0)
s_barrier
v_mfma_f32_16x16x32_bf16 v[68:71], a[100:103], a[64:67], v[68:71]
v_mfma_f32_16x16x32_bf16 v[72:75], a[64:67], a[104:107], v[72:75]
ds_read_b128 a[0:3], v6 offset:0
v_mfma_f32_16x16x32_bf16 v[76:79], a[64:67], a[108:111], v[76:79]
v_mfma_f32_16x16x32_bf16 v[80:83], a[64:67], a[112:115], v[80:83]
ds_read_b64_tr_b16 a[32:33], v8 offset:24576
v_mfma_f32_16x16x32_bf16 v[84:87], a[64:67], a[116:119], v[84:87]
v_mfma_f32_16x16x32_bf16 v[88:91], a[96:99], a[68:71], v[88:91]
ds_read_b64_tr_b16 a[34:35], v8 offset:25088
v_mfma_f32_16x16x32_bf16 v[92:95], a[100:103], a[68:71], v[92:95]
v_mfma_f32_16x16x32_bf16 v[96:99], a[68:71], a[104:107], v[96:99]
ds_read_b64_tr_b16 a[36:37], v9 offset:24576
v_mfma_f32_16x16x32_bf16 v[100:103], a[68:71], a[108:111], v[100:103]
v_mfma_f32_16x16x32_bf16 v[104:107], a[68:71], a[112:115], v[104:107]
ds_read_b64_tr_b16 a[38:39], v9 offset:25088
v_mfma_f32_16x16x32_bf16 v[108:111], a[68:71], a[116:119], v[108:111]
v_mfma_f32_16x16x32_bf16 v[112:115], a[96:99], a[72:75], v[112:115]
ds_read_b64_tr_b16 a[40:41], v8 offset:32768
v_mfma_f32_16x16x32_bf16 v[116:119], a[100:103], a[72:75], v[116:119]
v_mfma_f32_16x16x32_bf16 v[120:123], a[72:75], a[104:107], v[120:123]
ds_read_b64_tr_b16 a[42:43], v8 offset:33280
v_mfma_f32_16x16x32_bf16 v[124:127], a[72:75], a[108:111], v[124:127]
v_mfma_f32_16x16x32_bf16 v[128:131], a[72:75], a[112:115], v[128:131]
ds_read_b64_tr_b16 a[44:45], v9 offset:32768
v_mfma_f32_16x16x32_bf16 v[132:135], a[72:75], a[116:119], v[132:135]
v_mfma_f32_16x16x32_bf16 v[136:139], a[96:99], a[76:79], v[136:139]
ds_read_b64_tr_b16 a[46:47], v9 offset:33280
v_mfma_f32_16x16x32_bf16 v[140:143], a[100:103], a[76:79], v[140:143]
v_mfma_f32_16x16x32_bf16 v[144:147], a[76:79], a[104:107], v[144:147]
ds_read_b64_tr_b16 a[48:49], v8 offset:40960
v_mfma_f32_16x16x32_bf16 v[148:151], a[76:79], a[108:111], v[148:151]
v_mfma_f32_16x16x32_bf16 v[152:155], a[76:79], a[112:115], v[152:155]
ds_read_b64_tr_b16 a[50:51], v8 offset:41472
v_mfma_f32_16x16x32_bf16 v[156:159], a[76:79], a[116:119], v[156:159]
v_mfma_f32_16x16x32_bf16 v[160:163], a[96:99], a[80:83], v[160:163]
ds_read_b64_tr_b16 a[52:53], v9 offset:40960
v_mfma_f32_16x16x32_bf16 v[164:167], a[100:103], a[80:83], v[164:167]
v_mfma_f32_16x16x32_bf16 v[168:171], a[80:83], a[104:107], v[168:171]
ds_read_b64_tr_b16 a[54:55], v9 offset:41472
v_mfma_f32_16x16x32_bf16 v[172:175], a[80:83], a[108:111], v[172:175]
v_mfma_f32_16x16x32_bf16 v[176:179], a[80:83], a[112:115], v[176:179]
ds_read_b128 a[4:7], v6 offset:2048
v_mfma_f32_16x16x32_bf16 v[180:183], a[80:83], a[116:119], v[180:183]
v_mfma_f32_16x16x32_bf16 v[184:187], a[96:99], a[84:87], v[184:187]
ds_read_b128 a[8:11], v6 offset:4096
v_mfma_f32_16x16x32_bf16 v[188:191], a[100:103], a[84:87], v[188:191]
v_mfma_f32_16x16x32_bf16 v[192:195], a[84:87], a[104:107], v[192:195]
ds_read_b128 a[12:15], v6 offset:6144
v_mfma_f32_16x16x32_bf16 v[196:199], a[84:87], a[108:111], v[196:199]
v_mfma_f32_16x16x32_bf16 v[200:203], a[84:87], a[112:115], v[200:203]
ds_read_b128 a[16:19], v6 offset:8192
v_mfma_f32_16x16x32_bf16 v[204:207], a[84:87], a[116:119], v[204:207]
v_mfma_f32_16x16x32_bf16 v[208:211], a[96:99], a[88:91], v[208:211]
ds_read_b128 a[20:23], v6 offset:10240
v_mfma_f32_16x16x32_bf16 v[212:215], a[100:103], a[88:91], v[212:215]
v_mfma_f32_16x16x32_bf16 v[216:219], a[88:91], a[104:107], v[216:219]
ds_read_b128 a[24:27], v6 offset:12288
v_mfma_f32_16x16x32_bf16 v[220:223], a[88:91], a[108:111], v[220:223]
v_mfma_f32_16x16x32_bf16 v[224:227], a[88:91], a[112:115], v[224:227]
ds_read_b128 a[28:31], v6 offset:14336
v_mfma_f32_16x16x32_bf16 v[228:231], a[88:91], a[116:119], v[228:231]
v_mfma_f32_16x16x32_bf16 v[232:235], a[96:99], a[92:95], v[232:235]
v_mfma_f32_16x16x32_bf16 v[236:239], a[100:103], a[92:95], v[236:239]
v_mfma_f32_16x16x32_bf16 v[240:243], a[92:95], a[104:107], v[240:243]
v_mfma_f32_16x16x32_bf16 v[244:247], a[92:95], a[108:111], v[244:247]
v_mfma_f32_16x16x32_bf16 v[248:251], a[92:95], a[112:115], v[248:251]
v_mfma_f32_16x16x32_bf16 v[252:255], a[92:95], a[116:119], v[252:255]
s_waitcnt lgkmcnt(0)
v_mfma_f32_16x16x32_bf16 v[64:67], a[32:35], a[0:3], v[64:67]
ds_read_b128 a[64:67], v7 offset:0
v_mfma_f32_16x16x32_bf16 v[68:71], a[36:39], a[0:3], v[68:71]
v_mfma_f32_16x16x32_bf16 v[72:75], a[0:3], a[40:43], v[72:75]
ds_read_b64_tr_b16 a[96:97], v8 offset:28672
v_mfma_f32_16x16x32_bf16 v[76:79], a[0:3], a[44:47], v[76:79]
v_mfma_f32_16x16x32_bf16 v[80:83], a[0:3], a[48:51], v[80:83]
ds_read_b64_tr_b16 a[98:99], v8 offset:29184
v_mfma_f32_16x16x32_bf16 v[84:87], a[0:3], a[52:55], v[84:87]
v_mfma_f32_16x16x32_bf16 v[88:91], a[32:35], a[4:7], v[88:91]
ds_read_b64_tr_b16 a[100:101], v9 offset:28672
v_mfma_f32_16x16x32_bf16 v[92:95], a[36:39], a[4:7], v[92:95]
v_mfma_f32_16x16x32_bf16 v[96:99], a[4:7], a[40:43], v[96:99]
ds_read_b64_tr_b16 a[102:103], v9 offset:29184
v_mfma_f32_16x16x32_bf16 v[100:103], a[4:7], a[44:47], v[100:103]
v_mfma_f32_16x16x32_bf16 v[104:107], a[4:7], a[48:51], v[104:107]
ds_read_b64_tr_b16 a[104:105], v8 offset:36864
v_mfma_f32_16x16x32_bf16 v[108:111], a[4:7], a[52:55], v[108:111]
v_mfma_f32_16x16x32_bf16 v[112:115], a[32:35], a[8:11], v[112:115]
ds_read_b64_tr_b16 a[106:107], v8 offset:37376
v_mfma_f32_16x16x32_bf16 v[116:119], a[36:39], a[8:11], v[116:119]
v_mfma_f32_16x16x32_bf16 v[120:123], a[8:11], a[40:43], v[120:123]
ds_read_b64_tr_b16 a[108:109], v9 offset:36864
v_mfma_f32_16x16x32_bf16 v[124:127], a[8:11], a[44:47], v[124:127]
v_mfma_f32_16x16x32_bf16 v[128:131], a[8:11], a[48:51], v[128:131]
ds_read_b64_tr_b16 a[110:111], v9 offset:37376
v_mfma_f32_16x16x32_bf16 v[132:135], a[8:11], a[52:55], v[132:135]
v_mfma_f32_16x16x32_bf16 v[136:139], a[32:35], a[12:15], v[136:139]
ds_read_b64_tr_b16 a[112:113], v8 offset:45056
v_mfma_f32_16x16x32_bf16 v[140:143], a[36:39], a[12:15], v[140:143]
v_mfma_f32_16x16x32_bf16 v[144:147], a[12:15], a[40:43], v[144:147]
ds_read_b64_tr_b16 a[114:115], v8 offset:45568
v_mfma_f32_16x16x32_bf16 v[148:151], a[12:15], a[44:47], v[148:151]
v_mfma_f32_16x16x32_bf16 v[152:155], a[12:15], a[48:51], v[152:155]
ds_read_b64_tr_b16 a[116:117], v9 offset:45056
v_mfma_f32_16x16x32_bf16 v[156:159], a[12:15], a[52:55], v[156:159]
v_mfma_f32_16x16x32_bf16 v[160:163], a[32:35], a[16:19], v[160:163]
ds_read_b64_tr_b16 a[118:119], v9 offset:45568
v_mfma_f32_16x16x32_bf16 v[164:167], a[36:39], a[16:19], v[164:167]
v_mfma_f32_16x16x32_bf16 v[168:171], a[16:19], a[40:43], v[168:171]
ds_read_b128 a[68:71], v7 offset:2048
v_mfma_f32_16x16x32_bf16 v[172:175], a[16:19], a[44:47], v[172:175]
v_mfma_f32_16x16x32_bf16 v[176:179], a[16:19], a[48:51], v[176:179]
ds_read_b128 a[72:75], v7 offset:4096
v_mfma_f32_16x16x32_bf16 v[180:183], a[16:19], a[52:55], v[180:183]
v_mfma_f32_16x16x32_bf16 v[184:187], a[32:35], a[20:23], v[184:187]
ds_read_b128 a[76:79], v7 offset:6144
v_mfma_f32_16x16x32_bf16 v[188:191], a[36:39], a[20:23], v[188:191]
v_mfma_f32_16x16x32_bf16 v[192:195], a[20:23], a[40:43], v[192:195]
ds_read_b128 a[80:83], v7 offset:8192
v_mfma_f32_16x16x32_bf16 v[196:199], a[20:23], a[44:47], v[196:199]
v_mfma_f32_16x16x32_bf16 v[200:203], a[20:23], a[48:51], v[200:203]
ds_read_b128 a[84:87], v7 offset:10240
v_mfma_f32_16x16x32_bf16 v[204:207], a[20:23], a[52:55], v[204:207]
v_mfma_f32_16x16x32_bf16 v[208:211], a[32:35], a[24:27], v[208:211]
ds_read_b128 a[88:91], v7 offset:12288
v_mfma_f32_16x16x32_bf16 v[212:215], a[36:39], a[24:27], v[212:215]
v_mfma_f32_16x16x32_bf16 v[216:219], a[24:27], a[40:43], v[216:219]
ds_read_b128 a[92:95], v7 offset:14336
v_mfma_f32_16x16x32_bf16 v[220:223], a[24:27], a[44:47], v[220:223]
v_mfma_f32_16x16x32_bf16 v[224:227], a[24:27], a[48:51], v[224:227]
v_add_u32 v7, s92, v7
v_mfma_f32_16x16x32_bf16 v[228:231], a[24:27], a[52:55], v[228:231]
v_add_u32 v6, s92, v6
v_mfma_f32_16x16x32_bf16 v[232:235], a[32:35], a[28:31], v[232:235]
s_mov_b32 s17, s92
v_mfma_f32_16x16x32_bf16 v[236:239], a[36:39], a[28:31], v[236:239]
s_mov_b32 s92, s93
v_mfma_f32_16x16x32_bf16 v[240:243], a[28:31], a[40:43], v[240:243]
s_mov_b32 s93, s94
v_mfma_f32_16x16x32_bf16 v[244:247], a[28:31], a[44:47], v[244:247]
s_mov_b32 s94, s17
v_mfma_f32_16x16x32_bf16 v[248:251], a[28:31], a[48:51], v[248:251]
v_mfma_f32_16x16x32_bf16 v[252:255], a[28:31], a[52:55], v[252:255]
s_waitcnt lgkmcnt(0)
v_mfma_f32_16x16x32_bf16 v[64:67], a[96:99], a[64:67], v[64:67]
v_mfma_f32_16x16x32_bf16 v[68:71], a[100:103], a[64:67], v[68:71]
v_mfma_f32_16x16x32_bf16 v[72:75], a[64:67], a[104:107], v[72:75]
v_mfma_f32_16x16x32_bf16 v[76:79], a[64:67], a[108:111], v[76:79]
v_mfma_f32_16x16x32_bf16 v[80:83], a[64:67], a[112:115], v[80:83]
v_mfma_f32_16x16x32_bf16 v[84:87], a[64:67], a[116:119], v[84:87]
v_mfma_f32_16x16x32_bf16 v[88:91], a[96:99], a[68:71], v[88:91]
v_mfma_f32_16x16x32_bf16 v[92:95], a[100:103], a[68:71], v[92:95]
v_mfma_f32_16x16x32_bf16 v[96:99], a[68:71], a[104:107], v[96:99]
v_mfma_f32_16x16x32_bf16 v[100:103], a[68:71], a[108:111], v[100:103]
v_mfma_f32_16x16x32_bf16 v[104:107], a[68:71], a[112:115], v[104:107]
v_mfma_f32_16x16x32_bf16 v[108:111], a[68:71], a[116:119], v[108:111]
v_mfma_f32_16x16x32_bf16 v[112:115], a[96:99], a[72:75], v[112:115]
v_mfma_f32_16x16x32_bf16 v[116:119], a[100:103], a[72:75], v[116:119]
v_mfma_f32_16x16x32_bf16 v[120:123], a[72:75], a[104:107], v[120:123]
v_mfma_f32_16x16x32_bf16 v[124:127], a[72:75], a[108:111], v[124:127]
v_mfma_f32_16x16x32_bf16 v[128:131], a[72:75], a[112:115], v[128:131]
v_mfma_f32_16x16x32_bf16 v[132:135], a[72:75], a[116:119], v[132:135]
v_mfma_f32_16x16x32_bf16 v[136:139], a[96:99], a[76:79], v[136:139]
v_mfma_f32_16x16x32_bf16 v[140:143], a[100:103], a[76:79], v[140:143]
v_mfma_f32_16x16x32_bf16 v[144:147], a[76:79], a[104:107], v[144:147]
v_mfma_f32_16x16x32_bf16 v[148:151], a[76:79], a[108:111], v[148:151]
v_mfma_f32_16x16x32_bf16 v[152:155], a[76:79], a[112:115], v[152:155]
v_mfma_f32_16x16x32_bf16 v[156:159], a[76:79], a[116:119], v[156:159]
v_mfma_f32_16x16x32_bf16 v[160:163], a[96:99], a[80:83], v[160:163]
v_mfma_f32_16x16x32_bf16 v[164:167], a[100:103], a[80:83], v[164:167]
v_mfma_f32_16x16x32_bf16 v[168:171], a[80:83], a[104:107], v[168:171]
v_mfma_f32_16x16x32_bf16 v[172:175], a[80:83], a[108:111], v[172:175]
v_mfma_f32_16x16x32_bf16 v[176:179], a[80:83], a[112:115], v[176:179]
v_mfma_f32_16x16x32_bf16 v[180:183], a[80:83], a[116:119], v[180:183]
v_mfma_f32_16x16x32_bf16 v[184:187], a[96:99], a[84:87], v[184:187]
v_mfma_f32_16x16x32_bf16 v[188:191], a[100:103], a[84:87], v[188:191]
v_mfma_f32_16x16x32_bf16 v[192:195], a[84:87], a[104:107], v[192:195]
v_mfma_f32_16x16x32_bf16 v[196:199], a[84:87], a[108:111], v[196:199]
v_mfma_f32_16x16x32_bf16 v[200:203], a[84:87], a[112:115], v[200:203]
v_mfma_f32_16x16x32_bf16 v[204:207], a[84:87], a[116:119], v[204:207]
v_mfma_f32_16x16x32_bf16 v[208:211], a[96:99], a[88:91], v[208:211]
v_mfma_f32_16x16x32_bf16 v[212:215], a[100:103], a[88:91], v[212:215]
v_mfma_f32_16x16x32_bf16 v[216:219], a[88:91], a[104:107], v[216:219]
v_mfma_f32_16x16x32_bf16 v[220:223], a[88:91], a[108:111], v[220:223]
v_mfma_f32_16x16x32_bf16 v[224:227], a[88:91], a[112:115], v[224:227]
v_mfma_f32_16x16x32_bf16 v[228:231], a[88:91], a[116:119], v[228:231]
v_mfma_f32_16x16x32_bf16 v[232:235], a[96:99], a[92:95], v[232:235]
v_mfma_f32_16x16x32_bf16 v[236:239], a[100:103], a[92:95], v[236:239]
v_mfma_f32_16x16x32_bf16 v[240:243], a[92:95], a[104:107], v[240:243]
v_mfma_f32_16x16x32_bf16 v[244:247], a[92:95], a[108:111], v[244:247]
v_mfma_f32_16x16x32_bf16 v[248:251], a[92:95], a[112:115], v[248:251]
v_mfma_f32_16x16x32_bf16 v[252:255], a[92:95], a[116:119], v[252:255]
s_branch .Lph2_A
.Lp3:
s_mov_b32 s71, 131072
s_mov_b32 s72, 146432
s_mov_b32 s73, 161792
s_mov_b32 s74, 177152
s_mov_b32 s75, 196608
s_mov_b32 s76, 211968
s_mov_b32 s92, 32768
s_mov_b32 s93, 32768
s_mov_b32 s94, -65536
s_mov_b32 s99, 393216

s_mov_b32 s12, s62
s_mov_b32 s13, s63
s_mov_b32 s14, 0x10000000
s_mov_b32 s15, 0x20000
v_and_b32 v13, 7, v0
v_and_b32 v14, 1, v0
s_sub_u32 s24, s44, 1
s_max_i32 s24, s24, 0
v_mov_b32 v15, s24
v_mov_b32 v16, s44
v_cmp_eq_u32 vcc, 0, v14
s_cmp_eq_u32 s43, 0
s_cselect_b32 s25, 0x4000, 0
v_cndmask_b32 v15, v15, v16, vcc
s_cselect_b64 vcc, -1, 0
s_lshl_b32 s26, s45, 7
s_add_u32 s25, s25, s26
s_add_u32 s25, s25, 29360128
v_cndmask_b32 v15, v15, v13, vcc
v_lshlrev_b32 v15, 11, v15
v_bfe_u32 v14, v0, 1, 1
v_lshlrev_b32 v14, 15, v14
v_cndmask_b32 v14, v14, 0, vcc
v_add3_u32 v63, s25, v15, v14
buffer_load_dword v62, v63, s[12:15], 0 offen sc1

s_lshl_b32 s24, s43, 3
s_add_u32 s24, s24, s44
s_lshl_b32 s24, s24, 11
s_add_u32 s24, s24, 29409280
v_and_b32 v61, 15, v0
v_lshlrev_b32 v61, 7, v61
v_add_u32 v61, s24, v61
buffer_load_dword v60, v61, s[12:15], 0 offen sc1

s_add_u32 m0, s40, 0
s_nop 0
buffer_load_dwordx4 v2, s[4:7], 0 offen lds
buffer_load_dwordx4 v3, s[4:7], s64 offen offset:1024 lds
buffer_load_dwordx4 v2, s[4:7], s65 offen offset:2048 lds
buffer_load_dwordx4 v3, s[4:7], s66 offen offset:3072 lds
s_add_u32 m0, s40, 4096
s_nop 0
buffer_load_dwordx4 v2, s[4:7], s67 offen lds
buffer_load_dwordx4 v3, s[4:7], s68 offen offset:1024 lds
buffer_load_dwordx4 v2, s[4:7], s69 offen offset:2048 lds
buffer_load_dwordx4 v3, s[4:7], s70 offen offset:3072 lds
s_add_u32 m0, s40, 8192
s_nop 0
buffer_load_dwordx4 v2, s[4:7], s71 offen lds
buffer_load_dwordx4 v3, s[4:7], s72 offen offset:1024 lds
buffer_load_dwordx4 v2, s[4:7], s73 offen offset:2048 lds
buffer_load_dwordx4 v3, s[4:7], s74 offen offset:3072 lds
s_add_u32 m0, s40, 12288
s_nop 0
buffer_load_dwordx4 v2, s[4:7], s75 offen lds
buffer_load_dwordx4 v3, s[4:7], s76 offen offset:1024 lds
v_add_u32 v2, 0x80, v2
v_add_u32 v3, 0x80, v3
s_mov_b32 s16, s87
s_mov_b32 s87, s88
s_mov_b32 s88, s89
s_mov_b32 s89, s16
s_mov_b32 s40, s87
s_and_b32 s16, s45, 7
s_lshl_b32 s16, s16, 5
v_and_b32 v20, 31, v0
v_add_u32 v20, s16, v20
v_lshlrev_b32 v20, 11, v20
s_add_u32 s90, s38, 5
s_mul_i32 s16, s2, 1
s_and_b32 s16, s2, 7
s_lshr_b32 s16, s16, 1
s_mul_i32 s16, s16, 0
s_add_u32 s90, s16, 5
s_and_b32 s90, s90, 15
s_lshl_b32 s17, s90, 7
v_add_u32 v10, s17, v20
s_and_b32 s17, s44, 3
s_lshl_b32 s17, s17, 4
v_and_b32 v20, 15, v0
v_add_u32 v20, s17, v20
v_mul_u32_u24 v20, 6144, v20
v_lshrrev_b32 v21, 4, v0
v_min_u32 v22, 2, v21
v_lshlrev_b32 v22, 11, v22
v_add_u32 v20, v20, v22
s_add_u32 s91, s16, 4
s_and_b32 s91, s91, 15
s_mul_i32 s17, s91, 393216
v_add_u32 v11, s17, v20

s_mov_b32 s62, 256
s_mov_b32 s63, 0x20000
s_mov_b32 s97, -65536
s_mov_b32 s96, 32768
s_mov_b32 s39, 0
s_mov_b32 s47, 0
v_lshrrev_b32 v21, 4, v0
v_and_b32 v20, 15, v0
v_bfe_u32 v22, v0, 1, 3
v_xor_b32 v22, v22, v21
s_lshr_b32 s16, s46, 1
s_lshl_b32 s16, s16, 7
v_add_u32 v23, s16, v20
v_lshlrev_b32 v23, 7, v23

v_xor_b32 v24, 0, v22
v_lshlrev_b32 v24, 4, v24
v_add_u32 v6, v23, v24
v_xor_b32 v24, 4, v22
v_lshlrev_b32 v24, 4, v24
v_add_u32 v7, v23, v24
v_bfe_u32 v20, v0, 2, 2
v_lshlrev_b32 v22, 3, v21
v_add_u32 v22, v22, v20
v_lshlrev_b32 v22, 7, v22
v_bfe_u32 v23, v0, 3, 1
v_and_b32 v24, 1, v21
v_lshlrev_b32 v24, 1, v24
v_or_b32 v23, v23, v24
s_and_b32 s16, s46, 1
s_lshl_b32 s16, s16, 1
v_xor_b32 v23, s16, v23
v_lshlrev_b32 v23, 5, v23
v_add_u32 v22, v22, v23
v_and_b32 v23, 3, v0
v_lshlrev_b32 v23, 3, v23
v_add_u32 v22, v22, v23
v_add_u32 v8, 98304, v22
v_xor_b32 v9, 32, v8

s_waitcnt vmcnt(16)
s_barrier
s_cmp_eq_u32 s43, 0
s_cbranch_scc1 .Lmain_A3
.Lv_B3:
ds_read_b128 a[0:3], v6 offset:0
ds_read_b64_tr_b16 a[32:33], v8 offset:0
ds_read_b64_tr_b16 a[34:35], v8 offset:512
ds_read_b64_tr_b16 a[36:37], v9 offset:0
ds_read_b64_tr_b16 a[38:39], v9 offset:512
ds_read_b64_tr_b16 a[40:41], v8 offset:8192
ds_read_b64_tr_b16 a[42:43], v8 offset:8704
ds_read_b64_tr_b16 a[44:45], v9 offset:8192
ds_read_b64_tr_b16 a[46:47], v9 offset:8704
ds_read_b64_tr_b16 a[48:49], v8 offset:16384
ds_read_b64_tr_b16 a[50:51], v8 offset:16896
ds_read_b64_tr_b16 a[52:53], v9 offset:16384
ds_read_b64_tr_b16 a[54:55], v9 offset:16896
ds_read_b128 a[4:7], v6 offset:2048
ds_read_b128 a[8:11], v6 offset:4096
ds_read_b128 a[12:15], v6 offset:6144
ds_read_b128 a[16:19], v6 offset:8192
ds_read_b128 a[20:23], v6 offset:10240
ds_read_b128 a[24:27], v6 offset:12288
ds_read_b128 a[28:31], v6 offset:14336
s_mov_b32 s42, 0
s_waitcnt lgkmcnt(15)
v_mfma_f32_16x16x32_bf16 v[64:67], a[32:35], a[0:3], 0
ds_read_b128 a[64:67], v7 offset:0
v_mfma_f32_16x16x32_bf16 v[68:71], a[36:39], a[0:3], 0
s_add_u32 m0, s40, 0
s_nop 0
buffer_load_dwordx4 v2, s[4:7], 0 offen lds
s_waitcnt lgkmcnt(14)
v_mfma_f32_16x16x32_bf16 v[72:75], a[40:43], a[0:3], 0
ds_read_b64_tr_b16 a[96:97], v8 offset:4096
s_waitcnt lgkmcnt(13)
v_mfma_f32_16x16x32_bf16 v[76:79], a[44:47], a[0:3], 0
buffer_load_dwordx4 v3, s[4:7], s64 offen offset:1024 lds
s_waitcnt lgkmcnt(11)
v_mfma_f32_16x16x32_bf16 v[80:83], a[0:3], a[48:51], 0
ds_read_b64_tr_b16 a[98:99], v8 offset:4608
s_waitcnt lgkmcnt(10)
v_mfma_f32_16x16x32_bf16 v[84:87], a[0:3], a[52:55], 0
buffer_load_dwordx4 v2, s[4:7], s65 offen offset:2048 lds
s_waitcnt lgkmcnt(9)
v_mfma_f32_16x16x32_bf16 v[88:91], a[32:35], a[4:7], 0
ds_read_b64_tr_b16 a[100:101], v9 offset:4096
v_mfma_f32_16x16x32_bf16 v[92:95], a[36:39], a[4:7], 0
buffer_load_dwordx4 v3, s[4:7], s66 offen offset:3072 lds
v_mfma_f32_16x16x32_bf16 v[96:99], a[40:43], a[4:7], 0
ds_read_b64_tr_b16 a[102:103], v9 offset:4608
v_mfma_f32_16x16x32_bf16 v[100:103], a[44:47], a[4:7], 0
s_add_u32 m0, s40, 4096
s_nop 0
buffer_load_dwordx4 v2, s[4:7], s67 offen lds
v_mfma_f32_16x16x32_bf16 v[104:107], a[4:7], a[48:51], 0
ds_read_b64_tr_b16 a[104:105], v8 offset:12288
v_mfma_f32_16x16x32_bf16 v[108:111], a[4:7], a[52:55], 0
buffer_load_dwordx4 v3, s[4:7], s68 offen offset:1024 lds
s_waitcnt lgkmcnt(3)
v_mfma_f32_16x16x32_bf16 v[112:115], a[32:35], a[8:11], 0
ds_read_b64_tr_b16 a[106:107], v8 offset:12800
v_mfma_f32_16x16x32_bf16 v[116:119], a[36:39], a[8:11], 0
buffer_load_dwordx4 v2, s[4:7], s69 offen offset:2048 lds
v_mfma_f32_16x16x32_bf16 v[120:123], a[40:43], a[8:11], 0
ds_read_b64_tr_b16 a[108:109], v9 offset:12288
v_mfma_f32_16x16x32_bf16 v[124:127], a[44:47], a[8:11], 0
buffer_load_dwordx4 v3, s[4:7], s70 offen offset:3072 lds
v_mfma_f32_16x16x32_bf16 v[128:131], a[8:11], a[48:51], 0
ds_read_b64_tr_b16 a[110:111], v9 offset:12800
v_mfma_f32_16x16x32_bf16 v[132:135], a[8:11], a[52:55], 0
s_add_u32 m0, s40, 8192
s_nop 0
buffer_load_dwordx4 v2, s[4:7], s71 offen lds
v_mfma_f32_16x16x32_bf16 v[136:139], a[32:35], a[12:15], 0
ds_read_b64_tr_b16 a[112:113], v8 offset:20480
v_mfma_f32_16x16x32_bf16 v[140:143], a[36:39], a[12:15], 0
buffer_load_dwordx4 v3, s[4:7], s72 offen offset:1024 lds
v_mfma_f32_16x16x32_bf16 v[144:147], a[40:43], a[12:15], 0
ds_read_b64_tr_b16 a[114:115], v8 offset:20992
v_mfma_f32_16x16x32_bf16 v[148:151], a[44:47], a[12:15], 0
buffer_load_dwordx4 v2, s[4:7], s73 offen offset:2048 lds
v_mfma_f32_16x16x32_bf16 v[152:155], a[12:15], a[48:51], 0
ds_read_b64_tr_b16 a[116:117], v9 offset:20480
v_mfma_f32_16x16x32_bf16 v[156:159], a[12:15], a[52:55], 0
buffer_load_dwordx4 v3, s[4:7], s74 offen offset:3072 lds
v_mfma_f32_16x16x32_bf16 v[160:163], a[32:35], a[16:19], 0
ds_read_b64_tr_b16 a[118:119], v9 offset:20992
v_mfma_f32_16x16x32_bf16 v[164:167], a[36:39], a[16:19], 0
s_add_u32 m0, s40, 12288
s_nop 0
buffer_load_dwordx4 v2, s[4:7], s75 offen lds
v_mfma_f32_16x16x32_bf16 v[168:171], a[40:43], a[16:19], 0
ds_read_b128 a[68:71], v7 offset:2048
v_mfma_f32_16x16x32_bf16 v[172:175], a[44:47], a[16:19], 0
buffer_load_dwordx4 v3, s[4:7], s76 offen offset:1024 lds
v_mfma_f32_16x16x32_bf16 v[176:179], a[16:19], a[48:51], 0
ds_read_b128 a[72:75], v7 offset:4096
v_add_u32 v2, 0x80, v2
v_mfma_f32_16x16x32_bf16 v[180:183], a[16:19], a[52:55], 0
buffer_load_dword v12, v11, s[8:11], 0 offen
v_mfma_f32_16x16x32_bf16 v[184:187], a[32:35], a[20:23], 0
ds_read_b128 a[76:79], v7 offset:6144
v_add_u32 v3, 0x80, v3
v_mfma_f32_16x16x32_bf16 v[188:191], a[36:39], a[20:23], 0
s_mov_b32 s16, s87
v_mfma_f32_16x16x32_bf16 v[192:195], a[40:43], a[20:23], 0
ds_read_b128 a[80:83], v7 offset:8192
s_mov_b32 s87, s88
v_mfma_f32_16x16x32_bf16 v[196:199], a[44:47], a[20:23], 0
s_mov_b32 s88, s89
v_mfma_f32_16x16x32_bf16 v[200:203], a[20:23], a[48:51], 0
ds_read_b128 a[84:87], v7 offset:10240
s_mov_b32 s89, s16
v_mfma_f32_16x16x32_bf16 v[204:207], a[20:23], a[52:55], 0
s_mov_b32 s40, s87
v_mfma_f32_16x16x32_bf16 v[208:211], a[32:35], a[24:27], 0
ds_read_b128 a[88:91], v7 offset:12288
v_add_u32 v10, 0x80, v10
v_mfma_f32_16x16x32_bf16 v[212:215], a[36:39], a[24:27], 0
v_add_u32 v11, s99, v11
v_mfma_f32_16x16x32_bf16 v[216:219], a[40:43], a[24:27], 0
ds_read_b128 a[92:95], v7 offset:14336
v_mfma_f32_16x16x32_bf16 v[220:223], a[44:47], a[24:27], 0
v_mfma_f32_16x16x32_bf16 v[224:227], a[24:27], a[48:51], 0
v_add_u32 v7, s92, v7
v_mfma_f32_16x16x32_bf16 v[228:231], a[24:27], a[52:55], 0
v_add_u32 v6, s92, v6
v_mfma_f32_16x16x32_bf16 v[232:235], a[32:35], a[28:31], 0
s_mov_b32 s17, s92
v_mfma_f32_16x16x32_bf16 v[236:239], a[36:39], a[28:31], 0
s_mov_b32 s92, s93
v_mfma_f32_16x16x32_bf16 v[240:243], a[40:43], a[28:31], 0
s_mov_b32 s93, s94
v_mfma_f32_16x16x32_bf16 v[244:247], a[44:47], a[28:31], 0
s_mov_b32 s94, s17
v_mfma_f32_16x16x32_bf16 v[248:251], a[28:31], a[48:51], 0
v_mfma_f32_16x16x32_bf16 v[252:255], a[28:31], a[52:55], 0
s_waitcnt lgkmcnt(0)
v_mfma_f32_16x16x32_bf16 v[64:67], a[96:99], a[64:67], v[64:67]
s_waitcnt vmcnt(15)
s_barrier
v_mfma_f32_16x16x32_bf16 v[68:71], a[100:103], a[64:67], v[68:71]
s_add_u32 m0, s40, 0
s_nop 0
buffer_load_dwordx4 v2, s[4:7], 0 offen lds
v_mfma_f32_16x16x32_bf16 v[72:75], a[104:107], a[64:67], v[72:75]
ds_read_b128 a[0:3], v6 offset:0
v_mfma_f32_16x16x32_bf16 v[76:79], a[108:111], a[64:67], v[76:79]
s_cmp_eq_u32 s43, 0
s_cselect_b32 s24, s44, 0
s_cselect_b32 s25, 0x4000, 0
v_readlane_b32 s30, v62, s24
v_readlane_b32 s31, v62, 1
v_readlane_b32 s33, v63, 1
v_readlane_b32 s3, v62, 2
v_readlane_b32 s34, v62, 3
s_lshl_b32 s24, s44, 4
s_add_u32 s24, s24, s45
s_lshl_b32 s24, s24, 7
s_add_u32 s32, s24, s25
s_add_u32 s32, s32, 29360128

v_accvgpr_write_b32 a252, v60
v_accvgpr_write_b32 a253, v61
v_mfma_f32_16x16x32_bf16 v[80:83], a[64:67], a[112:115], v[80:83]
ds_read_b64_tr_b16 a[32:33], v8 offset:24576
v_mfma_f32_16x16x32_bf16 v[84:87], a[64:67], a[116:119], v[84:87]
buffer_load_dwordx4 v3, s[4:7], s64 offen offset:1024 lds
v_mfma_f32_16x16x32_bf16 v[88:91], a[96:99], a[68:71], v[88:91]
ds_read_b64_tr_b16 a[34:35], v8 offset:25088
v_mfma_f32_16x16x32_bf16 v[92:95], a[100:103], a[68:71], v[92:95]
v_mfma_f32_16x16x32_bf16 v[96:99], a[104:107], a[68:71], v[96:99]
ds_read_b64_tr_b16 a[36:37], v9 offset:24576
v_mfma_f32_16x16x32_bf16 v[100:103], a[108:111], a[68:71], v[100:103]
buffer_load_dwordx4 v2, s[4:7], s65 offen offset:2048 lds
v_mfma_f32_16x16x32_bf16 v[104:107], a[68:71], a[112:115], v[104:107]
ds_read_b64_tr_b16 a[38:39], v9 offset:25088
v_mfma_f32_16x16x32_bf16 v[108:111], a[68:71], a[116:119], v[108:111]
v_mfma_f32_16x16x32_bf16 v[112:115], a[96:99], a[72:75], v[112:115]
ds_read_b64_tr_b16 a[40:41], v8 offset:32768
v_mfma_f32_16x16x32_bf16 v[116:119], a[100:103], a[72:75], v[116:119]
buffer_load_dwordx4 v3, s[4:7], s66 offen offset:3072 lds
v_mfma_f32_16x16x32_bf16 v[120:123], a[104:107], a[72:75], v[120:123]
ds_read_b64_tr_b16 a[42:43], v8 offset:33280
v_mfma_f32_16x16x32_bf16 v[124:127], a[108:111], a[72:75], v[124:127]
v_mfma_f32_16x16x32_bf16 v[128:131], a[72:75], a[112:115], v[128:131]
ds_read_b64_tr_b16 a[44:45], v9 offset:32768
v_mfma_f32_16x16x32_bf16 v[132:135], a[72:75], a[116:119], v[132:135]
s_add_u32 m0, s40, 4096
s_nop 0
buffer_load_dwordx4 v2, s[4:7], s67 offen lds
v_mfma_f32_16x16x32_bf16 v[136:139], a[96:99], a[76:79], v[136:139]
ds_read_b64_tr_b16 a[46:47], v9 offset:33280
v_mfma_f32_16x16x32_bf16 v[140:143], a[100:103], a[76:79], v[140:143]
v_mfma_f32_16x16x32_bf16 v[144:147], a[104:107], a[76:79], v[144:147]
ds_read_b64_tr_b16 a[48:49], v8 offset:40960
v_mfma_f32_16x16x32_bf16 v[148:151], a[108:111], a[76:79], v[148:151]
buffer_load_dwordx4 v3, s[4:7], s68 offen offset:1024 lds
v_mfma_f32_16x16x32_bf16 v[152:155], a[76:79], a[112:115], v[152:155]
ds_read_b64_tr_b16 a[50:51], v8 offset:41472
v_mfma_f32_16x16x32_bf16 v[156:159], a[76:79], a[116:119], v[156:159]
v_mfma_f32_16x16x32_bf16 v[160:163], a[96:99], a[80:83], v[160:163]
ds_read_b64_tr_b16 a[52:53], v9 offset:40960
v_mfma_f32_16x16x32_bf16 v[164:167], a[100:103], a[80:83], v[164:167]
buffer_load_dwordx4 v2, s[4:7], s69 offen offset:2048 lds
v_mfma_f32_16x16x32_bf16 v[168:171], a[104:107], a[80:83], v[168:171]
ds_read_b64_tr_b16 a[54:55], v9 offset:41472
v_mfma_f32_16x16x32_bf16 v[172:175], a[108:111], a[80:83], v[172:175]
v_mfma_f32_16x16x32_bf16 v[176:179], a[80:83], a[112:115], v[176:179]
ds_read_b128 a[4:7], v6 offset:2048
v_mfma_f32_16x16x32_bf16 v[180:183], a[80:83], a[116:119], v[180:183]
buffer_load_dwordx4 v3, s[4:7], s70 offen offset:3072 lds
v_mfma_f32_16x16x32_bf16 v[184:187], a[96:99], a[84:87], v[184:187]
ds_read_b128 a[8:11], v6 offset:4096
v_mfma_f32_16x16x32_bf16 v[188:191], a[100:103], a[84:87], v[188:191]
v_mfma_f32_16x16x32_bf16 v[192:195], a[104:107], a[84:87], v[192:195]
ds_read_b128 a[12:15], v6 offset:6144
v_mfma_f32_16x16x32_bf16 v[196:199], a[108:111], a[84:87], v[196:199]
s_add_u32 m0, s40, 8192
s_nop 0
buffer_load_dwordx4 v2, s[4:7], s71 offen lds
v_mfma_f32_16x16x32_bf16 v[200:203], a[84:87], a[112:115], v[200:203]
ds_read_b128 a[16:19], v6 offset:8192
v_mfma_f32_16x16x32_bf16 v[204:207], a[84:87], a[116:119], v[204:207]
v_mfma_f32_16x16x32_bf16 v[208:211], a[96:99], a[88:91], v[208:211]
ds_read_b128 a[20:23], v6 offset:10240
v_mfma_f32_16x16x32_bf16 v[212:215], a[100:103], a[88:91], v[212:215]
buffer_load_dwordx4 v3, s[4:7], s72 offen offset:1024 lds
v_mfma_f32_16x16x32_bf16 v[216:219], a[104:107], a[88:91], v[216:219]
ds_read_b128 a[24:27], v6 offset:12288
v_mfma_f32_16x16x32_bf16 v[220:223], a[108:111], a[88:91], v[220:223]
v_mfma_f32_16x16x32_bf16 v[224:227], a[88:91], a[112:115], v[224:227]
ds_read_b128 a[28:31], v6 offset:14336
v_mfma_f32_16x16x32_bf16 v[228:231], a[88:91], a[116:119], v[228:231]
buffer_load_dwordx4 v2, s[4:7], s73 offen offset:2048 lds
v_mfma_f32_16x16x32_bf16 v[232:235], a[96:99], a[92:95], v[232:235]
v_mfma_f32_16x16x32_bf16 v[236:239], a[100:103], a[92:95], v[236:239]
v_mfma_f32_16x16x32_bf16 v[240:243], a[104:107], a[92:95], v[240:243]
v_mfma_f32_16x16x32_bf16 v[244:247], a[108:111], a[92:95], v[244:247]
buffer_load_dwordx4 v3, s[4:7], s74 offen offset:3072 lds
v_mfma_f32_16x16x32_bf16 v[248:251], a[92:95], a[112:115], v[248:251]
v_mfma_f32_16x16x32_bf16 v[252:255], a[92:95], a[116:119], v[252:255]
.p2align 6
.LB3_loop:
s_waitcnt lgkmcnt(0)
v_mfma_f32_16x16x32_bf16 v[64:67], a[32:35], a[0:3], v[64:67]
ds_read_b128 a[64:67], v7 offset:0
v_mfma_f32_16x16x32_bf16 v[68:71], a[36:39], a[0:3], v[68:71]
s_add_u32 m0, s40, 12288
s_nop 0
buffer_load_dwordx4 v2, s[4:7], s75 offen lds
v_mfma_f32_16x16x32_bf16 v[72:75], a[40:43], a[0:3], v[72:75]
ds_read_b64_tr_b16 a[96:97], v8 offset:28672
v_mfma_f32_16x16x32_bf16 v[76:79], a[44:47], a[0:3], v[76:79]
v_mfma_f32_16x16x32_bf16 v[80:83], a[0:3], a[48:51], v[80:83]
ds_read_b64_tr_b16 a[98:99], v8 offset:29184
v_mfma_f32_16x16x32_bf16 v[84:87], a[0:3], a[52:55], v[84:87]
buffer_load_dwordx4 v3, s[4:7], s76 offen offset:1024 lds
v_mfma_f32_16x16x32_bf16 v[88:91], a[32:35], a[4:7], v[88:91]
ds_read_b64_tr_b16 a[100:101], v9 offset:28672
v_mfma_f32_16x16x32_bf16 v[92:95], a[36:39], a[4:7], v[92:95]
v_add_u32 v2, 0x80, v2
v_mfma_f32_16x16x32_bf16 v[96:99], a[40:43], a[4:7], v[96:99]
ds_read_b64_tr_b16 a[102:103], v9 offset:29184
v_mfma_f32_16x16x32_bf16 v[100:103], a[44:47], a[4:7], v[100:103]
buffer_load_dword v12, v11, s[8:11], 0 offen
v_mfma_f32_16x16x32_bf16 v[104:107], a[4:7], a[48:51], v[104:107]
ds_read_b64_tr_b16 a[104:105], v8 offset:36864
v_mfma_f32_16x16x32_bf16 v[108:111], a[4:7], a[52:55], v[108:111]
v_add_u32 v3, 0x80, v3
v_add_u32 v10, 0x80, v10
v_mfma_f32_16x16x32_bf16 v[112:115], a[32:35], a[8:11], v[112:115]
ds_read_b64_tr_b16 a[106:107], v8 offset:37376
v_mfma_f32_16x16x32_bf16 v[116:119], a[36:39], a[8:11], v[116:119]
v_mfma_f32_16x16x32_bf16 v[120:123], a[40:43], a[8:11], v[120:123]
ds_read_b64_tr_b16 a[108:109], v9 offset:36864
v_mfma_f32_16x16x32_bf16 v[124:127], a[44:47], a[8:11], v[124:127]
s_mov_b32 s16, s87
v_add_u32 v11, s99, v11
v_mfma_f32_16x16x32_bf16 v[128:131], a[8:11], a[48:51], v[128:131]
ds_read_b64_tr_b16 a[110:111], v9 offset:37376
v_mfma_f32_16x16x32_bf16 v[132:135], a[8:11], a[52:55], v[132:135]
v_mfma_f32_16x16x32_bf16 v[136:139], a[32:35], a[12:15], v[136:139]
ds_read_b64_tr_b16 a[112:113], v8 offset:45056
v_mfma_f32_16x16x32_bf16 v[140:143], a[36:39], a[12:15], v[140:143]
s_mov_b32 s87, s88
v_mfma_f32_16x16x32_bf16 v[144:147], a[40:43], a[12:15], v[144:147]
ds_read_b64_tr_b16 a[114:115], v8 offset:45568
v_mfma_f32_16x16x32_bf16 v[148:151], a[44:47], a[12:15], v[148:151]
v_mfma_f32_16x16x32_bf16 v[152:155], a[12:15], a[48:51], v[152:155]
ds_read_b64_tr_b16 a[116:117], v9 offset:45056
v_mfma_f32_16x16x32_bf16 v[156:159], a[12:15], a[52:55], v[156:159]
s_mov_b32 s88, s89
v_mfma_f32_16x16x32_bf16 v[160:163], a[32:35], a[16:19], v[160:163]
ds_read_b64_tr_b16 a[118:119], v9 offset:45568
v_mfma_f32_16x16x32_bf16 v[164:167], a[36:39], a[16:19], v[164:167]
v_mfma_f32_16x16x32_bf16 v[168:171], a[40:43], a[16:19], v[168:171]
ds_read_b128 a[68:71], v7 offset:2048
v_mfma_f32_16x16x32_bf16 v[172:175], a[44:47], a[16:19], v[172:175]
s_mov_b32 s89, s16
v_mfma_f32_16x16x32_bf16 v[176:179], a[16:19], a[48:51], v[176:179]
ds_read_b128 a[72:75], v7 offset:4096
v_mfma_f32_16x16x32_bf16 v[180:183], a[16:19], a[52:55], v[180:183]
v_mfma_f32_16x16x32_bf16 v[184:187], a[32:35], a[20:23], v[184:187]
ds_read_b128 a[76:79], v7 offset:6144
v_mfma_f32_16x16x32_bf16 v[188:191], a[36:39], a[20:23], v[188:191]
s_mov_b32 s40, s87
v_mfma_f32_16x16x32_bf16 v[192:195], a[40:43], a[20:23], v[192:195]
ds_read_b128 a[80:83], v7 offset:8192
v_mfma_f32_16x16x32_bf16 v[196:199], a[44:47], a[20:23], v[196:199]
v_mfma_f32_16x16x32_bf16 v[200:203], a[20:23], a[48:51], v[200:203]
ds_read_b128 a[84:87], v7 offset:10240
v_mfma_f32_16x16x32_bf16 v[204:207], a[20:23], a[52:55], v[204:207]
v_mfma_f32_16x16x32_bf16 v[208:211], a[32:35], a[24:27], v[208:211]
ds_read_b128 a[88:91], v7 offset:12288
v_mfma_f32_16x16x32_bf16 v[212:215], a[36:39], a[24:27], v[212:215]
v_mfma_f32_16x16x32_bf16 v[216:219], a[40:43], a[24:27], v[216:219]
ds_read_b128 a[92:95], v7 offset:14336
v_mfma_f32_16x16x32_bf16 v[220:223], a[44:47], a[24:27], v[220:223]
v_mfma_f32_16x16x32_bf16 v[224:227], a[24:27], a[48:51], v[224:227]
v_add_u32 v7, s92, v7
v_mfma_f32_16x16x32_bf16 v[228:231], a[24:27], a[52:55], v[228:231]
v_add_u32 v6, s92, v6
v_mfma_f32_16x16x32_bf16 v[232:235], a[32:35], a[28:31], v[232:235]
s_mov_b32 s17, s92
v_mfma_f32_16x16x32_bf16 v[236:239], a[36:39], a[28:31], v[236:239]
s_mov_b32 s92, s93
v_mfma_f32_16x16x32_bf16 v[240:243], a[40:43], a[28:31], v[240:243]
s_mov_b32 s93, s94
v_mfma_f32_16x16x32_bf16 v[244:247], a[44:47], a[28:31], v[244:247]
s_mov_b32 s94, s17
v_mfma_f32_16x16x32_bf16 v[248:251], a[28:31], a[48:51], v[248:251]
v_mfma_f32_16x16x32_bf16 v[252:255], a[28:31], a[52:55], v[252:255]
s_waitcnt lgkmcnt(0)
v_mfma_f32_16x16x32_bf16 v[64:67], a[96:99], a[64:67], v[64:67]
s_waitcnt vmcnt(16)
s_barrier
v_mfma_f32_16x16x32_bf16 v[68:71], a[100:103], a[64:67], v[68:71]
s_add_u32 m0, s40, 0
s_nop 0
buffer_load_dwordx4 v2, s[4:7], 0 offen lds
v_mfma_f32_16x16x32_bf16 v[72:75], a[104:107], a[64:67], v[72:75]
ds_read_b128 a[0:3], v6 offset:0
v_mfma_f32_16x16x32_bf16 v[76:79], a[108:111], a[64:67], v[76:79]
v_mfma_f32_16x16x32_bf16 v[80:83], a[64:67], a[112:115], v[80:83]
ds_read_b64_tr_b16 a[32:33], v8 offset:0
v_mfma_f32_16x16x32_bf16 v[84:87], a[64:67], a[116:119], v[84:87]
buffer_load_dwordx4 v3, s[4:7], s64 offen offset:1024 lds
v_mfma_f32_16x16x32_bf16 v[88:91], a[96:99], a[68:71], v[88:91]
ds_read_b64_tr_b16 a[34:35], v8 offset:512
v_mfma_f32_16x16x32_bf16 v[92:95], a[100:103], a[68:71], v[92:95]
v_mfma_f32_16x16x32_bf16 v[96:99], a[104:107], a[68:71], v[96:99]
ds_read_b64_tr_b16 a[36:37], v9 offset:0
v_mfma_f32_16x16x32_bf16 v[100:103], a[108:111], a[68:71], v[100:103]
buffer_load_dwordx4 v2, s[4:7], s65 offen offset:2048 lds
v_mfma_f32_16x16x32_bf16 v[104:107], a[68:71], a[112:115], v[104:107]
ds_read_b64_tr_b16 a[38:39], v9 offset:512
v_mfma_f32_16x16x32_bf16 v[108:111], a[68:71], a[116:119], v[108:111]
v_mfma_f32_16x16x32_bf16 v[112:115], a[96:99], a[72:75], v[112:115]
ds_read_b64_tr_b16 a[40:41], v8 offset:8192
v_mfma_f32_16x16x32_bf16 v[116:119], a[100:103], a[72:75], v[116:119]
buffer_load_dwordx4 v3, s[4:7], s66 offen offset:3072 lds
v_mfma_f32_16x16x32_bf16 v[120:123], a[104:107], a[72:75], v[120:123]
ds_read_b64_tr_b16 a[42:43], v8 offset:8704
v_mfma_f32_16x16x32_bf16 v[124:127], a[108:111], a[72:75], v[124:127]
v_mfma_f32_16x16x32_bf16 v[128:131], a[72:75], a[112:115], v[128:131]
ds_read_b64_tr_b16 a[44:45], v9 offset:8192
v_mfma_f32_16x16x32_bf16 v[132:135], a[72:75], a[116:119], v[132:135]
s_add_u32 m0, s40, 4096
s_nop 0
buffer_load_dwordx4 v2, s[4:7], s67 offen lds
v_mfma_f32_16x16x32_bf16 v[136:139], a[96:99], a[76:79], v[136:139]
ds_read_b64_tr_b16 a[46:47], v9 offset:8704
v_mfma_f32_16x16x32_bf16 v[140:143], a[100:103], a[76:79], v[140:143]
v_mfma_f32_16x16x32_bf16 v[144:147], a[104:107], a[76:79], v[144:147]
ds_read_b64_tr_b16 a[48:49], v8 offset:16384
v_mfma_f32_16x16x32_bf16 v[148:151], a[108:111], a[76:79], v[148:151]
buffer_load_dwordx4 v3, s[4:7], s68 offen offset:1024 lds
v_mfma_f32_16x16x32_bf16 v[152:155], a[76:79], a[112:115], v[152:155]
ds_read_b64_tr_b16 a[50:51], v8 offset:16896
v_mfma_f32_16x16x32_bf16 v[156:159], a[76:79], a[116:119], v[156:159]
v_mfma_f32_16x16x32_bf16 v[160:163], a[96:99], a[80:83], v[160:163]
ds_read_b64_tr_b16 a[52:53], v9 offset:16384
v_mfma_f32_16x16x32_bf16 v[164:167], a[100:103], a[80:83], v[164:167]
buffer_load_dwordx4 v2, s[4:7], s69 offen offset:2048 lds
v_mfma_f32_16x16x32_bf16 v[168:171], a[104:107], a[80:83], v[168:171]
ds_read_b64_tr_b16 a[54:55], v9 offset:16896
v_mfma_f32_16x16x32_bf16 v[172:175], a[108:111], a[80:83], v[172:175]
v_mfma_f32_16x16x32_bf16 v[176:179], a[80:83], a[112:115], v[176:179]
ds_read_b128 a[4:7], v6 offset:2048
v_mfma_f32_16x16x32_bf16 v[180:183], a[80:83], a[116:119], v[180:183]
buffer_load_dwordx4 v3, s[4:7], s70 offen offset:3072 lds
v_mfma_f32_16x16x32_bf16 v[184:187], a[96:99], a[84:87], v[184:187]
ds_read_b128 a[8:11], v6 offset:4096
v_mfma_f32_16x16x32_bf16 v[188:191], a[100:103], a[84:87], v[188:191]
v_mfma_f32_16x16x32_bf16 v[192:195], a[104:107], a[84:87], v[192:195]
ds_read_b128 a[12:15], v6 offset:6144
v_mfma_f32_16x16x32_bf16 v[196:199], a[108:111], a[84:87], v[196:199]
s_add_u32 m0, s40, 8192
s_nop 0
buffer_load_dwordx4 v2, s[4:7], s71 offen lds
v_mfma_f32_16x16x32_bf16 v[200:203], a[84:87], a[112:115], v[200:203]
ds_read_b128 a[16:19], v6 offset:8192
v_mfma_f32_16x16x32_bf16 v[204:207], a[84:87], a[116:119], v[204:207]
v_mfma_f32_16x16x32_bf16 v[208:211], a[96:99], a[88:91], v[208:211]
ds_read_b128 a[20:23], v6 offset:10240
v_mfma_f32_16x16x32_bf16 v[212:215], a[100:103], a[88:91], v[212:215]
buffer_load_dwordx4 v3, s[4:7], s72 offen offset:1024 lds
v_mfma_f32_16x16x32_bf16 v[216:219], a[104:107], a[88:91], v[216:219]
ds_read_b128 a[24:27], v6 offset:12288
v_mfma_f32_16x16x32_bf16 v[220:223], a[108:111], a[88:91], v[220:223]
v_mfma_f32_16x16x32_bf16 v[224:227], a[88:91], a[112:115], v[224:227]
ds_read_b128 a[28:31], v6 offset:14336
v_mfma_f32_16x16x32_bf16 v[228:231], a[88:91], a[116:119], v[228:231]
buffer_load_dwordx4 v2, s[4:7], s73 offen offset:2048 lds
v_mfma_f32_16x16x32_bf16 v[232:235], a[96:99], a[92:95], v[232:235]
v_mfma_f32_16x16x32_bf16 v[236:239], a[100:103], a[92:95], v[236:239]
v_mfma_f32_16x16x32_bf16 v[240:243], a[104:107], a[92:95], v[240:243]
v_mfma_f32_16x16x32_bf16 v[244:247], a[108:111], a[92:95], v[244:247]
buffer_load_dwordx4 v3, s[4:7], s74 offen offset:3072 lds
v_mfma_f32_16x16x32_bf16 v[248:251], a[92:95], a[112:115], v[248:251]
v_mfma_f32_16x16x32_bf16 v[252:255], a[92:95], a[116:119], v[252:255]
s_waitcnt lgkmcnt(0)
v_mfma_f32_16x16x32_bf16 v[64:67], a[32:35], a[0:3], v[64:67]
ds_read_b128 a[64:67], v7 offset:0
v_mfma_f32_16x16x32_bf16 v[68:71], a[36:39], a[0:3], v[68:71]
s_add_u32 m0, s40, 12288
s_nop 0
buffer_load_dwordx4 v2, s[4:7], s75 offen lds
v_mfma_f32_16x16x32_bf16 v[72:75], a[40:43], a[0:3], v[72:75]
ds_read_b64_tr_b16 a[96:97], v8 offset:4096
v_mfma_f32_16x16x32_bf16 v[76:79], a[44:47], a[0:3], v[76:79]
v_mfma_f32_16x16x32_bf16 v[80:83], a[0:3], a[48:51], v[80:83]
ds_read_b64_tr_b16 a[98:99], v8 offset:4608
v_mfma_f32_16x16x32_bf16 v[84:87], a[0:3], a[52:55], v[84:87]
buffer_load_dwordx4 v3, s[4:7], s76 offen offset:1024 lds
v_mfma_f32_16x16x32_bf16 v[88:91], a[32:35], a[4:7], v[88:91]
ds_read_b64_tr_b16 a[100:101], v9 offset:4096
v_mfma_f32_16x16x32_bf16 v[92:95], a[36:39], a[4:7], v[92:95]
v_add_u32 v2, 0x80, v2
v_mfma_f32_16x16x32_bf16 v[96:99], a[40:43], a[4:7], v[96:99]
ds_read_b64_tr_b16 a[102:103], v9 offset:4608
v_mfma_f32_16x16x32_bf16 v[100:103], a[44:47], a[4:7], v[100:103]
buffer_load_dword v12, v11, s[8:11], 0 offen
v_mfma_f32_16x16x32_bf16 v[104:107], a[4:7], a[48:51], v[104:107]
ds_read_b64_tr_b16 a[104:105], v8 offset:12288
v_mfma_f32_16x16x32_bf16 v[108:111], a[4:7], a[52:55], v[108:111]
v_add_u32 v3, 0x80, v3
v_add_u32 v10, 0x80, v10
v_mfma_f32_16x16x32_bf16 v[112:115], a[32:35], a[8:11], v[112:115]
ds_read_b64_tr_b16 a[106:107], v8 offset:12800
v_mfma_f32_16x16x32_bf16 v[116:119], a[36:39], a[8:11], v[116:119]
v_mfma_f32_16x16x32_bf16 v[120:123], a[40:43], a[8:11], v[120:123]
ds_read_b64_tr_b16 a[108:109], v9 offset:12288
v_mfma_f32_16x16x32_bf16 v[124:127], a[44:47], a[8:11], v[124:127]
s_mov_b32 s16, s87
v_add_u32 v11, s99, v11
v_mfma_f32_16x16x32_bf16 v[128:131], a[8:11], a[48:51], v[128:131]
ds_read_b64_tr_b16 a[110:111], v9 offset:12800
v_mfma_f32_16x16x32_bf16 v[132:135], a[8:11], a[52:55], v[132:135]
v_mfma_f32_16x16x32_bf16 v[136:139], a[32:35], a[12:15], v[136:139]
ds_read_b64_tr_b16 a[112:113], v8 offset:20480
v_mfma_f32_16x16x32_bf16 v[140:143], a[36:39], a[12:15], v[140:143]
s_mov_b32 s87, s88
v_mfma_f32_16x16x32_bf16 v[144:147], a[40:43], a[12:15], v[144:147]
ds_read_b64_tr_b16 a[114:115], v8 offset:20992
v_mfma_f32_16x16x32_bf16 v[148:151], a[44:47], a[12:15], v[148:151]
v_mfma_f32_16x16x32_bf16 v[152:155], a[12:15], a[48:51], v[152:155]
ds_read_b64_tr_b16 a[116:117], v9 offset:20480
v_mfma_f32_16x16x32_bf16 v[156:159], a[12:15], a[52:55], v[156:159]
s_mov_b32 s88, s89
v_mfma_f32_16x16x32_bf16 v[160:163], a[32:35], a[16:19], v[160:163]
ds_read_b64_tr_b16 a[118:119], v9 offset:20992
v_mfma_f32_16x16x32_bf16 v[164:167], a[36:39], a[16:19], v[164:167]
v_mfma_f32_16x16x32_bf16 v[168:171], a[40:43], a[16:19], v[168:171]
ds_read_b128 a[68:71], v7 offset:2048
v_mfma_f32_16x16x32_bf16 v[172:175], a[44:47], a[16:19], v[172:175]
s_mov_b32 s89, s16
v_mfma_f32_16x16x32_bf16 v[176:179], a[16:19], a[48:51], v[176:179]
ds_read_b128 a[72:75], v7 offset:4096
v_mfma_f32_16x16x32_bf16 v[180:183], a[16:19], a[52:55], v[180:183]
v_mfma_f32_16x16x32_bf16 v[184:187], a[32:35], a[20:23], v[184:187]
ds_read_b128 a[76:79], v7 offset:6144
v_mfma_f32_16x16x32_bf16 v[188:191], a[36:39], a[20:23], v[188:191]
s_mov_b32 s40, s87
v_mfma_f32_16x16x32_bf16 v[192:195], a[40:43], a[20:23], v[192:195]
ds_read_b128 a[80:83], v7 offset:8192
v_mfma_f32_16x16x32_bf16 v[196:199], a[44:47], a[20:23], v[196:199]
v_mfma_f32_16x16x32_bf16 v[200:203], a[20:23], a[48:51], v[200:203]
ds_read_b128 a[84:87], v7 offset:10240
v_mfma_f32_16x16x32_bf16 v[204:207], a[20:23], a[52:55], v[204:207]
v_mfma_f32_16x16x32_bf16 v[208:211], a[32:35], a[24:27], v[208:211]
ds_read_b128 a[88:91], v7 offset:12288
v_mfma_f32_16x16x32_bf16 v[212:215], a[36:39], a[24:27], v[212:215]
v_mfma_f32_16x16x32_bf16 v[216:219], a[40:43], a[24:27], v[216:219]
ds_read_b128 a[92:95], v7 offset:14336
v_mfma_f32_16x16x32_bf16 v[220:223], a[44:47], a[24:27], v[220:223]
v_mfma_f32_16x16x32_bf16 v[224:227], a[24:27], a[48:51], v[224:227]
v_add_u32 v7, s92, v7
v_mfma_f32_16x16x32_bf16 v[228:231], a[24:27], a[52:55], v[228:231]
v_add_u32 v6, s92, v6
v_mfma_f32_16x16x32_bf16 v[232:235], a[32:35], a[28:31], v[232:235]
s_mov_b32 s17, s92
v_mfma_f32_16x16x32_bf16 v[236:239], a[36:39], a[28:31], v[236:239]
s_mov_b32 s92, s93
v_mfma_f32_16x16x32_bf16 v[240:243], a[40:43], a[28:31], v[240:243]
s_mov_b32 s93, s94
v_mfma_f32_16x16x32_bf16 v[244:247], a[44:47], a[28:31], v[244:247]
s_mov_b32 s94, s17
v_mfma_f32_16x16x32_bf16 v[248:251], a[28:31], a[48:51], v[248:251]
v_mfma_f32_16x16x32_bf16 v[252:255], a[28:31], a[52:55], v[252:255]
s_waitcnt lgkmcnt(0)
v_mfma_f32_16x16x32_bf16 v[64:67], a[96:99], a[64:67], v[64:67]
s_waitcnt vmcnt(16)
s_barrier
v_mfma_f32_16x16x32_bf16 v[68:71], a[100:103], a[64:67], v[68:71]
s_add_u32 m0, s40, 0
s_nop 0
buffer_load_dwordx4 v2, s[4:7], 0 offen lds
v_mfma_f32_16x16x32_bf16 v[72:75], a[104:107], a[64:67], v[72:75]
ds_read_b128 a[0:3], v6 offset:0
v_mfma_f32_16x16x32_bf16 v[76:79], a[108:111], a[64:67], v[76:79]
v_mfma_f32_16x16x32_bf16 v[80:83], a[64:67], a[112:115], v[80:83]
ds_read_b64_tr_b16 a[32:33], v8 offset:24576
v_mfma_f32_16x16x32_bf16 v[84:87], a[64:67], a[116:119], v[84:87]
buffer_load_dwordx4 v3, s[4:7], s64 offen offset:1024 lds
v_mfma_f32_16x16x32_bf16 v[88:91], a[96:99], a[68:71], v[88:91]
ds_read_b64_tr_b16 a[34:35], v8 offset:25088
v_mfma_f32_16x16x32_bf16 v[92:95], a[100:103], a[68:71], v[92:95]
v_mfma_f32_16x16x32_bf16 v[96:99], a[104:107], a[68:71], v[96:99]
ds_read_b64_tr_b16 a[36:37], v9 offset:24576
v_mfma_f32_16x16x32_bf16 v[100:103], a[108:111], a[68:71], v[100:103]
buffer_load_dwordx4 v2, s[4:7], s65 offen offset:2048 lds
v_mfma_f32_16x16x32_bf16 v[104:107], a[68:71], a[112:115], v[104:107]
ds_read_b64_tr_b16 a[38:39], v9 offset:25088
v_mfma_f32_16x16x32_bf16 v[108:111], a[68:71], a[116:119], v[108:111]
v_mfma_f32_16x16x32_bf16 v[112:115], a[96:99], a[72:75], v[112:115]
ds_read_b64_tr_b16 a[40:41], v8 offset:32768
v_mfma_f32_16x16x32_bf16 v[116:119], a[100:103], a[72:75], v[116:119]
buffer_load_dwordx4 v3, s[4:7], s66 offen offset:3072 lds
v_mfma_f32_16x16x32_bf16 v[120:123], a[104:107], a[72:75], v[120:123]
ds_read_b64_tr_b16 a[42:43], v8 offset:33280
v_mfma_f32_16x16x32_bf16 v[124:127], a[108:111], a[72:75], v[124:127]
v_mfma_f32_16x16x32_bf16 v[128:131], a[72:75], a[112:115], v[128:131]
ds_read_b64_tr_b16 a[44:45], v9 offset:32768
v_mfma_f32_16x16x32_bf16 v[132:135], a[72:75], a[116:119], v[132:135]
s_add_u32 m0, s40, 4096
s_nop 0
buffer_load_dwordx4 v2, s[4:7], s67 offen lds
v_mfma_f32_16x16x32_bf16 v[136:139], a[96:99], a[76:79], v[136:139]
ds_read_b64_tr_b16 a[46:47], v9 offset:33280
v_mfma_f32_16x16x32_bf16 v[140:143], a[100:103], a[76:79], v[140:143]
v_mfma_f32_16x16x32_bf16 v[144:147], a[104:107], a[76:79], v[144:147]
ds_read_b64_tr_b16 a[48:49], v8 offset:40960
v_mfma_f32_16x16x32_bf16 v[148:151], a[108:111], a[76:79], v[148:151]
buffer_load_dwordx4 v3, s[4:7], s68 offen offset:1024 lds
v_mfma_f32_16x16x32_bf16 v[152:155], a[76:79], a[112:115], v[152:155]
ds_read_b64_tr_b16 a[50:51], v8 offset:41472
v_mfma_f32_16x16x32_bf16 v[156:159], a[76:79], a[116:119], v[156:159]
v_mfma_f32_16x16x32_bf16 v[160:163], a[96:99], a[80:83], v[160:163]
ds_read_b64_tr_b16 a[52:53], v9 offset:40960
v_mfma_f32_16x16x32_bf16 v[164:167], a[100:103], a[80:83], v[164:167]
buffer_load_dwordx4 v2, s[4:7], s69 offen offset:2048 lds
v_mfma_f32_16x16x32_bf16 v[168:171], a[104:107], a[80:83], v[168:171]
ds_read_b64_tr_b16 a[54:55], v9 offset:41472
v_mfma_f32_16x16x32_bf16 v[172:175], a[108:111], a[80:83], v[172:175]
v_mfma_f32_16x16x32_bf16 v[176:179], a[80:83], a[112:115], v[176:179]
ds_read_b128 a[4:7], v6 offset:2048
v_mfma_f32_16x16x32_bf16 v[180:183], a[80:83], a[116:119], v[180:183]
buffer_load_dwordx4 v3, s[4:7], s70 offen offset:3072 lds
v_mfma_f32_16x16x32_bf16 v[184:187], a[96:99], a[84:87], v[184:187]
ds_read_b128 a[8:11], v6 offset:4096
v_mfma_f32_16x16x32_bf16 v[188:191], a[100:103], a[84:87], v[188:191]
v_mfma_f32_16x16x32_bf16 v[192:195], a[104:107], a[84:87], v[192:195]
ds_read_b128 a[12:15], v6 offset:6144
v_mfma_f32_16x16x32_bf16 v[196:199], a[108:111], a[84:87], v[196:199]
s_add_u32 m0, s40, 8192
s_nop 0
buffer_load_dwordx4 v2, s[4:7], s71 offen lds
v_mfma_f32_16x16x32_bf16 v[200:203], a[84:87], a[112:115], v[200:203]
ds_read_b128 a[16:19], v6 offset:8192
v_mfma_f32_16x16x32_bf16 v[204:207], a[84:87], a[116:119], v[204:207]
v_mfma_f32_16x16x32_bf16 v[208:211], a[96:99], a[88:91], v[208:211]
ds_read_b128 a[20:23], v6 offset:10240
v_mfma_f32_16x16x32_bf16 v[212:215], a[100:103], a[88:91], v[212:215]
buffer_load_dwordx4 v3, s[4:7], s72 offen offset:1024 lds
v_mfma_f32_16x16x32_bf16 v[216:219], a[104:107], a[88:91], v[216:219]
ds_read_b128 a[24:27], v6 offset:12288
v_mfma_f32_16x16x32_bf16 v[220:223], a[108:111], a[88:91], v[220:223]
v_mfma_f32_16x16x32_bf16 v[224:227], a[88:91], a[112:115], v[224:227]
ds_read_b128 a[28:31], v6 offset:14336
v_mfma_f32_16x16x32_bf16 v[228:231], a[88:91], a[116:119], v[228:231]
buffer_load_dwordx4 v2, s[4:7], s73 offen offset:2048 lds
v_mfma_f32_16x16x32_bf16 v[232:235], a[96:99], a[92:95], v[232:235]
v_mfma_f32_16x16x32_bf16 v[236:239], a[100:103], a[92:95], v[236:239]
v_mfma_f32_16x16x32_bf16 v[240:243], a[104:107], a[92:95], v[240:243]
v_mfma_f32_16x16x32_bf16 v[244:247], a[108:111], a[92:95], v[244:247]
buffer_load_dwordx4 v3, s[4:7], s74 offen offset:3072 lds
v_mfma_f32_16x16x32_bf16 v[248:251], a[92:95], a[112:115], v[248:251]
v_mfma_f32_16x16x32_bf16 v[252:255], a[92:95], a[116:119], v[252:255]
s_add_u32 s42, s42, 1
s_cmp_lt_u32 s42, 6
s_cbranch_scc1 .LB3_loop
.Ltail_B3:
s_waitcnt lgkmcnt(0)
v_mfma_f32_16x16x32_bf16 v[64:67], a[32:35], a[0:3], v[64:67]
ds_read_b128 a[64:67], v7 offset:0
v_mfma_f32_16x16x32_bf16 v[68:71], a[36:39], a[0:3], v[68:71]
s_add_u32 m0, s40, 12288
s_nop 0
buffer_load_dwordx4 v2, s[4:7], s75 offen lds
v_and_b32 v13, 15, v0
v_lshrrev_b32 v14, 4, v0
v_mfma_f32_16x16x32_bf16 v[72:75], a[40:43], a[0:3], v[72:75]
ds_read_b64_tr_b16 a[96:97], v8 offset:28672
v_mfma_f32_16x16x32_bf16 v[76:79], a[44:47], a[0:3], v[76:79]
s_and_b32 s24, s46, 1
s_lshr_b32 s25, s46, 1
v_mfma_f32_16x16x32_bf16 v[80:83], a[0:3], a[48:51], v[80:83]
ds_read_b64_tr_b16 a[98:99], v8 offset:29184
v_mfma_f32_16x16x32_bf16 v[84:87], a[0:3], a[52:55], v[84:87]
buffer_load_dwordx4 v3, s[4:7], s76 offen offset:1024 lds
s_lshl_b32 s26, s24, 15
s_lshl_b32 s27, s25, 13
v_mfma_f32_16x16x32_bf16 v[88:91], a[32:35], a[4:7], v[88:91]
ds_read_b64_tr_b16 a[100:101], v9 offset:28672
v_mfma_f32_16x16x32_bf16 v[92:95], a[36:39], a[4:7], v[92:95]
v_add_u32 v2, 0x80, v2
s_add_u32 s26, s26, s27
s_add_u32 s26, s26, 16384
v_mfma_f32_16x16x32_bf16 v[96:99], a[40:43], a[4:7], v[96:99]
ds_read_b64_tr_b16 a[102:103], v9 offset:29184
v_mfma_f32_16x16x32_bf16 v[100:103], a[44:47], a[4:7], v[100:103]
buffer_load_dword v12, v11, s[8:11], 0 offen
v_lshrrev_b32 v16, 1, v14
v_lshlrev_b32 v16, 9, v16
v_mfma_f32_16x16x32_bf16 v[104:107], a[4:7], a[48:51], v[104:107]
ds_read_b64_tr_b16 a[104:105], v8 offset:36864
v_mfma_f32_16x16x32_bf16 v[108:111], a[4:7], a[52:55], v[108:111]
v_add_u32 v3, 0x80, v3
v_add_u32 v10, 0x80, v10
v_lshlrev_b32 v17, 4, v13
v_add_u32 v16, v16, v17
v_mfma_f32_16x16x32_bf16 v[112:115], a[32:35], a[8:11], v[112:115]
ds_read_b64_tr_b16 a[106:107], v8 offset:37376
v_mfma_f32_16x16x32_bf16 v[116:119], a[36:39], a[8:11], v[116:119]
v_and_b32 v18, 1, v14
v_lshlrev_b32 v18, 10, v18
v_mfma_f32_16x16x32_bf16 v[120:123], a[40:43], a[8:11], v[120:123]
ds_read_b64_tr_b16 a[108:109], v9 offset:36864
v_mfma_f32_16x16x32_bf16 v[124:127], a[44:47], a[8:11], v[124:127]
s_mov_b32 s16, s87
v_add_u32 v11, s99, v11
v_add_u32 v16, v16, v18
v_add_u32 v24, s26, v16
v_mfma_f32_16x16x32_bf16 v[128:131], a[8:11], a[48:51], v[128:131]
ds_read_b64_tr_b16 a[110:111], v9 offset:37376
v_mfma_f32_16x16x32_bf16 v[132:135], a[8:11], a[52:55], v[132:135]
s_lshl_b32 s28, s24, 14
s_add_u32 s28, s28, s27
v_mfma_f32_16x16x32_bf16 v[136:139], a[32:35], a[12:15], v[136:139]
ds_read_b64_tr_b16 a[112:113], v8 offset:45056
v_mfma_f32_16x16x32_bf16 v[140:143], a[36:39], a[12:15], v[140:143]
s_mov_b32 s87, s88
v_add_u32 v19, s28, v16
s_add_u32 s28, s28, 131072
v_mfma_f32_16x16x32_bf16 v[144:147], a[40:43], a[12:15], v[144:147]
ds_read_b64_tr_b16 a[114:115], v8 offset:45568
v_mfma_f32_16x16x32_bf16 v[148:151], a[44:47], a[12:15], v[148:151]
v_add_u32 v26, s28, v16
v_and_b32 v16, 1, v14
v_mfma_f32_16x16x32_bf16 v[152:155], a[12:15], a[48:51], v[152:155]
ds_read_b64_tr_b16 a[116:117], v9 offset:45056
v_mfma_f32_16x16x32_bf16 v[156:159], a[12:15], a[52:55], v[156:159]
s_mov_b32 s88, s89
v_lshlrev_b32 v16, 9, v16
v_add_u32 v16, v16, v17
v_mfma_f32_16x16x32_bf16 v[160:163], a[32:35], a[16:19], v[160:163]
ds_read_b64_tr_b16 a[118:119], v9 offset:45568
v_mfma_f32_16x16x32_bf16 v[164:167], a[36:39], a[16:19], v[164:167]
v_lshrrev_b32 v18, 1, v14
v_lshlrev_b32 v18, 8, v18
v_mfma_f32_16x16x32_bf16 v[168:171], a[40:43], a[16:19], v[168:171]
ds_read_b128 a[68:71], v7 offset:2048
v_mfma_f32_16x16x32_bf16 v[172:175], a[44:47], a[16:19], v[172:175]
s_mov_b32 s89, s16
v_add_u32 v16, v16, v18
s_add_u32 s26, s26, 65536
v_mfma_f32_16x16x32_bf16 v[176:179], a[16:19], a[48:51], v[176:179]
ds_read_b128 a[72:75], v7 offset:4096
v_mfma_f32_16x16x32_bf16 v[180:183], a[16:19], a[52:55], v[180:183]
v_add_u32 v25, s26, v16
s_sub_u32 s28, s28, 98304
v_mfma_f32_16x16x32_bf16 v[184:187], a[32:35], a[20:23], v[184:187]
ds_read_b128 a[76:79], v7 offset:6144
v_mfma_f32_16x16x32_bf16 v[188:191], a[36:39], a[20:23], v[188:191]
s_mov_b32 s40, s87
v_add_u32 v1, s28, v16
v_accvgpr_write_b32 a250, v19
v_mfma_f32_16x16x32_bf16 v[192:195], a[40:43], a[20:23], v[192:195]
ds_read_b128 a[80:83], v7 offset:8192
v_mfma_f32_16x16x32_bf16 v[196:199], a[44:47], a[20:23], v[196:199]
v_accvgpr_write_b32 a251, v1
v_lshlrev_b32 v27, 4, v0
v_mfma_f32_16x16x32_bf16 v[200:203], a[20:23], a[48:51], v[200:203]
ds_read_b128 a[84:87], v7 offset:10240
v_mfma_f32_16x16x32_bf16 v[204:207], a[20:23], a[52:55], v[204:207]
s_lshl_b32 s26, s24, 15
s_lshl_b32 s27, s25, 11
v_mfma_f32_16x16x32_bf16 v[208:211], a[32:35], a[24:27], v[208:211]
ds_read_b128 a[88:91], v7 offset:12288
v_mfma_f32_16x16x32_bf16 v[212:215], a[36:39], a[24:27], v[212:215]
s_add_u32 s26, s26, s27
v_add_u32 v28, s26, v27
v_mfma_f32_16x16x32_bf16 v[216:219], a[40:43], a[24:27], v[216:219]
ds_read_b128 a[92:95], v7 offset:14336
v_mfma_f32_16x16x32_bf16 v[220:223], a[44:47], a[24:27], v[220:223]
v_add_u32 v29, 65536, v28
s_lshl_b32 s26, s24, 14
v_mfma_f32_16x16x32_bf16 v[224:227], a[24:27], a[48:51], v[224:227]
v_add_u32 v7, s92, v7
s_add_u32 s26, s26, s27
v_mfma_f32_16x16x32_bf16 v[228:231], a[24:27], a[52:55], v[228:231]
v_add_u32 v6, s92, v6
s_add_u32 s26, s26, 131072
v_add_u32 v31, s26, v27
v_mfma_f32_16x16x32_bf16 v[232:235], a[32:35], a[28:31], v[232:235]
s_mov_b32 s17, s92
v_bfe_u32 v16, v0, 4, 1
v_mfma_f32_16x16x32_bf16 v[236:239], a[36:39], a[28:31], v[236:239]
s_mov_b32 s92, s93
v_lshlrev_b32 v16, 15, v16
v_lshrrev_b32 v17, 5, v0
v_mfma_f32_16x16x32_bf16 v[240:243], a[40:43], a[28:31], v[240:243]
s_mov_b32 s93, s94
v_lshlrev_b32 v18, 8, v17
v_mfma_f32_16x16x32_bf16 v[244:247], a[44:47], a[28:31], v[244:247]
s_mov_b32 s94, s17
v_add_u32 v16, v16, v18
v_and_b32 v18, 15, v0
v_mfma_f32_16x16x32_bf16 v[248:251], a[28:31], a[48:51], v[248:251]
v_lshlrev_b32 v18, 4, v18
v_mfma_f32_16x16x32_bf16 v[252:255], a[28:31], a[52:55], v[252:255]
v_add_u32 v30, v16, v18
v_and_b32 v16, 31, v0
s_waitcnt lgkmcnt(0)
v_mfma_f32_16x16x32_bf16 v[64:67], a[96:99], a[64:67], v[64:67]
s_waitcnt vmcnt(16)
s_barrier
v_mfma_f32_16x16x32_bf16 v[68:71], a[100:103], a[64:67], v[68:71]
v_lshlrev_b32 v17, 2, v17
v_sub_u32 v15, v16, v17
v_mfma_f32_16x16x32_bf16 v[72:75], a[104:107], a[64:67], v[72:75]
ds_read_b128 a[0:3], v6 offset:0
v_mfma_f32_16x16x32_bf16 v[76:79], a[108:111], a[64:67], v[76:79]
s_getpc_b64 s[20:21]
.Lpc_lateB3:
s_add_u32 s20, s20, .Lph2_A-.Lpc_lateB3
s_addc_u32 s21, s21, 0
v_lshlrev_b32 v10, 7, v0
v_min_u32 v11, .Lall_text_end-.Lph2_A-4, v10
global_load_dword v12, v11, s[20:21]
v_add_u32 v10, 0x2000, v10
v_min_u32 v11, .Lall_text_end-.Lph2_A-4, v10
global_load_dword v12, v11, s[20:21]
v_add_u32 v10, 0x2000, v10
v_min_u32 v11, .Lall_text_end-.Lph2_A-4, v10
global_load_dword v12, v11, s[20:21]
v_add_u32 v10, 0x2000, v10
v_min_u32 v11, .Lall_text_end-.Lph2_A-4, v10
global_load_dword v12, v11, s[20:21]
v_add_u32 v10, 0x2000, v10
v_min_u32 v11, .Lall_text_end-.Lph2_A-4, v10
global_load_dword v12, v11, s[20:21]
v_mov_b32 v13, 0xffff
v_mov_b32 v14, 0xffff0000
v_mfma_f32_16x16x32_bf16 v[80:83], a[64:67], a[112:115], v[80:83]
ds_read_b64_tr_b16 a[32:33], v8 offset:0
v_mfma_f32_16x16x32_bf16 v[84:87], a[64:67], a[116:119], v[84:87]
v_cmp_le_i32 vcc, 0, v15
v_cmp_le_i32 s[28:29], 1, v15
v_mfma_f32_16x16x32_bf16 v[88:91], a[96:99], a[68:71], v[88:91]
ds_read_b64_tr_b16 a[34:35], v8 offset:512
v_mfma_f32_16x16x32_bf16 v[92:95], a[100:103], a[68:71], v[92:95]
s_nop 0
v_cndmask_b32 v1, 0, v13, vcc
v_mfma_f32_16x16x32_bf16 v[96:99], a[104:107], a[68:71], v[96:99]
ds_read_b64_tr_b16 a[36:37], v9 offset:0
v_mfma_f32_16x16x32_bf16 v[100:103], a[108:111], a[68:71], v[100:103]
v_cndmask_b32 v16, 0, v14, s[28:29]
v_or_b32 v16, v16, v1
v_mfma_f32_16x16x32_bf16 v[104:107], a[68:71], a[112:115], v[104:107]
ds_read_b64_tr_b16 a[38:39], v9 offset:512
v_mfma_f32_16x16x32_bf16 v[108:111], a[68:71], a[116:119], v[108:111]
v_cmp_le_i32 vcc, 2, v15
v_cmp_le_i32 s[28:29], 3, v15
v_mfma_f32_16x16x32_bf16 v[112:115], a[96:99], a[72:75], v[112:115]
ds_read_b64_tr_b16 a[40:41], v8 offset:8192
v_mfma_f32_16x16x32_bf16 v[116:119], a[100:103], a[72:75], v[116:119]
s_nop 0
v_cndmask_b32 v1, 0, v13, vcc
v_mfma_f32_16x16x32_bf16 v[120:123], a[104:107], a[72:75], v[120:123]
ds_read_b64_tr_b16 a[42:43], v8 offset:8704
v_mfma_f32_16x16x32_bf16 v[124:127], a[108:111], a[72:75], v[124:127]
v_cndmask_b32 v17, 0, v14, s[28:29]
v_or_b32 v17, v17, v1
v_mfma_f32_16x16x32_bf16 v[128:131], a[72:75], a[112:115], v[128:131]
ds_read_b64_tr_b16 a[44:45], v9 offset:8192
v_mfma_f32_16x16x32_bf16 v[132:135], a[72:75], a[116:119], v[132:135]
v_cmp_le_i32 vcc, 8, v15
v_cmp_le_i32 s[28:29], 9, v15
v_mfma_f32_16x16x32_bf16 v[136:139], a[96:99], a[76:79], v[136:139]
ds_read_b64_tr_b16 a[46:47], v9 offset:8704
v_mfma_f32_16x16x32_bf16 v[140:143], a[100:103], a[76:79], v[140:143]
s_nop 0
v_cndmask_b32 v1, 0, v13, vcc
v_mfma_f32_16x16x32_bf16 v[144:147], a[104:107], a[76:79], v[144:147]
ds_read_b64_tr_b16 a[48:49], v8 offset:16384
v_mfma_f32_16x16x32_bf16 v[148:151], a[108:111], a[76:79], v[148:151]
v_cndmask_b32 v18, 0, v14, s[28:29]
v_or_b32 v18, v18, v1
v_mfma_f32_16x16x32_bf16 v[152:155], a[76:79], a[112:115], v[152:155]
ds_read_b64_tr_b16 a[50:51], v8 offset:16896
v_mfma_f32_16x16x32_bf16 v[156:159], a[76:79], a[116:119], v[156:159]
v_cmp_le_i32 vcc, 10, v15
v_cmp_le_i32 s[28:29], 11, v15
v_mfma_f32_16x16x32_bf16 v[160:163], a[96:99], a[80:83], v[160:163]
ds_read_b64_tr_b16 a[52:53], v9 offset:16384
v_mfma_f32_16x16x32_bf16 v[164:167], a[100:103], a[80:83], v[164:167]
s_nop 0
v_cndmask_b32 v1, 0, v13, vcc
v_mfma_f32_16x16x32_bf16 v[168:171], a[104:107], a[80:83], v[168:171]
ds_read_b64_tr_b16 a[54:55], v9 offset:16896
v_mfma_f32_16x16x32_bf16 v[172:175], a[108:111], a[80:83], v[172:175]
v_cndmask_b32 v19, 0, v14, s[28:29]
v_or_b32 v19, v19, v1
v_mfma_f32_16x16x32_bf16 v[176:179], a[80:83], a[112:115], v[176:179]
ds_read_b128 a[4:7], v6 offset:2048
v_mfma_f32_16x16x32_bf16 v[180:183], a[80:83], a[116:119], v[180:183]
v_cmp_le_i32 vcc, 16, v15
v_cmp_le_i32 s[28:29], 17, v15
v_mfma_f32_16x16x32_bf16 v[184:187], a[96:99], a[84:87], v[184:187]
ds_read_b128 a[8:11], v6 offset:4096
v_mfma_f32_16x16x32_bf16 v[188:191], a[100:103], a[84:87], v[188:191]
s_nop 0
v_cndmask_b32 v1, 0, v13, vcc
v_mfma_f32_16x16x32_bf16 v[192:195], a[104:107], a[84:87], v[192:195]
ds_read_b128 a[12:15], v6 offset:6144
v_mfma_f32_16x16x32_bf16 v[196:199], a[108:111], a[84:87], v[196:199]
v_cndmask_b32 v20, 0, v14, s[28:29]
v_or_b32 v20, v20, v1
v_mfma_f32_16x16x32_bf16 v[200:203], a[84:87], a[112:115], v[200:203]
ds_read_b128 a[16:19], v6 offset:8192
v_mfma_f32_16x16x32_bf16 v[204:207], a[84:87], a[116:119], v[204:207]
v_cmp_le_i32 vcc, 18, v15
v_cmp_le_i32 s[28:29], 19, v15
v_mfma_f32_16x16x32_bf16 v[208:211], a[96:99], a[88:91], v[208:211]
ds_read_b128 a[20:23], v6 offset:10240
v_mfma_f32_16x16x32_bf16 v[212:215], a[100:103], a[88:91], v[212:215]
s_nop 0
v_cndmask_b32 v1, 0, v13, vcc
v_mfma_f32_16x16x32_bf16 v[216:219], a[104:107], a[88:91], v[216:219]
ds_read_b128 a[24:27], v6 offset:12288
v_mfma_f32_16x16x32_bf16 v[220:223], a[108:111], a[88:91], v[220:223]
v_cndmask_b32 v21, 0, v14, s[28:29]
v_or_b32 v21, v21, v1
v_mfma_f32_16x16x32_bf16 v[224:227], a[88:91], a[112:115], v[224:227]
ds_read_b128 a[28:31], v6 offset:14336
v_cmp_le_i32 vcc, 24, v15
v_mfma_f32_16x16x32_bf16 v[228:231], a[88:91], a[116:119], v[228:231]
v_cmp_le_i32 s[28:29], 25, v15
s_nop 0
v_mfma_f32_16x16x32_bf16 v[232:235], a[96:99], a[92:95], v[232:235]
v_cndmask_b32 v1, 0, v13, vcc
v_mfma_f32_16x16x32_bf16 v[236:239], a[100:103], a[92:95], v[236:239]
v_cndmask_b32 v22, 0, v14, s[28:29]
v_or_b32 v22, v22, v1
v_mfma_f32_16x16x32_bf16 v[240:243], a[104:107], a[92:95], v[240:243]
v_cmp_le_i32 vcc, 26, v15
v_mfma_f32_16x16x32_bf16 v[244:247], a[108:111], a[92:95], v[244:247]
v_cmp_le_i32 s[28:29], 27, v15
s_nop 0
v_mfma_f32_16x16x32_bf16 v[248:251], a[92:95], a[112:115], v[248:251]
v_cndmask_b32 v1, 0, v13, vcc
v_mfma_f32_16x16x32_bf16 v[252:255], a[92:95], a[116:119], v[252:255]
v_cndmask_b32 v23, 0, v14, s[28:29]
v_or_b32 v23, v23, v1
s_waitcnt lgkmcnt(0)
v_mfma_f32_16x16x32_bf16 v[64:67], a[32:35], a[0:3], v[64:67]
ds_read_b128 a[64:67], v7 offset:0
v_mfma_f32_16x16x32_bf16 v[68:71], a[36:39], a[0:3], v[68:71]
s_cmp_eq_u32 s44, 0
s_cselect_b32 s24, 4048155338, 0
s_cmp_lt_u32 s46, 2
s_cselect_b32 s25, s24, 0
v_mfma_f32_16x16x32_bf16 v[72:75], a[40:43], a[0:3], v[72:75]
ds_read_b64_tr_b16 a[96:97], v8 offset:4096
v_mfma_f32_16x16x32_bf16 v[76:79], a[44:47], a[0:3], v[76:79]
v_mov_b32 v32, s25
v_mov_b32 v48, s24
v_mfma_f32_16x16x32_bf16 v[80:83], a[0:3], a[48:51], v[80:83]
ds_read_b64_tr_b16 a[98:99], v8 offset:4608
v_mfma_f32_16x16x32_bf16 v[84:87], a[0:3], a[52:55], v[84:87]
v_mov_b32 v33, s25
v_mov_b32 v49, s24
v_mfma_f32_16x16x32_bf16 v[88:91], a[32:35], a[4:7], v[88:91]
ds_read_b64_tr_b16 a[100:101], v9 offset:4096
v_mfma_f32_16x16x32_bf16 v[92:95], a[36:39], a[4:7], v[92:95]
v_mov_b32 v34, s25
v_mov_b32 v50, s24
v_mfma_f32_16x16x32_bf16 v[96:99], a[40:43], a[4:7], v[96:99]
ds_read_b64_tr_b16 a[102:103], v9 offset:4608
v_mfma_f32_16x16x32_bf16 v[100:103], a[44:47], a[4:7], v[100:103]
v_mov_b32 v35, s25
v_mov_b32 v51, s24
v_mfma_f32_16x16x32_bf16 v[104:107], a[4:7], a[48:51], v[104:107]
ds_read_b64_tr_b16 a[104:105], v8 offset:12288
v_mfma_f32_16x16x32_bf16 v[108:111], a[4:7], a[52:55], v[108:111]
v_mov_b32 v36, s25
v_mov_b32 v52, s24
v_mfma_f32_16x16x32_bf16 v[112:115], a[32:35], a[8:11], v[112:115]
ds_read_b64_tr_b16 a[106:107], v8 offset:12800
v_mfma_f32_16x16x32_bf16 v[116:119], a[36:39], a[8:11], v[116:119]
v_mov_b32 v37, s25
v_mov_b32 v53, s24
v_mfma_f32_16x16x32_bf16 v[120:123], a[40:43], a[8:11], v[120:123]
ds_read_b64_tr_b16 a[108:109], v9 offset:12288
v_mfma_f32_16x16x32_bf16 v[124:127], a[44:47], a[8:11], v[124:127]
v_mov_b32 v38, s25
v_mov_b32 v54, s24
v_mfma_f32_16x16x32_bf16 v[128:131], a[8:11], a[48:51], v[128:131]
ds_read_b64_tr_b16 a[110:111], v9 offset:12800
v_mfma_f32_16x16x32_bf16 v[132:135], a[8:11], a[52:55], v[132:135]
v_mov_b32 v39, s25
v_mov_b32 v55, s24
v_mfma_f32_16x16x32_bf16 v[136:139], a[32:35], a[12:15], v[136:139]
ds_read_b64_tr_b16 a[112:113], v8 offset:20480
v_mfma_f32_16x16x32_bf16 v[140:143], a[36:39], a[12:15], v[140:143]
v_mov_b32 v40, s25
v_mov_b32 v56, s24
v_mfma_f32_16x16x32_bf16 v[144:147], a[40:43], a[12:15], v[144:147]
ds_read_b64_tr_b16 a[114:115], v8 offset:20992
v_mfma_f32_16x16x32_bf16 v[148:151], a[44:47], a[12:15], v[148:151]
v_mov_b32 v41, s25
v_mov_b32 v57, s24
v_mfma_f32_16x16x32_bf16 v[152:155], a[12:15], a[48:51], v[152:155]
ds_read_b64_tr_b16 a[116:117], v9 offset:20480
v_mfma_f32_16x16x32_bf16 v[156:159], a[12:15], a[52:55], v[156:159]
v_mov_b32 v42, s25
v_mov_b32 v58, s24
v_mfma_f32_16x16x32_bf16 v[160:163], a[32:35], a[16:19], v[160:163]
ds_read_b64_tr_b16 a[118:119], v9 offset:20992
v_mfma_f32_16x16x32_bf16 v[164:167], a[36:39], a[16:19], v[164:167]
v_mov_b32 v43, s25
v_mov_b32 v59, s24
v_mfma_f32_16x16x32_bf16 v[168:171], a[40:43], a[16:19], v[168:171]
ds_read_b128 a[68:71], v7 offset:2048
v_mfma_f32_16x16x32_bf16 v[172:175], a[44:47], a[16:19], v[172:175]
v_mov_b32 v44, s25
v_mov_b32 v60, s24
v_mfma_f32_16x16x32_bf16 v[176:179], a[16:19], a[48:51], v[176:179]
ds_read_b128 a[72:75], v7 offset:4096
v_mfma_f32_16x16x32_bf16 v[180:183], a[16:19], a[52:55], v[180:183]
v_mov_b32 v45, s25
v_mov_b32 v61, s24
v_mfma_f32_16x16x32_bf16 v[184:187], a[32:35], a[20:23], v[184:187]
ds_read_b128 a[76:79], v7 offset:6144
v_mfma_f32_16x16x32_bf16 v[188:191], a[36:39], a[20:23], v[188:191]
v_mov_b32 v46, s25
v_mov_b32 v62, s24
v_mfma_f32_16x16x32_bf16 v[192:195], a[40:43], a[20:23], v[192:195]
ds_read_b128 a[80:83], v7 offset:8192
v_mfma_f32_16x16x32_bf16 v[196:199], a[44:47], a[20:23], v[196:199]
v_mov_b32 v47, s25
v_mov_b32 v63, s24
v_mfma_f32_16x16x32_bf16 v[200:203], a[20:23], a[48:51], v[200:203]
ds_read_b128 a[84:87], v7 offset:10240
v_mfma_f32_16x16x32_bf16 v[204:207], a[20:23], a[52:55], v[204:207]
s_lshl_b32 s36, s44, 4
s_add_u32 s36, s36, s45
v_mfma_f32_16x16x32_bf16 v[208:211], a[32:35], a[24:27], v[208:211]
ds_read_b128 a[88:91], v7 offset:12288
v_mfma_f32_16x16x32_bf16 v[212:215], a[36:39], a[24:27], v[212:215]
s_lshl_b32 s36, s36, 16
s_add_u32 s36, s36, 16777216
v_mfma_f32_16x16x32_bf16 v[216:219], a[40:43], a[24:27], v[216:219]
ds_read_b128 a[92:95], v7 offset:14336
v_mfma_f32_16x16x32_bf16 v[220:223], a[44:47], a[24:27], v[220:223]
v_accvgpr_read_b32 v2, a250
v_accvgpr_read_b32 v3, a251
v_mfma_f32_16x16x32_bf16 v[224:227], a[24:27], a[48:51], v[224:227]
v_add_u32 v7, s92, v7
s_mov_b32 s22, 1048744942
v_mfma_f32_16x16x32_bf16 v[228:231], a[24:27], a[52:55], v[228:231]
v_add_u32 v6, s92, v6
s_mov_b32 s23, 1048744942
s_mov_b32 s24, s12
v_mfma_f32_16x16x32_bf16 v[232:235], a[32:35], a[28:31], v[232:235]
s_mov_b32 s17, s92
s_mov_b32 s25, s13
v_mfma_f32_16x16x32_bf16 v[236:239], a[36:39], a[28:31], v[236:239]
s_mov_b32 s92, s93
s_mov_b32 s27, 0x20000
s_cmp_ge_u32 s46, 2
s_cselect_b32 s26, 0x10000000, 0
v_mfma_f32_16x16x32_bf16 v[240:243], a[40:43], a[28:31], v[240:243]
s_mov_b32 s93, s94
s_add_u32 s4, s36, 0
v_mfma_f32_16x16x32_bf16 v[244:247], a[44:47], a[28:31], v[244:247]
s_mov_b32 s94, s17
s_add_u32 s5, s36, 2048
s_add_u32 s6, s36, 4096
v_mfma_f32_16x16x32_bf16 v[248:251], a[28:31], a[48:51], v[248:251]
s_add_u32 s7, s36, 6144
v_mfma_f32_16x16x32_bf16 v[252:255], a[28:31], a[52:55], v[252:255]
s_waitcnt lgkmcnt(0)
v_mfma_f32_16x16x32_bf16 v[64:67], a[96:99], a[64:67], v[64:67]
s_waitcnt vmcnt(0)
s_barrier
v_mfma_f32_16x16x32_bf16 v[68:71], a[100:103], a[64:67], v[68:71]
v_mfma_f32_16x16x32_bf16 v[72:75], a[104:107], a[64:67], v[72:75]
ds_read_b128 a[0:3], v6 offset:0
v_mfma_f32_16x16x32_bf16 v[76:79], a[108:111], a[64:67], v[76:79]
v_mfma_f32_16x16x32_bf16 v[80:83], a[64:67], a[112:115], v[80:83]
ds_read_b64_tr_b16 a[32:33], v8 offset:24576
v_mfma_f32_16x16x32_bf16 v[84:87], a[64:67], a[116:119], v[84:87]
v_mfma_f32_16x16x32_bf16 v[88:91], a[96:99], a[68:71], v[88:91]
ds_read_b64_tr_b16 a[34:35], v8 offset:25088
v_mfma_f32_16x16x32_bf16 v[92:95], a[100:103], a[68:71], v[92:95]
v_mfma_f32_16x16x32_bf16 v[96:99], a[104:107], a[68:71], v[96:99]
ds_read_b64_tr_b16 a[36:37], v9 offset:24576
v_mfma_f32_16x16x32_bf16 v[100:103], a[108:111], a[68:71], v[100:103]
v_mfma_f32_16x16x32_bf16 v[104:107], a[68:71], a[112:115], v[104:107]
ds_read_b64_tr_b16 a[38:39], v9 offset:25088
v_mfma_f32_16x16x32_bf16 v[108:111], a[68:71], a[116:119], v[108:111]
v_mfma_f32_16x16x32_bf16 v[112:115], a[96:99], a[72:75], v[112:115]
ds_read_b64_tr_b16 a[40:41], v8 offset:32768
v_mfma_f32_16x16x32_bf16 v[116:119], a[100:103], a[72:75], v[116:119]
v_mfma_f32_16x16x32_bf16 v[120:123], a[104:107], a[72:75], v[120:123]
ds_read_b64_tr_b16 a[42:43], v8 offset:33280
v_mfma_f32_16x16x32_bf16 v[124:127], a[108:111], a[72:75], v[124:127]
v_mfma_f32_16x16x32_bf16 v[128:131], a[72:75], a[112:115], v[128:131]
ds_read_b64_tr_b16 a[44:45], v9 offset:32768
v_mfma_f32_16x16x32_bf16 v[132:135], a[72:75], a[116:119], v[132:135]
v_mfma_f32_16x16x32_bf16 v[136:139], a[96:99], a[76:79], v[136:139]
ds_read_b64_tr_b16 a[46:47], v9 offset:33280
v_mfma_f32_16x16x32_bf16 v[140:143], a[100:103], a[76:79], v[140:143]
v_mfma_f32_16x16x32_bf16 v[144:147], a[104:107], a[76:79], v[144:147]
ds_read_b64_tr_b16 a[48:49], v8 offset:40960
v_mfma_f32_16x16x32_bf16 v[148:151], a[108:111], a[76:79], v[148:151]
v_mfma_f32_16x16x32_bf16 v[152:155], a[76:79], a[112:115], v[152:155]
ds_read_b64_tr_b16 a[50:51], v8 offset:41472
v_mfma_f32_16x16x32_bf16 v[156:159], a[76:79], a[116:119], v[156:159]
v_mfma_f32_16x16x32_bf16 v[160:163], a[96:99], a[80:83], v[160:163]
ds_read_b64_tr_b16 a[52:53], v9 offset:40960
v_mfma_f32_16x16x32_bf16 v[164:167], a[100:103], a[80:83], v[164:167]
v_mfma_f32_16x16x32_bf16 v[168:171], a[104:107], a[80:83], v[168:171]
ds_read_b64_tr_b16 a[54:55], v9 offset:41472
v_mfma_f32_16x16x32_bf16 v[172:175], a[108:111], a[80:83], v[172:175]
v_mfma_f32_16x16x32_bf16 v[176:179], a[80:83], a[112:115], v[176:179]
ds_read_b128 a[4:7], v6 offset:2048
v_mfma_f32_16x16x32_bf16 v[180:183], a[80:83], a[116:119], v[180:183]
v_mfma_f32_16x16x32_bf16 v[184:187], a[96:99], a[84:87], v[184:187]
ds_read_b128 a[8:11], v6 offset:4096
v_mfma_f32_16x16x32_bf16 v[188:191], a[100:103], a[84:87], v[188:191]
v_mfma_f32_16x16x32_bf16 v[192:195], a[104:107], a[84:87], v[192:195]
ds_read_b128 a[12:15], v6 offset:6144
v_mfma_f32_16x16x32_bf16 v[196:199], a[108:111], a[84:87], v[196:199]
v_mfma_f32_16x16x32_bf16 v[200:203], a[84:87], a[112:115], v[200:203]
ds_read_b128 a[16:19], v6 offset:8192
v_mfma_f32_16x16x32_bf16 v[204:207], a[84:87], a[116:119], v[204:207]
v_mfma_f32_16x16x32_bf16 v[208:211], a[96:99], a[88:91], v[208:211]
ds_read_b128 a[20:23], v6 offset:10240
v_mfma_f32_16x16x32_bf16 v[212:215], a[100:103], a[88:91], v[212:215]
v_mfma_f32_16x16x32_bf16 v[216:219], a[104:107], a[88:91], v[216:219]
ds_read_b128 a[24:27], v6 offset:12288
v_mfma_f32_16x16x32_bf16 v[220:223], a[108:111], a[88:91], v[220:223]
v_mfma_f32_16x16x32_bf16 v[224:227], a[88:91], a[112:115], v[224:227]
ds_read_b128 a[28:31], v6 offset:14336
v_mfma_f32_16x16x32_bf16 v[228:231], a[88:91], a[116:119], v[228:231]
v_mfma_f32_16x16x32_bf16 v[232:235], a[96:99], a[92:95], v[232:235]
v_mfma_f32_16x16x32_bf16 v[236:239], a[100:103], a[92:95], v[236:239]
v_mfma_f32_16x16x32_bf16 v[240:243], a[104:107], a[92:95], v[240:243]
v_mfma_f32_16x16x32_bf16 v[244:247], a[108:111], a[92:95], v[244:247]
v_mfma_f32_16x16x32_bf16 v[248:251], a[92:95], a[112:115], v[248:251]
v_mfma_f32_16x16x32_bf16 v[252:255], a[92:95], a[116:119], v[252:255]
s_waitcnt lgkmcnt(0)
v_mfma_f32_16x16x32_bf16 v[64:67], a[32:35], a[0:3], v[64:67]
ds_read_b128 a[64:67], v7 offset:0
v_mfma_f32_16x16x32_bf16 v[68:71], a[36:39], a[0:3], v[68:71]
v_mfma_f32_16x16x32_bf16 v[72:75], a[40:43], a[0:3], v[72:75]
ds_read_b64_tr_b16 a[96:97], v8 offset:28672
v_mfma_f32_16x16x32_bf16 v[76:79], a[44:47], a[0:3], v[76:79]
v_mfma_f32_16x16x32_bf16 v[80:83], a[0:3], a[48:51], v[80:83]
ds_read_b64_tr_b16 a[98:99], v8 offset:29184
v_mfma_f32_16x16x32_bf16 v[84:87], a[0:3], a[52:55], v[84:87]
v_mfma_f32_16x16x32_bf16 v[88:91], a[32:35], a[4:7], v[88:91]
ds_read_b64_tr_b16 a[100:101], v9 offset:28672
v_mfma_f32_16x16x32_bf16 v[92:95], a[36:39], a[4:7], v[92:95]
v_mfma_f32_16x16x32_bf16 v[96:99], a[40:43], a[4:7], v[96:99]
ds_read_b64_tr_b16 a[102:103], v9 offset:29184
v_mfma_f32_16x16x32_bf16 v[100:103], a[44:47], a[4:7], v[100:103]
v_mfma_f32_16x16x32_bf16 v[104:107], a[4:7], a[48:51], v[104:107]
ds_read_b64_tr_b16 a[104:105], v8 offset:36864
v_mfma_f32_16x16x32_bf16 v[108:111], a[4:7], a[52:55], v[108:111]
v_mfma_f32_16x16x32_bf16 v[112:115], a[32:35], a[8:11], v[112:115]
ds_read_b64_tr_b16 a[106:107], v8 offset:37376
v_mfma_f32_16x16x32_bf16 v[116:119], a[36:39], a[8:11], v[116:119]
v_mfma_f32_16x16x32_bf16 v[120:123], a[40:43], a[8:11], v[120:123]
ds_read_b64_tr_b16 a[108:109], v9 offset:36864
v_mfma_f32_16x16x32_bf16 v[124:127], a[44:47], a[8:11], v[124:127]
v_mfma_f32_16x16x32_bf16 v[128:131], a[8:11], a[48:51], v[128:131]
ds_read_b64_tr_b16 a[110:111], v9 offset:37376
v_mfma_f32_16x16x32_bf16 v[132:135], a[8:11], a[52:55], v[132:135]
v_mfma_f32_16x16x32_bf16 v[136:139], a[32:35], a[12:15], v[136:139]
ds_read_b64_tr_b16 a[112:113], v8 offset:45056
v_mfma_f32_16x16x32_bf16 v[140:143], a[36:39], a[12:15], v[140:143]
v_mfma_f32_16x16x32_bf16 v[144:147], a[40:43], a[12:15], v[144:147]
ds_read_b64_tr_b16 a[114:115], v8 offset:45568
v_mfma_f32_16x16x32_bf16 v[148:151], a[44:47], a[12:15], v[148:151]
v_mfma_f32_16x16x32_bf16 v[152:155], a[12:15], a[48:51], v[152:155]
ds_read_b64_tr_b16 a[116:117], v9 offset:45056
v_mfma_f32_16x16x32_bf16 v[156:159], a[12:15], a[52:55], v[156:159]
v_mfma_f32_16x16x32_bf16 v[160:163], a[32:35], a[16:19], v[160:163]
ds_read_b64_tr_b16 a[118:119], v9 offset:45568
v_mfma_f32_16x16x32_bf16 v[164:167], a[36:39], a[16:19], v[164:167]
v_mfma_f32_16x16x32_bf16 v[168:171], a[40:43], a[16:19], v[168:171]
ds_read_b128 a[68:71], v7 offset:2048
v_mfma_f32_16x16x32_bf16 v[172:175], a[44:47], a[16:19], v[172:175]
v_mfma_f32_16x16x32_bf16 v[176:179], a[16:19], a[48:51], v[176:179]
ds_read_b128 a[72:75], v7 offset:4096
v_mfma_f32_16x16x32_bf16 v[180:183], a[16:19], a[52:55], v[180:183]
v_mfma_f32_16x16x32_bf16 v[184:187], a[32:35], a[20:23], v[184:187]
ds_read_b128 a[76:79], v7 offset:6144
v_mfma_f32_16x16x32_bf16 v[188:191], a[36:39], a[20:23], v[188:191]
v_mfma_f32_16x16x32_bf16 v[192:195], a[40:43], a[20:23], v[192:195]
ds_read_b128 a[80:83], v7 offset:8192
v_mfma_f32_16x16x32_bf16 v[196:199], a[44:47], a[20:23], v[196:199]
v_mfma_f32_16x16x32_bf16 v[200:203], a[20:23], a[48:51], v[200:203]
ds_read_b128 a[84:87], v7 offset:10240
v_mfma_f32_16x16x32_bf16 v[204:207], a[20:23], a[52:55], v[204:207]
v_mfma_f32_16x16x32_bf16 v[208:211], a[32:35], a[24:27], v[208:211]
ds_read_b128 a[88:91], v7 offset:12288
v_mfma_f32_16x16x32_bf16 v[212:215], a[36:39], a[24:27], v[212:215]
v_mfma_f32_16x16x32_bf16 v[216:219], a[40:43], a[24:27], v[216:219]
ds_read_b128 a[92:95], v7 offset:14336
v_mfma_f32_16x16x32_bf16 v[220:223], a[44:47], a[24:27], v[220:223]
v_mfma_f32_16x16x32_bf16 v[224:227], a[24:27], a[48:51], v[224:227]
v_add_u32 v7, s92, v7
v_mfma_f32_16x16x32_bf16 v[228:231], a[24:27], a[52:55], v[228:231]
v_add_u32 v6, s92, v6
v_mfma_f32_16x16x32_bf16 v[232:235], a[32:35], a[28:31], v[232:235]
s_mov_b32 s17, s92
v_mfma_f32_16x16x32_bf16 v[236:239], a[36:39], a[28:31], v[236:239]
s_mov_b32 s92, s93
v_mfma_f32_16x16x32_bf16 v[240:243], a[40:43], a[28:31], v[240:243]
s_mov_b32 s93, s94
v_mfma_f32_16x16x32_bf16 v[244:247], a[44:47], a[28:31], v[244:247]
s_mov_b32 s94, s17
v_mfma_f32_16x16x32_bf16 v[248:251], a[28:31], a[48:51], v[248:251]
v_mfma_f32_16x16x32_bf16 v[252:255], a[28:31], a[52:55], v[252:255]
s_waitcnt lgkmcnt(0)
v_mfma_f32_16x16x32_bf16 v[232:235], a[96:99], a[92:95], v[232:235]
s_barrier
v_mfma_f32_16x16x32_bf16 v[236:239], a[100:103], a[92:95], v[236:239]
v_mfma_f32_16x16x32_bf16 v[240:243], a[104:107], a[92:95], v[240:243]
v_mfma_f32_16x16x32_bf16 v[244:247], a[108:111], a[92:95], v[244:247]
v_mfma_f32_16x16x32_bf16 v[248:251], a[92:95], a[112:115], v[248:251]
v_mfma_f32_16x16x32_bf16 v[252:255], a[92:95], a[116:119], v[252:255]
v_mfma_f32_16x16x32_bf16 v[208:211], a[96:99], a[88:91], v[208:211]
v_mfma_f32_16x16x32_bf16 v[212:215], a[100:103], a[88:91], v[212:215]
v_mfma_f32_16x16x32_bf16 v[216:219], a[104:107], a[88:91], v[216:219]
v_mfma_f32_16x16x32_bf16 v[220:223], a[108:111], a[88:91], v[220:223]
v_mfma_f32_16x16x32_bf16 v[224:227], a[88:91], a[112:115], v[224:227]
v_mfma_f32_16x16x32_bf16 v[228:231], a[88:91], a[116:119], v[228:231]
v_mfma_f32_16x16x32_bf16 v[184:187], a[96:99], a[84:87], v[184:187]
v_cvt_pk_bf16_f32 v240, v240, v241
v_cvt_pk_bf16_f32 v241, v242, v243
v_mfma_f32_16x16x32_bf16 v[188:191], a[100:103], a[84:87], v[188:191]
v_cvt_pk_bf16_f32 v242, v244, v245
v_cvt_pk_bf16_f32 v243, v246, v247
v_mfma_f32_16x16x32_bf16 v[192:195], a[104:107], a[84:87], v[192:195]
v_cvt_pk_bf16_f32 v248, v248, v249
v_cvt_pk_bf16_f32 v249, v250, v251
v_mfma_f32_16x16x32_bf16 v[196:199], a[108:111], a[84:87], v[196:199]
v_cvt_pk_bf16_f32 v250, v252, v253
v_cvt_pk_bf16_f32 v251, v254, v255
v_mfma_f32_16x16x32_bf16 v[200:203], a[84:87], a[112:115], v[200:203]
v_permlane16_swap_b32 v240, v242
v_permlane16_swap_b32 v241, v243
v_mfma_f32_16x16x32_bf16 v[204:207], a[84:87], a[116:119], v[204:207]
buffer_store_dwordx4 v[240:243], v2, s[24:27], s7 offen offset:256 sc1
ds_write_b128 v24, v[240:243] offset:6400
v_mfma_f32_16x16x32_bf16 v[160:163], a[96:99], a[80:83], v[160:163]
v_cvt_pk_bf16_f32 v216, v216, v217
v_cvt_pk_bf16_f32 v217, v218, v219
v_mfma_f32_16x16x32_bf16 v[164:167], a[100:103], a[80:83], v[164:167]
v_cvt_pk_bf16_f32 v218, v220, v221
v_cvt_pk_bf16_f32 v219, v222, v223
v_mfma_f32_16x16x32_bf16 v[168:171], a[104:107], a[80:83], v[168:171]
v_permlane32_swap_b32 v248, v250
v_permlane32_swap_b32 v249, v251
v_mfma_f32_16x16x32_bf16 v[172:175], a[108:111], a[80:83], v[172:175]
buffer_store_dwordx4 v[248:251], v3, s[24:27], s7 offen offset:1024 sc1
ds_write_b128 v25, v[248:251] offset:7168
v_mfma_f32_16x16x32_bf16 v[176:179], a[80:83], a[112:115], v[176:179]
v_cvt_pk_bf16_f32 v224, v224, v225
v_cvt_pk_bf16_f32 v225, v226, v227
v_mfma_f32_16x16x32_bf16 v[180:183], a[80:83], a[116:119], v[180:183]
v_cvt_pk_bf16_f32 v226, v228, v229
v_cvt_pk_bf16_f32 v227, v230, v231
v_mfma_f32_16x16x32_bf16 v[136:139], a[96:99], a[76:79], v[136:139]
v_permlane16_swap_b32 v216, v218
v_permlane16_swap_b32 v217, v219
v_mfma_f32_16x16x32_bf16 v[140:143], a[100:103], a[76:79], v[140:143]
buffer_store_dwordx4 v[216:219], v2, s[24:27], s7 offen offset:0 sc1
ds_write_b128 v24, v[216:219] offset:6144
v_mfma_f32_16x16x32_bf16 v[144:147], a[104:107], a[76:79], v[144:147]
v_cvt_pk_bf16_f32 v192, v192, v193
v_cvt_pk_bf16_f32 v193, v194, v195
v_mfma_f32_16x16x32_bf16 v[148:151], a[108:111], a[76:79], v[148:151]
v_cvt_pk_bf16_f32 v194, v196, v197
v_cvt_pk_bf16_f32 v195, v198, v199
v_mfma_f32_16x16x32_bf16 v[152:155], a[76:79], a[112:115], v[152:155]
v_permlane32_swap_b32 v224, v226
v_permlane32_swap_b32 v225, v227
v_mfma_f32_16x16x32_bf16 v[156:159], a[76:79], a[116:119], v[156:159]
buffer_store_dwordx4 v[224:227], v3, s[24:27], s7 offen offset:0 sc1
ds_write_b128 v25, v[224:227] offset:6144
v_mfma_f32_16x16x32_bf16 v[112:115], a[96:99], a[72:75], v[112:115]
v_cvt_pk_bf16_f32 v200, v200, v201
v_cvt_pk_bf16_f32 v201, v202, v203
v_mfma_f32_16x16x32_bf16 v[116:119], a[100:103], a[72:75], v[116:119]
v_cvt_pk_bf16_f32 v202, v204, v205
v_cvt_pk_bf16_f32 v203, v206, v207
v_mfma_f32_16x16x32_bf16 v[120:123], a[104:107], a[72:75], v[120:123]
v_permlane16_swap_b32 v192, v194
v_permlane16_swap_b32 v193, v195
v_mfma_f32_16x16x32_bf16 v[124:127], a[108:111], a[72:75], v[124:127]
buffer_store_dwordx4 v[192:195], v2, s[24:27], s6 offen offset:256 sc1
ds_write_b128 v24, v[192:195] offset:4352
v_mfma_f32_16x16x32_bf16 v[128:131], a[72:75], a[112:115], v[128:131]
v_cvt_pk_bf16_f32 v244, v168, v169
v_cvt_pk_bf16_f32 v245, v170, v171
v_mfma_f32_16x16x32_bf16 v[132:135], a[72:75], a[116:119], v[132:135]
v_cvt_pk_bf16_f32 v246, v172, v173
v_cvt_pk_bf16_f32 v247, v174, v175
v_mfma_f32_16x16x32_bf16 v[88:91], a[96:99], a[68:71], v[88:91]
v_permlane32_swap_b32 v200, v202
v_permlane32_swap_b32 v201, v203
v_mfma_f32_16x16x32_bf16 v[92:95], a[100:103], a[68:71], v[92:95]
buffer_store_dwordx4 v[200:203], v3, s[24:27], s6 offen offset:1024 sc1
ds_write_b128 v25, v[200:203] offset:5120
v_mfma_f32_16x16x32_bf16 v[96:99], a[104:107], a[68:71], v[96:99]
v_cvt_pk_bf16_f32 v252, v176, v177
v_cvt_pk_bf16_f32 v253, v178, v179
v_mfma_f32_16x16x32_bf16 v[100:103], a[108:111], a[68:71], v[100:103]
v_cvt_pk_bf16_f32 v254, v180, v181
v_cvt_pk_bf16_f32 v255, v182, v183
v_mfma_f32_16x16x32_bf16 v[104:107], a[68:71], a[112:115], v[104:107]
v_permlane16_swap_b32 v244, v246
v_permlane16_swap_b32 v245, v247
v_mfma_f32_16x16x32_bf16 v[108:111], a[68:71], a[116:119], v[108:111]
buffer_store_dwordx4 v[244:247], v2, s[24:27], s6 offen offset:0 sc1
ds_write_b128 v24, v[244:247] offset:4096
v_mfma_f32_16x16x32_bf16 v[64:67], a[96:99], a[64:67], v[64:67]
v_cvt_pk_bf16_f32 v220, v144, v145
v_cvt_pk_bf16_f32 v221, v146, v147
v_mfma_f32_16x16x32_bf16 v[68:71], a[100:103], a[64:67], v[68:71]
v_cvt_pk_bf16_f32 v222, v148, v149
v_cvt_pk_bf16_f32 v223, v150, v151
v_mfma_f32_16x16x32_bf16 v[72:75], a[104:107], a[64:67], v[72:75]
v_permlane32_swap_b32 v252, v254
v_permlane32_swap_b32 v253, v255
v_mfma_f32_16x16x32_bf16 v[76:79], a[108:111], a[64:67], v[76:79]
buffer_store_dwordx4 v[252:255], v3, s[24:27], s6 offen offset:0 sc1
ds_write_b128 v25, v[252:255] offset:4096
v_mfma_f32_16x16x32_bf16 v[80:83], a[64:67], a[112:115], v[80:83]
v_cvt_pk_bf16_f32 v228, v152, v153
v_cvt_pk_bf16_f32 v229, v154, v155
v_mfma_f32_16x16x32_bf16 v[84:87], a[64:67], a[116:119], v[84:87]
v_cvt_pk_bf16_f32 v230, v156, v157
v_cvt_pk_bf16_f32 v231, v158, v159
s_branch .Lph2_B
.Lmain_A3:
.Lv_A3:
ds_read_b128 a[0:3], v6 offset:0
ds_read_b64_tr_b16 a[32:33], v8 offset:0
ds_read_b64_tr_b16 a[34:35], v8 offset:512
ds_read_b64_tr_b16 a[36:37], v9 offset:0
ds_read_b64_tr_b16 a[38:39], v9 offset:512
ds_read_b64_tr_b16 a[40:41], v8 offset:8192
ds_read_b64_tr_b16 a[42:43], v8 offset:8704
ds_read_b64_tr_b16 a[44:45], v9 offset:8192
ds_read_b64_tr_b16 a[46:47], v9 offset:8704
ds_read_b64_tr_b16 a[48:49], v8 offset:16384
ds_read_b64_tr_b16 a[50:51], v8 offset:16896
ds_read_b64_tr_b16 a[52:53], v9 offset:16384
ds_read_b64_tr_b16 a[54:55], v9 offset:16896
ds_read_b128 a[4:7], v6 offset:2048
ds_read_b128 a[8:11], v6 offset:4096
ds_read_b128 a[12:15], v6 offset:6144
ds_read_b128 a[16:19], v6 offset:8192
ds_read_b128 a[20:23], v6 offset:10240
ds_read_b128 a[24:27], v6 offset:12288
ds_read_b128 a[28:31], v6 offset:14336
s_mov_b32 s42, 0
s_waitcnt lgkmcnt(15)
v_mfma_f32_16x16x32_bf16 v[64:67], a[32:35], a[0:3], 0
ds_read_b128 a[64:67], v7 offset:0
v_mfma_f32_16x16x32_bf16 v[68:71], a[36:39], a[0:3], 0
s_add_u32 m0, s40, 0
s_nop 0
buffer_load_dwordx4 v2, s[4:7], 0 offen lds
s_waitcnt lgkmcnt(14)
v_mfma_f32_16x16x32_bf16 v[72:75], a[0:3], a[40:43], 0
ds_read_b64_tr_b16 a[96:97], v8 offset:4096
s_waitcnt lgkmcnt(13)
v_mfma_f32_16x16x32_bf16 v[76:79], a[0:3], a[44:47], 0
buffer_load_dwordx4 v3, s[4:7], s64 offen offset:1024 lds
s_waitcnt lgkmcnt(11)
v_mfma_f32_16x16x32_bf16 v[80:83], a[0:3], a[48:51], 0
ds_read_b64_tr_b16 a[98:99], v8 offset:4608
s_waitcnt lgkmcnt(10)
v_mfma_f32_16x16x32_bf16 v[84:87], a[0:3], a[52:55], 0
buffer_load_dwordx4 v2, s[4:7], s65 offen offset:2048 lds
s_waitcnt lgkmcnt(9)
v_mfma_f32_16x16x32_bf16 v[88:91], a[32:35], a[4:7], 0
ds_read_b64_tr_b16 a[100:101], v9 offset:4096
v_mfma_f32_16x16x32_bf16 v[92:95], a[36:39], a[4:7], 0
buffer_load_dwordx4 v3, s[4:7], s66 offen offset:3072 lds
v_mfma_f32_16x16x32_bf16 v[96:99], a[4:7], a[40:43], 0
ds_read_b64_tr_b16 a[102:103], v9 offset:4608
v_mfma_f32_16x16x32_bf16 v[100:103], a[4:7], a[44:47], 0
s_add_u32 m0, s40, 4096
s_nop 0
buffer_load_dwordx4 v2, s[4:7], s67 offen lds
v_mfma_f32_16x16x32_bf16 v[104:107], a[4:7], a[48:51], 0
ds_read_b64_tr_b16 a[104:105], v8 offset:12288
v_mfma_f32_16x16x32_bf16 v[108:111], a[4:7], a[52:55], 0
buffer_load_dwordx4 v3, s[4:7], s68 offen offset:1024 lds
s_waitcnt lgkmcnt(3)
v_mfma_f32_16x16x32_bf16 v[112:115], a[32:35], a[8:11], 0
ds_read_b64_tr_b16 a[106:107], v8 offset:12800
v_mfma_f32_16x16x32_bf16 v[116:119], a[36:39], a[8:11], 0
buffer_load_dwordx4 v2, s[4:7], s69 offen offset:2048 lds
v_mfma_f32_16x16x32_bf16 v[120:123], a[8:11], a[40:43], 0
ds_read_b64_tr_b16 a[108:109], v9 offset:12288
v_mfma_f32_16x16x32_bf16 v[124:127], a[8:11], a[44:47], 0
buffer_load_dwordx4 v3, s[4:7], s70 offen offset:3072 lds
v_mfma_f32_16x16x32_bf16 v[128:131], a[8:11], a[48:51], 0
ds_read_b64_tr_b16 a[110:111], v9 offset:12800
v_mfma_f32_16x16x32_bf16 v[132:135], a[8:11], a[52:55], 0
s_add_u32 m0, s40, 8192
s_nop 0
buffer_load_dwordx4 v2, s[4:7], s71 offen lds
v_mfma_f32_16x16x32_bf16 v[136:139], a[32:35], a[12:15], 0
ds_read_b64_tr_b16 a[112:113], v8 offset:20480
v_mfma_f32_16x16x32_bf16 v[140:143], a[36:39], a[12:15], 0
buffer_load_dwordx4 v3, s[4:7], s72 offen offset:1024 lds
v_mfma_f32_16x16x32_bf16 v[144:147], a[12:15], a[40:43], 0
ds_read_b64_tr_b16 a[114:115], v8 offset:20992
v_mfma_f32_16x16x32_bf16 v[148:151], a[12:15], a[44:47], 0
buffer_load_dwordx4 v2, s[4:7], s73 offen offset:2048 lds
v_mfma_f32_16x16x32_bf16 v[152:155], a[12:15], a[48:51], 0
ds_read_b64_tr_b16 a[116:117], v9 offset:20480
v_mfma_f32_16x16x32_bf16 v[156:159], a[12:15], a[52:55], 0
buffer_load_dwordx4 v3, s[4:7], s74 offen offset:3072 lds
v_mfma_f32_16x16x32_bf16 v[160:163], a[32:35], a[16:19], 0
ds_read_b64_tr_b16 a[118:119], v9 offset:20992
v_mfma_f32_16x16x32_bf16 v[164:167], a[36:39], a[16:19], 0
s_add_u32 m0, s40, 12288
s_nop 0
buffer_load_dwordx4 v2, s[4:7], s75 offen lds
v_mfma_f32_16x16x32_bf16 v[168:171], a[16:19], a[40:43], 0
ds_read_b128 a[68:71], v7 offset:2048
v_mfma_f32_16x16x32_bf16 v[172:175], a[16:19], a[44:47], 0
buffer_load_dwordx4 v3, s[4:7], s76 offen offset:1024 lds
v_mfma_f32_16x16x32_bf16 v[176:179], a[16:19], a[48:51], 0
ds_read_b128 a[72:75], v7 offset:4096
v_add_u32 v2, 0x80, v2
v_mfma_f32_16x16x32_bf16 v[180:183], a[16:19], a[52:55], 0
buffer_load_dword v12, v11, s[8:11], 0 offen
v_mfma_f32_16x16x32_bf16 v[184:187], a[32:35], a[20:23], 0
ds_read_b128 a[76:79], v7 offset:6144
v_add_u32 v3, 0x80, v3
v_mfma_f32_16x16x32_bf16 v[188:191], a[36:39], a[20:23], 0
s_mov_b32 s16, s87
v_mfma_f32_16x16x32_bf16 v[192:195], a[20:23], a[40:43], 0
ds_read_b128 a[80:83], v7 offset:8192
s_mov_b32 s87, s88
v_mfma_f32_16x16x32_bf16 v[196:199], a[20:23], a[44:47], 0
s_mov_b32 s88, s89
v_mfma_f32_16x16x32_bf16 v[200:203], a[20:23], a[48:51], 0
ds_read_b128 a[84:87], v7 offset:10240
s_mov_b32 s89, s16
v_mfma_f32_16x16x32_bf16 v[204:207], a[20:23], a[52:55], 0
s_mov_b32 s40, s87
v_mfma_f32_16x16x32_bf16 v[208:211], a[32:35], a[24:27], 0
ds_read_b128 a[88:91], v7 offset:12288
v_add_u32 v10, 0x80, v10
v_mfma_f32_16x16x32_bf16 v[212:215], a[36:39], a[24:27], 0
v_add_u32 v11, s99, v11
v_mfma_f32_16x16x32_bf16 v[216:219], a[24:27], a[40:43], 0
ds_read_b128 a[92:95], v7 offset:14336
v_mfma_f32_16x16x32_bf16 v[220:223], a[24:27], a[44:47], 0
v_mfma_f32_16x16x32_bf16 v[224:227], a[24:27], a[48:51], 0
v_add_u32 v7, s92, v7
v_mfma_f32_16x16x32_bf16 v[228:231], a[24:27], a[52:55], 0
v_add_u32 v6, s92, v6
v_mfma_f32_16x16x32_bf16 v[232:235], a[32:35], a[28:31], 0
s_mov_b32 s17, s92
v_mfma_f32_16x16x32_bf16 v[236:239], a[36:39], a[28:31], 0
s_mov_b32 s92, s93
v_mfma_f32_16x16x32_bf16 v[240:243], a[28:31], a[40:43], 0
s_mov_b32 s93, s94
v_mfma_f32_16x16x32_bf16 v[244:247], a[28:31], a[44:47], 0
s_mov_b32 s94, s17
v_mfma_f32_16x16x32_bf16 v[248:251], a[28:31], a[48:51], 0
v_mfma_f32_16x16x32_bf16 v[252:255], a[28:31], a[52:55], 0
s_waitcnt lgkmcnt(0)
v_mfma_f32_16x16x32_bf16 v[64:67], a[96:99], a[64:67], v[64:67]
s_waitcnt vmcnt(15)
s_barrier
v_mfma_f32_16x16x32_bf16 v[68:71], a[100:103], a[64:67], v[68:71]
s_add_u32 m0, s40, 0
s_nop 0
buffer_load_dwordx4 v2, s[4:7], 0 offen lds
v_mfma_f32_16x16x32_bf16 v[72:75], a[64:67], a[104:107], v[72:75]
ds_read_b128 a[0:3], v6 offset:0
v_mfma_f32_16x16x32_bf16 v[76:79], a[64:67], a[108:111], v[76:79]
s_cmp_eq_u32 s43, 0
s_cselect_b32 s24, s44, 0
s_cselect_b32 s25, 0x4000, 0
v_readlane_b32 s30, v62, s24
v_readlane_b32 s31, v62, 1
v_readlane_b32 s33, v63, 1
v_readlane_b32 s3, v62, 2
v_readlane_b32 s34, v62, 3
s_lshl_b32 s24, s44, 4
s_add_u32 s24, s24, s45
s_lshl_b32 s24, s24, 7
s_add_u32 s32, s24, s25
s_add_u32 s32, s32, 29360128

v_accvgpr_write_b32 a252, v60
v_accvgpr_write_b32 a253, v61
v_mfma_f32_16x16x32_bf16 v[80:83], a[64:67], a[112:115], v[80:83]
ds_read_b64_tr_b16 a[32:33], v8 offset:24576
v_mfma_f32_16x16x32_bf16 v[84:87], a[64:67], a[116:119], v[84:87]
buffer_load_dwordx4 v3, s[4:7], s64 offen offset:1024 lds
v_mfma_f32_16x16x32_bf16 v[88:91], a[96:99], a[68:71], v[88:91]
ds_read_b64_tr_b16 a[34:35], v8 offset:25088
v_mfma_f32_16x16x32_bf16 v[92:95], a[100:103], a[68:71], v[92:95]
v_mfma_f32_16x16x32_bf16 v[96:99], a[68:71], a[104:107], v[96:99]
ds_read_b64_tr_b16 a[36:37], v9 offset:24576
v_mfma_f32_16x16x32_bf16 v[100:103], a[68:71], a[108:111], v[100:103]
buffer_load_dwordx4 v2, s[4:7], s65 offen offset:2048 lds
v_mfma_f32_16x16x32_bf16 v[104:107], a[68:71], a[112:115], v[104:107]
ds_read_b64_tr_b16 a[38:39], v9 offset:25088
v_mfma_f32_16x16x32_bf16 v[108:111], a[68:71], a[116:119], v[108:111]
v_mfma_f32_16x16x32_bf16 v[112:115], a[96:99], a[72:75], v[112:115]
ds_read_b64_tr_b16 a[40:41], v8 offset:32768
v_mfma_f32_16x16x32_bf16 v[116:119], a[100:103], a[72:75], v[116:119]
buffer_load_dwordx4 v3, s[4:7], s66 offen offset:3072 lds
v_mfma_f32_16x16x32_bf16 v[120:123], a[72:75], a[104:107], v[120:123]
ds_read_b64_tr_b16 a[42:43], v8 offset:33280
v_mfma_f32_16x16x32_bf16 v[124:127], a[72:75], a[108:111], v[124:127]
v_mfma_f32_16x16x32_bf16 v[128:131], a[72:75], a[112:115], v[128:131]
ds_read_b64_tr_b16 a[44:45], v9 offset:32768
v_mfma_f32_16x16x32_bf16 v[132:135], a[72:75], a[116:119], v[132:135]
s_add_u32 m0, s40, 4096
s_nop 0
buffer_load_dwordx4 v2, s[4:7], s67 offen lds
v_mfma_f32_16x16x32_bf16 v[136:139], a[96:99], a[76:79], v[136:139]
ds_read_b64_tr_b16 a[46:47], v9 offset:33280
v_mfma_f32_16x16x32_bf16 v[140:143], a[100:103], a[76:79], v[140:143]
v_mfma_f32_16x16x32_bf16 v[144:147], a[76:79], a[104:107], v[144:147]
ds_read_b64_tr_b16 a[48:49], v8 offset:40960
v_mfma_f32_16x16x32_bf16 v[148:151], a[76:79], a[108:111], v[148:151]
buffer_load_dwordx4 v3, s[4:7], s68 offen offset:1024 lds
v_mfma_f32_16x16x32_bf16 v[152:155], a[76:79], a[112:115], v[152:155]
ds_read_b64_tr_b16 a[50:51], v8 offset:41472
v_mfma_f32_16x16x32_bf16 v[156:159], a[76:79], a[116:119], v[156:159]
v_mfma_f32_16x16x32_bf16 v[160:163], a[96:99], a[80:83], v[160:163]
ds_read_b64_tr_b16 a[52:53], v9 offset:40960
v_mfma_f32_16x16x32_bf16 v[164:167], a[100:103], a[80:83], v[164:167]
buffer_load_dwordx4 v2, s[4:7], s69 offen offset:2048 lds
v_mfma_f32_16x16x32_bf16 v[168:171], a[80:83], a[104:107], v[168:171]
ds_read_b64_tr_b16 a[54:55], v9 offset:41472
v_mfma_f32_16x16x32_bf16 v[172:175], a[80:83], a[108:111], v[172:175]
v_mfma_f32_16x16x32_bf16 v[176:179], a[80:83], a[112:115], v[176:179]
ds_read_b128 a[4:7], v6 offset:2048
v_mfma_f32_16x16x32_bf16 v[180:183], a[80:83], a[116:119], v[180:183]
buffer_load_dwordx4 v3, s[4:7], s70 offen offset:3072 lds
v_mfma_f32_16x16x32_bf16 v[184:187], a[96:99], a[84:87], v[184:187]
ds_read_b128 a[8:11], v6 offset:4096
v_mfma_f32_16x16x32_bf16 v[188:191], a[100:103], a[84:87], v[188:191]
v_mfma_f32_16x16x32_bf16 v[192:195], a[84:87], a[104:107], v[192:195]
ds_read_b128 a[12:15], v6 offset:6144
v_mfma_f32_16x16x32_bf16 v[196:199], a[84:87], a[108:111], v[196:199]
s_add_u32 m0, s40, 8192
s_nop 0
buffer_load_dwordx4 v2, s[4:7], s71 offen lds
v_mfma_f32_16x16x32_bf16 v[200:203], a[84:87], a[112:115], v[200:203]
ds_read_b128 a[16:19], v6 offset:8192
v_mfma_f32_16x16x32_bf16 v[204:207], a[84:87], a[116:119], v[204:207]
v_mfma_f32_16x16x32_bf16 v[208:211], a[96:99], a[88:91], v[208:211]
ds_read_b128 a[20:23], v6 offset:10240
v_mfma_f32_16x16x32_bf16 v[212:215], a[100:103], a[88:91], v[212:215]
buffer_load_dwordx4 v3, s[4:7], s72 offen offset:1024 lds
v_mfma_f32_16x16x32_bf16 v[216:219], a[88:91], a[104:107], v[216:219]
ds_read_b128 a[24:27], v6 offset:12288
v_mfma_f32_16x16x32_bf16 v[220:223], a[88:91], a[108:111], v[220:223]
v_mfma_f32_16x16x32_bf16 v[224:227], a[88:91], a[112:115], v[224:227]
ds_read_b128 a[28:31], v6 offset:14336
v_mfma_f32_16x16x32_bf16 v[228:231], a[88:91], a[116:119], v[228:231]
buffer_load_dwordx4 v2, s[4:7], s73 offen offset:2048 lds
v_mfma_f32_16x16x32_bf16 v[232:235], a[96:99], a[92:95], v[232:235]
v_mfma_f32_16x16x32_bf16 v[236:239], a[100:103], a[92:95], v[236:239]
v_mfma_f32_16x16x32_bf16 v[240:243], a[92:95], a[104:107], v[240:243]
v_mfma_f32_16x16x32_bf16 v[244:247], a[92:95], a[108:111], v[244:247]
buffer_load_dwordx4 v3, s[4:7], s74 offen offset:3072 lds
v_mfma_f32_16x16x32_bf16 v[248:251], a[92:95], a[112:115], v[248:251]
v_mfma_f32_16x16x32_bf16 v[252:255], a[92:95], a[116:119], v[252:255]
.p2align 6
.LA3_loop:
s_waitcnt lgkmcnt(0)
v_mfma_f32_16x16x32_bf16 v[64:67], a[32:35], a[0:3], v[64:67]
ds_read_b128 a[64:67], v7 offset:0
v_mfma_f32_16x16x32_bf16 v[68:71], a[36:39], a[0:3], v[68:71]
s_add_u32 m0, s40, 12288
s_nop 0
buffer_load_dwordx4 v2, s[4:7], s75 offen lds
v_mfma_f32_16x16x32_bf16 v[72:75], a[0:3], a[40:43], v[72:75]
ds_read_b64_tr_b16 a[96:97], v8 offset:28672
v_mfma_f32_16x16x32_bf16 v[76:79], a[0:3], a[44:47], v[76:79]
v_mfma_f32_16x16x32_bf16 v[80:83], a[0:3], a[48:51], v[80:83]
ds_read_b64_tr_b16 a[98:99], v8 offset:29184
v_mfma_f32_16x16x32_bf16 v[84:87], a[0:3], a[52:55], v[84:87]
buffer_load_dwordx4 v3, s[4:7], s76 offen offset:1024 lds
v_mfma_f32_16x16x32_bf16 v[88:91], a[32:35], a[4:7], v[88:91]
ds_read_b64_tr_b16 a[100:101], v9 offset:28672
v_mfma_f32_16x16x32_bf16 v[92:95], a[36:39], a[4:7], v[92:95]
v_add_u32 v2, 0x80, v2
v_mfma_f32_16x16x32_bf16 v[96:99], a[4:7], a[40:43], v[96:99]
ds_read_b64_tr_b16 a[102:103], v9 offset:29184
v_mfma_f32_16x16x32_bf16 v[100:103], a[4:7], a[44:47], v[100:103]
buffer_load_dword v12, v11, s[8:11], 0 offen
v_mfma_f32_16x16x32_bf16 v[104:107], a[4:7], a[48:51], v[104:107]
ds_read_b64_tr_b16 a[104:105], v8 offset:36864
v_mfma_f32_16x16x32_bf16 v[108:111], a[4:7], a[52:55], v[108:111]
v_add_u32 v3, 0x80, v3
v_add_u32 v10, 0x80, v10
v_mfma_f32_16x16x32_bf16 v[112:115], a[32:35], a[8:11], v[112:115]
ds_read_b64_tr_b16 a[106:107], v8 offset:37376
v_mfma_f32_16x16x32_bf16 v[116:119], a[36:39], a[8:11], v[116:119]
v_mfma_f32_16x16x32_bf16 v[120:123], a[8:11], a[40:43], v[120:123]
ds_read_b64_tr_b16 a[108:109], v9 offset:36864
v_mfma_f32_16x16x32_bf16 v[124:127], a[8:11], a[44:47], v[124:127]
s_mov_b32 s16, s87
v_add_u32 v11, s99, v11
v_mfma_f32_16x16x32_bf16 v[128:131], a[8:11], a[48:51], v[128:131]
ds_read_b64_tr_b16 a[110:111], v9 offset:37376
v_mfma_f32_16x16x32_bf16 v[132:135], a[8:11], a[52:55], v[132:135]
v_mfma_f32_16x16x32_bf16 v[136:139], a[32:35], a[12:15], v[136:139]
ds_read_b64_tr_b16 a[112:113], v8 offset:45056
v_mfma_f32_16x16x32_bf16 v[140:143], a[36:39], a[12:15], v[140:143]
s_mov_b32 s87, s88
v_mfma_f32_16x16x32_bf16 v[144:147], a[12:15], a[40:43], v[144:147]
ds_read_b64_tr_b16 a[114:115], v8 offset:45568
v_mfma_f32_16x16x32_bf16 v[148:151], a[12:15], a[44:47], v[148:151]
v_mfma_f32_16x16x32_bf16 v[152:155], a[12:15], a[48:51], v[152:155]
ds_read_b64_tr_b16 a[116:117], v9 offset:45056
v_mfma_f32_16x16x32_bf16 v[156:159], a[12:15], a[52:55], v[156:159]
s_mov_b32 s88, s89
v_mfma_f32_16x16x32_bf16 v[160:163], a[32:35], a[16:19], v[160:163]
ds_read_b64_tr_b16 a[118:119], v9 offset:45568
v_mfma_f32_16x16x32_bf16 v[164:167], a[36:39], a[16:19], v[164:167]
v_mfma_f32_16x16x32_bf16 v[168:171], a[16:19], a[40:43], v[168:171]
ds_read_b128 a[68:71], v7 offset:2048
v_mfma_f32_16x16x32_bf16 v[172:175], a[16:19], a[44:47], v[172:175]
s_mov_b32 s89, s16
v_mfma_f32_16x16x32_bf16 v[176:179], a[16:19], a[48:51], v[176:179]
ds_read_b128 a[72:75], v7 offset:4096
v_mfma_f32_16x16x32_bf16 v[180:183], a[16:19], a[52:55], v[180:183]
v_mfma_f32_16x16x32_bf16 v[184:187], a[32:35], a[20:23], v[184:187]
ds_read_b128 a[76:79], v7 offset:6144
v_mfma_f32_16x16x32_bf16 v[188:191], a[36:39], a[20:23], v[188:191]
s_mov_b32 s40, s87
v_mfma_f32_16x16x32_bf16 v[192:195], a[20:23], a[40:43], v[192:195]
ds_read_b128 a[80:83], v7 offset:8192
v_mfma_f32_16x16x32_bf16 v[196:199], a[20:23], a[44:47], v[196:199]
v_mfma_f32_16x16x32_bf16 v[200:203], a[20:23], a[48:51], v[200:203]
ds_read_b128 a[84:87], v7 offset:10240
v_mfma_f32_16x16x32_bf16 v[204:207], a[20:23], a[52:55], v[204:207]
v_mfma_f32_16x16x32_bf16 v[208:211], a[32:35], a[24:27], v[208:211]
ds_read_b128 a[88:91], v7 offset:12288
v_mfma_f32_16x16x32_bf16 v[212:215], a[36:39], a[24:27], v[212:215]
v_mfma_f32_16x16x32_bf16 v[216:219], a[24:27], a[40:43], v[216:219]
ds_read_b128 a[92:95], v7 offset:14336
v_mfma_f32_16x16x32_bf16 v[220:223], a[24:27], a[44:47], v[220:223]
v_mfma_f32_16x16x32_bf16 v[224:227], a[24:27], a[48:51], v[224:227]
v_add_u32 v7, s92, v7
v_mfma_f32_16x16x32_bf16 v[228:231], a[24:27], a[52:55], v[228:231]
v_add_u32 v6, s92, v6
v_mfma_f32_16x16x32_bf16 v[232:235], a[32:35], a[28:31], v[232:235]
s_mov_b32 s17, s92
v_mfma_f32_16x16x32_bf16 v[236:239], a[36:39], a[28:31], v[236:239]
s_mov_b32 s92, s93
v_mfma_f32_16x16x32_bf16 v[240:243], a[28:31], a[40:43], v[240:243]
s_mov_b32 s93, s94
v_mfma_f32_16x16x32_bf16 v[244:247], a[28:31], a[44:47], v[244:247]
s_mov_b32 s94, s17
v_mfma_f32_16x16x32_bf16 v[248:251], a[28:31], a[48:51], v[248:251]
v_mfma_f32_16x16x32_bf16 v[252:255], a[28:31], a[52:55], v[252:255]
s_waitcnt lgkmcnt(0)
v_mfma_f32_16x16x32_bf16 v[64:67], a[96:99], a[64:67], v[64:67]
s_waitcnt vmcnt(16)
s_barrier
v_mfma_f32_16x16x32_bf16 v[68:71], a[100:103], a[64:67], v[68:71]
s_add_u32 m0, s40, 0
s_nop 0
buffer_load_dwordx4 v2, s[4:7], 0 offen lds
v_mfma_f32_16x16x32_bf16 v[72:75], a[64:67], a[104:107], v[72:75]
ds_read_b128 a[0:3], v6 offset:0
v_mfma_f32_16x16x32_bf16 v[76:79], a[64:67], a[108:111], v[76:79]
v_mfma_f32_16x16x32_bf16 v[80:83], a[64:67], a[112:115], v[80:83]
ds_read_b64_tr_b16 a[32:33], v8 offset:0
v_mfma_f32_16x16x32_bf16 v[84:87], a[64:67], a[116:119], v[84:87]
buffer_load_dwordx4 v3, s[4:7], s64 offen offset:1024 lds
v_mfma_f32_16x16x32_bf16 v[88:91], a[96:99], a[68:71], v[88:91]
ds_read_b64_tr_b16 a[34:35], v8 offset:512
v_mfma_f32_16x16x32_bf16 v[92:95], a[100:103], a[68:71], v[92:95]
v_mfma_f32_16x16x32_bf16 v[96:99], a[68:71], a[104:107], v[96:99]
ds_read_b64_tr_b16 a[36:37], v9 offset:0
v_mfma_f32_16x16x32_bf16 v[100:103], a[68:71], a[108:111], v[100:103]
buffer_load_dwordx4 v2, s[4:7], s65 offen offset:2048 lds
v_mfma_f32_16x16x32_bf16 v[104:107], a[68:71], a[112:115], v[104:107]
ds_read_b64_tr_b16 a[38:39], v9 offset:512
v_mfma_f32_16x16x32_bf16 v[108:111], a[68:71], a[116:119], v[108:111]
v_mfma_f32_16x16x32_bf16 v[112:115], a[96:99], a[72:75], v[112:115]
ds_read_b64_tr_b16 a[40:41], v8 offset:8192
v_mfma_f32_16x16x32_bf16 v[116:119], a[100:103], a[72:75], v[116:119]
buffer_load_dwordx4 v3, s[4:7], s66 offen offset:3072 lds
v_mfma_f32_16x16x32_bf16 v[120:123], a[72:75], a[104:107], v[120:123]
ds_read_b64_tr_b16 a[42:43], v8 offset:8704
v_mfma_f32_16x16x32_bf16 v[124:127], a[72:75], a[108:111], v[124:127]
v_mfma_f32_16x16x32_bf16 v[128:131], a[72:75], a[112:115], v[128:131]
ds_read_b64_tr_b16 a[44:45], v9 offset:8192
v_mfma_f32_16x16x32_bf16 v[132:135], a[72:75], a[116:119], v[132:135]
s_add_u32 m0, s40, 4096
s_nop 0
buffer_load_dwordx4 v2, s[4:7], s67 offen lds
v_mfma_f32_16x16x32_bf16 v[136:139], a[96:99], a[76:79], v[136:139]
ds_read_b64_tr_b16 a[46:47], v9 offset:8704
v_mfma_f32_16x16x32_bf16 v[140:143], a[100:103], a[76:79], v[140:143]
v_mfma_f32_16x16x32_bf16 v[144:147], a[76:79], a[104:107], v[144:147]
ds_read_b64_tr_b16 a[48:49], v8 offset:16384
v_mfma_f32_16x16x32_bf16 v[148:151], a[76:79], a[108:111], v[148:151]
buffer_load_dwordx4 v3, s[4:7], s68 offen offset:1024 lds
v_mfma_f32_16x16x32_bf16 v[152:155], a[76:79], a[112:115], v[152:155]
ds_read_b64_tr_b16 a[50:51], v8 offset:16896
v_mfma_f32_16x16x32_bf16 v[156:159], a[76:79], a[116:119], v[156:159]
v_mfma_f32_16x16x32_bf16 v[160:163], a[96:99], a[80:83], v[160:163]
ds_read_b64_tr_b16 a[52:53], v9 offset:16384
v_mfma_f32_16x16x32_bf16 v[164:167], a[100:103], a[80:83], v[164:167]
buffer_load_dwordx4 v2, s[4:7], s69 offen offset:2048 lds
v_mfma_f32_16x16x32_bf16 v[168:171], a[80:83], a[104:107], v[168:171]
ds_read_b64_tr_b16 a[54:55], v9 offset:16896
v_mfma_f32_16x16x32_bf16 v[172:175], a[80:83], a[108:111], v[172:175]
v_mfma_f32_16x16x32_bf16 v[176:179], a[80:83], a[112:115], v[176:179]
ds_read_b128 a[4:7], v6 offset:2048
v_mfma_f32_16x16x32_bf16 v[180:183], a[80:83], a[116:119], v[180:183]
buffer_load_dwordx4 v3, s[4:7], s70 offen offset:3072 lds
v_mfma_f32_16x16x32_bf16 v[184:187], a[96:99], a[84:87], v[184:187]
ds_read_b128 a[8:11], v6 offset:4096
v_mfma_f32_16x16x32_bf16 v[188:191], a[100:103], a[84:87], v[188:191]
v_mfma_f32_16x16x32_bf16 v[192:195], a[84:87], a[104:107], v[192:195]
ds_read_b128 a[12:15], v6 offset:6144
v_mfma_f32_16x16x32_bf16 v[196:199], a[84:87], a[108:111], v[196:199]
s_add_u32 m0, s40, 8192
s_nop 0
buffer_load_dwordx4 v2, s[4:7], s71 offen lds
v_mfma_f32_16x16x32_bf16 v[200:203], a[84:87], a[112:115], v[200:203]
ds_read_b128 a[16:19], v6 offset:8192
v_mfma_f32_16x16x32_bf16 v[204:207], a[84:87], a[116:119], v[204:207]
v_mfma_f32_16x16x32_bf16 v[208:211], a[96:99], a[88:91], v[208:211]
ds_read_b128 a[20:23], v6 offset:10240
v_mfma_f32_16x16x32_bf16 v[212:215], a[100:103], a[88:91], v[212:215]
buffer_load_dwordx4 v3, s[4:7], s72 offen offset:1024 lds
v_mfma_f32_16x16x32_bf16 v[216:219], a[88:91], a[104:107], v[216:219]
ds_read_b128 a[24:27], v6 offset:12288
v_mfma_f32_16x16x32_bf16 v[220:223], a[88:91], a[108:111], v[220:223]
v_mfma_f32_16x16x32_bf16 v[224:227], a[88:91], a[112:115], v[224:227]
ds_read_b128 a[28:31], v6 offset:14336
v_mfma_f32_16x16x32_bf16 v[228:231], a[88:91], a[116:119], v[228:231]
buffer_load_dwordx4 v2, s[4:7], s73 offen offset:2048 lds
v_mfma_f32_16x16x32_bf16 v[232:235], a[96:99], a[92:95], v[232:235]
v_mfma_f32_16x16x32_bf16 v[236:239], a[100:103], a[92:95], v[236:239]
v_mfma_f32_16x16x32_bf16 v[240:243], a[92:95], a[104:107], v[240:243]
v_mfma_f32_16x16x32_bf16 v[244:247], a[92:95], a[108:111], v[244:247]
buffer_load_dwordx4 v3, s[4:7], s74 offen offset:3072 lds
v_mfma_f32_16x16x32_bf16 v[248:251], a[92:95], a[112:115], v[248:251]
v_mfma_f32_16x16x32_bf16 v[252:255], a[92:95], a[116:119], v[252:255]
s_waitcnt lgkmcnt(0)
v_mfma_f32_16x16x32_bf16 v[64:67], a[32:35], a[0:3], v[64:67]
ds_read_b128 a[64:67], v7 offset:0
v_mfma_f32_16x16x32_bf16 v[68:71], a[36:39], a[0:3], v[68:71]
s_add_u32 m0, s40, 12288
s_nop 0
buffer_load_dwordx4 v2, s[4:7], s75 offen lds
v_mfma_f32_16x16x32_bf16 v[72:75], a[0:3], a[40:43], v[72:75]
ds_read_b64_tr_b16 a[96:97], v8 offset:4096
v_mfma_f32_16x16x32_bf16 v[76:79], a[0:3], a[44:47], v[76:79]
v_mfma_f32_16x16x32_bf16 v[80:83], a[0:3], a[48:51], v[80:83]
ds_read_b64_tr_b16 a[98:99], v8 offset:4608
v_mfma_f32_16x16x32_bf16 v[84:87], a[0:3], a[52:55], v[84:87]
buffer_load_dwordx4 v3, s[4:7], s76 offen offset:1024 lds
v_mfma_f32_16x16x32_bf16 v[88:91], a[32:35], a[4:7], v[88:91]
ds_read_b64_tr_b16 a[100:101], v9 offset:4096
v_mfma_f32_16x16x32_bf16 v[92:95], a[36:39], a[4:7], v[92:95]
v_add_u32 v2, 0x80, v2
v_mfma_f32_16x16x32_bf16 v[96:99], a[4:7], a[40:43], v[96:99]
ds_read_b64_tr_b16 a[102:103], v9 offset:4608
v_mfma_f32_16x16x32_bf16 v[100:103], a[4:7], a[44:47], v[100:103]
buffer_load_dword v12, v11, s[8:11], 0 offen
v_mfma_f32_16x16x32_bf16 v[104:107], a[4:7], a[48:51], v[104:107]
ds_read_b64_tr_b16 a[104:105], v8 offset:12288
v_mfma_f32_16x16x32_bf16 v[108:111], a[4:7], a[52:55], v[108:111]
v_add_u32 v3, 0x80, v3
v_add_u32 v10, 0x80, v10
v_mfma_f32_16x16x32_bf16 v[112:115], a[32:35], a[8:11], v[112:115]
ds_read_b64_tr_b16 a[106:107], v8 offset:12800
v_mfma_f32_16x16x32_bf16 v[116:119], a[36:39], a[8:11], v[116:119]
v_mfma_f32_16x16x32_bf16 v[120:123], a[8:11], a[40:43], v[120:123]
ds_read_b64_tr_b16 a[108:109], v9 offset:12288
v_mfma_f32_16x16x32_bf16 v[124:127], a[8:11], a[44:47], v[124:127]
s_mov_b32 s16, s87
v_add_u32 v11, s99, v11
v_mfma_f32_16x16x32_bf16 v[128:131], a[8:11], a[48:51], v[128:131]
ds_read_b64_tr_b16 a[110:111], v9 offset:12800
v_mfma_f32_16x16x32_bf16 v[132:135], a[8:11], a[52:55], v[132:135]
v_mfma_f32_16x16x32_bf16 v[136:139], a[32:35], a[12:15], v[136:139]
ds_read_b64_tr_b16 a[112:113], v8 offset:20480
v_mfma_f32_16x16x32_bf16 v[140:143], a[36:39], a[12:15], v[140:143]
s_mov_b32 s87, s88
v_mfma_f32_16x16x32_bf16 v[144:147], a[12:15], a[40:43], v[144:147]
ds_read_b64_tr_b16 a[114:115], v8 offset:20992
v_mfma_f32_16x16x32_bf16 v[148:151], a[12:15], a[44:47], v[148:151]
v_mfma_f32_16x16x32_bf16 v[152:155], a[12:15], a[48:51], v[152:155]
ds_read_b64_tr_b16 a[116:117], v9 offset:20480
v_mfma_f32_16x16x32_bf16 v[156:159], a[12:15], a[52:55], v[156:159]
s_mov_b32 s88, s89
v_mfma_f32_16x16x32_bf16 v[160:163], a[32:35], a[16:19], v[160:163]
ds_read_b64_tr_b16 a[118:119], v9 offset:20992
v_mfma_f32_16x16x32_bf16 v[164:167], a[36:39], a[16:19], v[164:167]
v_mfma_f32_16x16x32_bf16 v[168:171], a[16:19], a[40:43], v[168:171]
ds_read_b128 a[68:71], v7 offset:2048
v_mfma_f32_16x16x32_bf16 v[172:175], a[16:19], a[44:47], v[172:175]
s_mov_b32 s89, s16
v_mfma_f32_16x16x32_bf16 v[176:179], a[16:19], a[48:51], v[176:179]
ds_read_b128 a[72:75], v7 offset:4096
v_mfma_f32_16x16x32_bf16 v[180:183], a[16:19], a[52:55], v[180:183]
v_mfma_f32_16x16x32_bf16 v[184:187], a[32:35], a[20:23], v[184:187]
ds_read_b128 a[76:79], v7 offset:6144
v_mfma_f32_16x16x32_bf16 v[188:191], a[36:39], a[20:23], v[188:191]
s_mov_b32 s40, s87
v_mfma_f32_16x16x32_bf16 v[192:195], a[20:23], a[40:43], v[192:195]
ds_read_b128 a[80:83], v7 offset:8192
v_mfma_f32_16x16x32_bf16 v[196:199], a[20:23], a[44:47], v[196:199]
v_mfma_f32_16x16x32_bf16 v[200:203], a[20:23], a[48:51], v[200:203]
ds_read_b128 a[84:87], v7 offset:10240
v_mfma_f32_16x16x32_bf16 v[204:207], a[20:23], a[52:55], v[204:207]
v_mfma_f32_16x16x32_bf16 v[208:211], a[32:35], a[24:27], v[208:211]
ds_read_b128 a[88:91], v7 offset:12288
v_mfma_f32_16x16x32_bf16 v[212:215], a[36:39], a[24:27], v[212:215]
v_mfma_f32_16x16x32_bf16 v[216:219], a[24:27], a[40:43], v[216:219]
ds_read_b128 a[92:95], v7 offset:14336
v_mfma_f32_16x16x32_bf16 v[220:223], a[24:27], a[44:47], v[220:223]
v_mfma_f32_16x16x32_bf16 v[224:227], a[24:27], a[48:51], v[224:227]
v_add_u32 v7, s92, v7
v_mfma_f32_16x16x32_bf16 v[228:231], a[24:27], a[52:55], v[228:231]
v_add_u32 v6, s92, v6
v_mfma_f32_16x16x32_bf16 v[232:235], a[32:35], a[28:31], v[232:235]
s_mov_b32 s17, s92
v_mfma_f32_16x16x32_bf16 v[236:239], a[36:39], a[28:31], v[236:239]
s_mov_b32 s92, s93
v_mfma_f32_16x16x32_bf16 v[240:243], a[28:31], a[40:43], v[240:243]
s_mov_b32 s93, s94
v_mfma_f32_16x16x32_bf16 v[244:247], a[28:31], a[44:47], v[244:247]
s_mov_b32 s94, s17
v_mfma_f32_16x16x32_bf16 v[248:251], a[28:31], a[48:51], v[248:251]
v_mfma_f32_16x16x32_bf16 v[252:255], a[28:31], a[52:55], v[252:255]
s_waitcnt lgkmcnt(0)
v_mfma_f32_16x16x32_bf16 v[64:67], a[96:99], a[64:67], v[64:67]
s_waitcnt vmcnt(16)
s_barrier
v_mfma_f32_16x16x32_bf16 v[68:71], a[100:103], a[64:67], v[68:71]
s_add_u32 m0, s40, 0
s_nop 0
buffer_load_dwordx4 v2, s[4:7], 0 offen lds
v_mfma_f32_16x16x32_bf16 v[72:75], a[64:67], a[104:107], v[72:75]
ds_read_b128 a[0:3], v6 offset:0
v_mfma_f32_16x16x32_bf16 v[76:79], a[64:67], a[108:111], v[76:79]
v_mfma_f32_16x16x32_bf16 v[80:83], a[64:67], a[112:115], v[80:83]
ds_read_b64_tr_b16 a[32:33], v8 offset:24576
v_mfma_f32_16x16x32_bf16 v[84:87], a[64:67], a[116:119], v[84:87]
buffer_load_dwordx4 v3, s[4:7], s64 offen offset:1024 lds
v_mfma_f32_16x16x32_bf16 v[88:91], a[96:99], a[68:71], v[88:91]
ds_read_b64_tr_b16 a[34:35], v8 offset:25088
v_mfma_f32_16x16x32_bf16 v[92:95], a[100:103], a[68:71], v[92:95]
v_mfma_f32_16x16x32_bf16 v[96:99], a[68:71], a[104:107], v[96:99]
ds_read_b64_tr_b16 a[36:37], v9 offset:24576
v_mfma_f32_16x16x32_bf16 v[100:103], a[68:71], a[108:111], v[100:103]
buffer_load_dwordx4 v2, s[4:7], s65 offen offset:2048 lds
v_mfma_f32_16x16x32_bf16 v[104:107], a[68:71], a[112:115], v[104:107]
ds_read_b64_tr_b16 a[38:39], v9 offset:25088
v_mfma_f32_16x16x32_bf16 v[108:111], a[68:71], a[116:119], v[108:111]
v_mfma_f32_16x16x32_bf16 v[112:115], a[96:99], a[72:75], v[112:115]
ds_read_b64_tr_b16 a[40:41], v8 offset:32768
v_mfma_f32_16x16x32_bf16 v[116:119], a[100:103], a[72:75], v[116:119]
buffer_load_dwordx4 v3, s[4:7], s66 offen offset:3072 lds
v_mfma_f32_16x16x32_bf16 v[120:123], a[72:75], a[104:107], v[120:123]
ds_read_b64_tr_b16 a[42:43], v8 offset:33280
v_mfma_f32_16x16x32_bf16 v[124:127], a[72:75], a[108:111], v[124:127]
v_mfma_f32_16x16x32_bf16 v[128:131], a[72:75], a[112:115], v[128:131]
ds_read_b64_tr_b16 a[44:45], v9 offset:32768
v_mfma_f32_16x16x32_bf16 v[132:135], a[72:75], a[116:119], v[132:135]
s_add_u32 m0, s40, 4096
s_nop 0
buffer_load_dwordx4 v2, s[4:7], s67 offen lds
v_mfma_f32_16x16x32_bf16 v[136:139], a[96:99], a[76:79], v[136:139]
ds_read_b64_tr_b16 a[46:47], v9 offset:33280
v_mfma_f32_16x16x32_bf16 v[140:143], a[100:103], a[76:79], v[140:143]
v_mfma_f32_16x16x32_bf16 v[144:147], a[76:79], a[104:107], v[144:147]
ds_read_b64_tr_b16 a[48:49], v8 offset:40960
v_mfma_f32_16x16x32_bf16 v[148:151], a[76:79], a[108:111], v[148:151]
buffer_load_dwordx4 v3, s[4:7], s68 offen offset:1024 lds
v_mfma_f32_16x16x32_bf16 v[152:155], a[76:79], a[112:115], v[152:155]
ds_read_b64_tr_b16 a[50:51], v8 offset:41472
v_mfma_f32_16x16x32_bf16 v[156:159], a[76:79], a[116:119], v[156:159]
v_mfma_f32_16x16x32_bf16 v[160:163], a[96:99], a[80:83], v[160:163]
ds_read_b64_tr_b16 a[52:53], v9 offset:40960
v_mfma_f32_16x16x32_bf16 v[164:167], a[100:103], a[80:83], v[164:167]
buffer_load_dwordx4 v2, s[4:7], s69 offen offset:2048 lds
v_mfma_f32_16x16x32_bf16 v[168:171], a[80:83], a[104:107], v[168:171]
ds_read_b64_tr_b16 a[54:55], v9 offset:41472
v_mfma_f32_16x16x32_bf16 v[172:175], a[80:83], a[108:111], v[172:175]
v_mfma_f32_16x16x32_bf16 v[176:179], a[80:83], a[112:115], v[176:179]
ds_read_b128 a[4:7], v6 offset:2048
v_mfma_f32_16x16x32_bf16 v[180:183], a[80:83], a[116:119], v[180:183]
buffer_load_dwordx4 v3, s[4:7], s70 offen offset:3072 lds
v_mfma_f32_16x16x32_bf16 v[184:187], a[96:99], a[84:87], v[184:187]
ds_read_b128 a[8:11], v6 offset:4096
v_mfma_f32_16x16x32_bf16 v[188:191], a[100:103], a[84:87], v[188:191]
v_mfma_f32_16x16x32_bf16 v[192:195], a[84:87], a[104:107], v[192:195]
ds_read_b128 a[12:15], v6 offset:6144
v_mfma_f32_16x16x32_bf16 v[196:199], a[84:87], a[108:111], v[196:199]
s_add_u32 m0, s40, 8192
s_nop 0
buffer_load_dwordx4 v2, s[4:7], s71 offen lds
v_mfma_f32_16x16x32_bf16 v[200:203], a[84:87], a[112:115], v[200:203]
ds_read_b128 a[16:19], v6 offset:8192
v_mfma_f32_16x16x32_bf16 v[204:207], a[84:87], a[116:119], v[204:207]
v_mfma_f32_16x16x32_bf16 v[208:211], a[96:99], a[88:91], v[208:211]
ds_read_b128 a[20:23], v6 offset:10240
v_mfma_f32_16x16x32_bf16 v[212:215], a[100:103], a[88:91], v[212:215]
buffer_load_dwordx4 v3, s[4:7], s72 offen offset:1024 lds
v_mfma_f32_16x16x32_bf16 v[216:219], a[88:91], a[104:107], v[216:219]
ds_read_b128 a[24:27], v6 offset:12288
v_mfma_f32_16x16x32_bf16 v[220:223], a[88:91], a[108:111], v[220:223]
v_mfma_f32_16x16x32_bf16 v[224:227], a[88:91], a[112:115], v[224:227]
ds_read_b128 a[28:31], v6 offset:14336
v_mfma_f32_16x16x32_bf16 v[228:231], a[88:91], a[116:119], v[228:231]
buffer_load_dwordx4 v2, s[4:7], s73 offen offset:2048 lds
v_mfma_f32_16x16x32_bf16 v[232:235], a[96:99], a[92:95], v[232:235]
v_mfma_f32_16x16x32_bf16 v[236:239], a[100:103], a[92:95], v[236:239]
v_mfma_f32_16x16x32_bf16 v[240:243], a[92:95], a[104:107], v[240:243]
v_mfma_f32_16x16x32_bf16 v[244:247], a[92:95], a[108:111], v[244:247]
buffer_load_dwordx4 v3, s[4:7], s74 offen offset:3072 lds
v_mfma_f32_16x16x32_bf16 v[248:251], a[92:95], a[112:115], v[248:251]
v_mfma_f32_16x16x32_bf16 v[252:255], a[92:95], a[116:119], v[252:255]
s_add_u32 s42, s42, 1
s_cmp_lt_u32 s42, 6
s_cbranch_scc1 .LA3_loop
.Ltail_A3:
s_waitcnt lgkmcnt(0)
v_mfma_f32_16x16x32_bf16 v[64:67], a[32:35], a[0:3], v[64:67]
ds_read_b128 a[64:67], v7 offset:0
v_mfma_f32_16x16x32_bf16 v[68:71], a[36:39], a[0:3], v[68:71]
s_add_u32 m0, s40, 12288
s_nop 0
buffer_load_dwordx4 v2, s[4:7], s75 offen lds
v_mfma_f32_16x16x32_bf16 v[72:75], a[0:3], a[40:43], v[72:75]
ds_read_b64_tr_b16 a[96:97], v8 offset:28672
v_mfma_f32_16x16x32_bf16 v[76:79], a[0:3], a[44:47], v[76:79]
v_mfma_f32_16x16x32_bf16 v[80:83], a[0:3], a[48:51], v[80:83]
ds_read_b64_tr_b16 a[98:99], v8 offset:29184
v_mfma_f32_16x16x32_bf16 v[84:87], a[0:3], a[52:55], v[84:87]
buffer_load_dwordx4 v3, s[4:7], s76 offen offset:1024 lds
v_mfma_f32_16x16x32_bf16 v[88:91], a[32:35], a[4:7], v[88:91]
ds_read_b64_tr_b16 a[100:101], v9 offset:28672
v_mfma_f32_16x16x32_bf16 v[92:95], a[36:39], a[4:7], v[92:95]
v_add_u32 v2, 0x80, v2
v_mfma_f32_16x16x32_bf16 v[96:99], a[4:7], a[40:43], v[96:99]
ds_read_b64_tr_b16 a[102:103], v9 offset:29184
v_mfma_f32_16x16x32_bf16 v[100:103], a[4:7], a[44:47], v[100:103]
buffer_load_dword v12, v11, s[8:11], 0 offen
v_mfma_f32_16x16x32_bf16 v[104:107], a[4:7], a[48:51], v[104:107]
ds_read_b64_tr_b16 a[104:105], v8 offset:36864
v_mfma_f32_16x16x32_bf16 v[108:111], a[4:7], a[52:55], v[108:111]
v_add_u32 v3, 0x80, v3
v_add_u32 v10, 0x80, v10
v_mfma_f32_16x16x32_bf16 v[112:115], a[32:35], a[8:11], v[112:115]
ds_read_b64_tr_b16 a[106:107], v8 offset:37376
v_mfma_f32_16x16x32_bf16 v[116:119], a[36:39], a[8:11], v[116:119]
v_mfma_f32_16x16x32_bf16 v[120:123], a[8:11], a[40:43], v[120:123]
ds_read_b64_tr_b16 a[108:109], v9 offset:36864
v_mfma_f32_16x16x32_bf16 v[124:127], a[8:11], a[44:47], v[124:127]
s_mov_b32 s16, s87
v_add_u32 v11, s99, v11
v_mfma_f32_16x16x32_bf16 v[128:131], a[8:11], a[48:51], v[128:131]
ds_read_b64_tr_b16 a[110:111], v9 offset:37376
v_mfma_f32_16x16x32_bf16 v[132:135], a[8:11], a[52:55], v[132:135]
v_mfma_f32_16x16x32_bf16 v[136:139], a[32:35], a[12:15], v[136:139]
ds_read_b64_tr_b16 a[112:113], v8 offset:45056
v_mfma_f32_16x16x32_bf16 v[140:143], a[36:39], a[12:15], v[140:143]
s_mov_b32 s87, s88
v_mfma_f32_16x16x32_bf16 v[144:147], a[12:15], a[40:43], v[144:147]
ds_read_b64_tr_b16 a[114:115], v8 offset:45568
v_mfma_f32_16x16x32_bf16 v[148:151], a[12:15], a[44:47], v[148:151]
v_mfma_f32_16x16x32_bf16 v[152:155], a[12:15], a[48:51], v[152:155]
ds_read_b64_tr_b16 a[116:117], v9 offset:45056
v_mfma_f32_16x16x32_bf16 v[156:159], a[12:15], a[52:55], v[156:159]
s_mov_b32 s88, s89
v_mfma_f32_16x16x32_bf16 v[160:163], a[32:35], a[16:19], v[160:163]
ds_read_b64_tr_b16 a[118:119], v9 offset:45568
v_mfma_f32_16x16x32_bf16 v[164:167], a[36:39], a[16:19], v[164:167]
v_mfma_f32_16x16x32_bf16 v[168:171], a[16:19], a[40:43], v[168:171]
ds_read_b128 a[68:71], v7 offset:2048
v_mfma_f32_16x16x32_bf16 v[172:175], a[16:19], a[44:47], v[172:175]
s_mov_b32 s89, s16
v_mfma_f32_16x16x32_bf16 v[176:179], a[16:19], a[48:51], v[176:179]
ds_read_b128 a[72:75], v7 offset:4096
v_mfma_f32_16x16x32_bf16 v[180:183], a[16:19], a[52:55], v[180:183]
v_mfma_f32_16x16x32_bf16 v[184:187], a[32:35], a[20:23], v[184:187]
ds_read_b128 a[76:79], v7 offset:6144
v_mfma_f32_16x16x32_bf16 v[188:191], a[36:39], a[20:23], v[188:191]
s_mov_b32 s40, s87
v_mfma_f32_16x16x32_bf16 v[192:195], a[20:23], a[40:43], v[192:195]
ds_read_b128 a[80:83], v7 offset:8192
v_mfma_f32_16x16x32_bf16 v[196:199], a[20:23], a[44:47], v[196:199]
v_mfma_f32_16x16x32_bf16 v[200:203], a[20:23], a[48:51], v[200:203]
ds_read_b128 a[84:87], v7 offset:10240
v_mfma_f32_16x16x32_bf16 v[204:207], a[20:23], a[52:55], v[204:207]
v_mfma_f32_16x16x32_bf16 v[208:211], a[32:35], a[24:27], v[208:211]
ds_read_b128 a[88:91], v7 offset:12288
v_mfma_f32_16x16x32_bf16 v[212:215], a[36:39], a[24:27], v[212:215]
v_mfma_f32_16x16x32_bf16 v[216:219], a[24:27], a[40:43], v[216:219]
ds_read_b128 a[92:95], v7 offset:14336
v_mfma_f32_16x16x32_bf16 v[220:223], a[24:27], a[44:47], v[220:223]
v_mfma_f32_16x16x32_bf16 v[224:227], a[24:27], a[48:51], v[224:227]
v_add_u32 v7, s92, v7
v_mfma_f32_16x16x32_bf16 v[228:231], a[24:27], a[52:55], v[228:231]
v_add_u32 v6, s92, v6
v_mfma_f32_16x16x32_bf16 v[232:235], a[32:35], a[28:31], v[232:235]
s_mov_b32 s17, s92
v_mfma_f32_16x16x32_bf16 v[236:239], a[36:39], a[28:31], v[236:239]
s_mov_b32 s92, s93
v_mfma_f32_16x16x32_bf16 v[240:243], a[28:31], a[40:43], v[240:243]
s_mov_b32 s93, s94
v_mfma_f32_16x16x32_bf16 v[244:247], a[28:31], a[44:47], v[244:247]
s_mov_b32 s94, s17
v_mfma_f32_16x16x32_bf16 v[248:251], a[28:31], a[48:51], v[248:251]
v_mfma_f32_16x16x32_bf16 v[252:255], a[28:31], a[52:55], v[252:255]
s_waitcnt lgkmcnt(0)
v_mfma_f32_16x16x32_bf16 v[64:67], a[96:99], a[64:67], v[64:67]
s_waitcnt vmcnt(16)
s_barrier
v_mfma_f32_16x16x32_bf16 v[68:71], a[100:103], a[64:67], v[68:71]
v_mfma_f32_16x16x32_bf16 v[72:75], a[64:67], a[104:107], v[72:75]
ds_read_b128 a[0:3], v6 offset:0
v_mfma_f32_16x16x32_bf16 v[76:79], a[64:67], a[108:111], v[76:79]
s_getpc_b64 s[20:21]
.Lpc_lateA3:
s_add_u32 s20, s20, .Lph2_A-.Lpc_lateA3
s_addc_u32 s21, s21, 0
v_lshlrev_b32 v10, 7, v0
v_min_u32 v11, .Lall_text_end-.Lph2_A-4, v10
global_load_dword v12, v11, s[20:21]
v_add_u32 v10, 0x2000, v10
v_min_u32 v11, .Lall_text_end-.Lph2_A-4, v10
global_load_dword v12, v11, s[20:21]
v_add_u32 v10, 0x2000, v10
v_min_u32 v11, .Lall_text_end-.Lph2_A-4, v10
global_load_dword v12, v11, s[20:21]
v_add_u32 v10, 0x2000, v10
v_min_u32 v11, .Lall_text_end-.Lph2_A-4, v10
global_load_dword v12, v11, s[20:21]
v_add_u32 v10, 0x2000, v10
v_min_u32 v11, .Lall_text_end-.Lph2_A-4, v10
global_load_dword v12, v11, s[20:21]
v_mfma_f32_16x16x32_bf16 v[80:83], a[64:67], a[112:115], v[80:83]
ds_read_b64_tr_b16 a[32:33], v8 offset:0
v_mfma_f32_16x16x32_bf16 v[84:87], a[64:67], a[116:119], v[84:87]
v_mfma_f32_16x16x32_bf16 v[88:91], a[96:99], a[68:71], v[88:91]
ds_read_b64_tr_b16 a[34:35], v8 offset:512
v_mfma_f32_16x16x32_bf16 v[92:95], a[100:103], a[68:71], v[92:95]
v_mfma_f32_16x16x32_bf16 v[96:99], a[68:71], a[104:107], v[96:99]
ds_read_b64_tr_b16 a[36:37], v9 offset:0
v_mfma_f32_16x16x32_bf16 v[100:103], a[68:71], a[108:111], v[100:103]
v_mfma_f32_16x16x32_bf16 v[104:107], a[68:71], a[112:115], v[104:107]
ds_read_b64_tr_b16 a[38:39], v9 offset:512
v_mfma_f32_16x16x32_bf16 v[108:111], a[68:71], a[116:119], v[108:111]
v_mfma_f32_16x16x32_bf16 v[112:115], a[96:99], a[72:75], v[112:115]
ds_read_b64_tr_b16 a[40:41], v8 offset:8192
v_mfma_f32_16x16x32_bf16 v[116:119], a[100:103], a[72:75], v[116:119]
v_mfma_f32_16x16x32_bf16 v[120:123], a[72:75], a[104:107], v[120:123]
ds_read_b64_tr_b16 a[42:43], v8 offset:8704
v_mfma_f32_16x16x32_bf16 v[124:127], a[72:75], a[108:111], v[124:127]
v_mfma_f32_16x16x32_bf16 v[128:131], a[72:75], a[112:115], v[128:131]
ds_read_b64_tr_b16 a[44:45], v9 offset:8192
v_mfma_f32_16x16x32_bf16 v[132:135], a[72:75], a[116:119], v[132:135]
v_mfma_f32_16x16x32_bf16 v[136:139], a[96:99], a[76:79], v[136:139]
ds_read_b64_tr_b16 a[46:47], v9 offset:8704
v_mfma_f32_16x16x32_bf16 v[140:143], a[100:103], a[76:79], v[140:143]
v_mfma_f32_16x16x32_bf16 v[144:147], a[76:79], a[104:107], v[144:147]
ds_read_b64_tr_b16 a[48:49], v8 offset:16384
v_mfma_f32_16x16x32_bf16 v[148:151], a[76:79], a[108:111], v[148:151]
v_mfma_f32_16x16x32_bf16 v[152:155], a[76:79], a[112:115], v[152:155]
ds_read_b64_tr_b16 a[50:51], v8 offset:16896
v_mfma_f32_16x16x32_bf16 v[156:159], a[76:79], a[116:119], v[156:159]
v_mfma_f32_16x16x32_bf16 v[160:163], a[96:99], a[80:83], v[160:163]
ds_read_b64_tr_b16 a[52:53], v9 offset:16384
v_mfma_f32_16x16x32_bf16 v[164:167], a[100:103], a[80:83], v[164:167]
v_mfma_f32_16x16x32_bf16 v[168:171], a[80:83], a[104:107], v[168:171]
ds_read_b64_tr_b16 a[54:55], v9 offset:16896
v_mfma_f32_16x16x32_bf16 v[172:175], a[80:83], a[108:111], v[172:175]
v_mfma_f32_16x16x32_bf16 v[176:179], a[80:83], a[112:115], v[176:179]
ds_read_b128 a[4:7], v6 offset:2048
v_mfma_f32_16x16x32_bf16 v[180:183], a[80:83], a[116:119], v[180:183]
v_mfma_f32_16x16x32_bf16 v[184:187], a[96:99], a[84:87], v[184:187]
ds_read_b128 a[8:11], v6 offset:4096
v_mfma_f32_16x16x32_bf16 v[188:191], a[100:103], a[84:87], v[188:191]
v_mfma_f32_16x16x32_bf16 v[192:195], a[84:87], a[104:107], v[192:195]
ds_read_b128 a[12:15], v6 offset:6144
v_mfma_f32_16x16x32_bf16 v[196:199], a[84:87], a[108:111], v[196:199]
v_mfma_f32_16x16x32_bf16 v[200:203], a[84:87], a[112:115], v[200:203]
ds_read_b128 a[16:19], v6 offset:8192
v_mfma_f32_16x16x32_bf16 v[204:207], a[84:87], a[116:119], v[204:207]
v_mfma_f32_16x16x32_bf16 v[208:211], a[96:99], a[88:91], v[208:211]
ds_read_b128 a[20:23], v6 offset:10240
v_mfma_f32_16x16x32_bf16 v[212:215], a[100:103], a[88:91], v[212:215]
v_mfma_f32_16x16x32_bf16 v[216:219], a[88:91], a[104:107], v[216:219]
ds_read_b128 a[24:27], v6 offset:12288
v_mfma_f32_16x16x32_bf16 v[220:223], a[88:91], a[108:111], v[220:223]
v_mfma_f32_16x16x32_bf16 v[224:227], a[88:91], a[112:115], v[224:227]
ds_read_b128 a[28:31], v6 offset:14336
v_mfma_f32_16x16x32_bf16 v[228:231], a[88:91], a[116:119], v[228:231]
v_mfma_f32_16x16x32_bf16 v[232:235], a[96:99], a[92:95], v[232:235]
v_mfma_f32_16x16x32_bf16 v[236:239], a[100:103], a[92:95], v[236:239]
v_mfma_f32_16x16x32_bf16 v[240:243], a[92:95], a[104:107], v[240:243]
v_mfma_f32_16x16x32_bf16 v[244:247], a[92:95], a[108:111], v[244:247]
v_mfma_f32_16x16x32_bf16 v[248:251], a[92:95], a[112:115], v[248:251]
v_mfma_f32_16x16x32_bf16 v[252:255], a[92:95], a[116:119], v[252:255]
s_waitcnt lgkmcnt(0)
v_mfma_f32_16x16x32_bf16 v[64:67], a[32:35], a[0:3], v[64:67]
ds_read_b128 a[64:67], v7 offset:0
v_mfma_f32_16x16x32_bf16 v[68:71], a[36:39], a[0:3], v[68:71]
v_mfma_f32_16x16x32_bf16 v[72:75], a[0:3], a[40:43], v[72:75]
ds_read_b64_tr_b16 a[96:97], v8 offset:4096
v_mfma_f32_16x16x32_bf16 v[76:79], a[0:3], a[44:47], v[76:79]
v_mfma_f32_16x16x32_bf16 v[80:83], a[0:3], a[48:51], v[80:83]
ds_read_b64_tr_b16 a[98:99], v8 offset:4608
v_mfma_f32_16x16x32_bf16 v[84:87], a[0:3], a[52:55], v[84:87]
v_mfma_f32_16x16x32_bf16 v[88:91], a[32:35], a[4:7], v[88:91]
ds_read_b64_tr_b16 a[100:101], v9 offset:4096
v_mfma_f32_16x16x32_bf16 v[92:95], a[36:39], a[4:7], v[92:95]
v_mfma_f32_16x16x32_bf16 v[96:99], a[4:7], a[40:43], v[96:99]
ds_read_b64_tr_b16 a[102:103], v9 offset:4608
v_mfma_f32_16x16x32_bf16 v[100:103], a[4:7], a[44:47], v[100:103]
v_mfma_f32_16x16x32_bf16 v[104:107], a[4:7], a[48:51], v[104:107]
ds_read_b64_tr_b16 a[104:105], v8 offset:12288
v_mfma_f32_16x16x32_bf16 v[108:111], a[4:7], a[52:55], v[108:111]
v_mfma_f32_16x16x32_bf16 v[112:115], a[32:35], a[8:11], v[112:115]
ds_read_b64_tr_b16 a[106:107], v8 offset:12800
v_mfma_f32_16x16x32_bf16 v[116:119], a[36:39], a[8:11], v[116:119]
v_mfma_f32_16x16x32_bf16 v[120:123], a[8:11], a[40:43], v[120:123]
ds_read_b64_tr_b16 a[108:109], v9 offset:12288
v_mfma_f32_16x16x32_bf16 v[124:127], a[8:11], a[44:47], v[124:127]
v_mfma_f32_16x16x32_bf16 v[128:131], a[8:11], a[48:51], v[128:131]
ds_read_b64_tr_b16 a[110:111], v9 offset:12800
v_mfma_f32_16x16x32_bf16 v[132:135], a[8:11], a[52:55], v[132:135]
v_mfma_f32_16x16x32_bf16 v[136:139], a[32:35], a[12:15], v[136:139]
ds_read_b64_tr_b16 a[112:113], v8 offset:20480
v_mfma_f32_16x16x32_bf16 v[140:143], a[36:39], a[12:15], v[140:143]
v_mfma_f32_16x16x32_bf16 v[144:147], a[12:15], a[40:43], v[144:147]
ds_read_b64_tr_b16 a[114:115], v8 offset:20992
v_mfma_f32_16x16x32_bf16 v[148:151], a[12:15], a[44:47], v[148:151]
v_mfma_f32_16x16x32_bf16 v[152:155], a[12:15], a[48:51], v[152:155]
ds_read_b64_tr_b16 a[116:117], v9 offset:20480
v_mfma_f32_16x16x32_bf16 v[156:159], a[12:15], a[52:55], v[156:159]
v_mfma_f32_16x16x32_bf16 v[160:163], a[32:35], a[16:19], v[160:163]
ds_read_b64_tr_b16 a[118:119], v9 offset:20992
v_mfma_f32_16x16x32_bf16 v[164:167], a[36:39], a[16:19], v[164:167]
v_mfma_f32_16x16x32_bf16 v[168:171], a[16:19], a[40:43], v[168:171]
ds_read_b128 a[68:71], v7 offset:2048
v_mfma_f32_16x16x32_bf16 v[172:175], a[16:19], a[44:47], v[172:175]
v_mfma_f32_16x16x32_bf16 v[176:179], a[16:19], a[48:51], v[176:179]
ds_read_b128 a[72:75], v7 offset:4096
v_mfma_f32_16x16x32_bf16 v[180:183], a[16:19], a[52:55], v[180:183]
v_mfma_f32_16x16x32_bf16 v[184:187], a[32:35], a[20:23], v[184:187]
ds_read_b128 a[76:79], v7 offset:6144
v_mfma_f32_16x16x32_bf16 v[188:191], a[36:39], a[20:23], v[188:191]
v_mfma_f32_16x16x32_bf16 v[192:195], a[20:23], a[40:43], v[192:195]
ds_read_b128 a[80:83], v7 offset:8192
v_mfma_f32_16x16x32_bf16 v[196:199], a[20:23], a[44:47], v[196:199]
v_mfma_f32_16x16x32_bf16 v[200:203], a[20:23], a[48:51], v[200:203]
ds_read_b128 a[84:87], v7 offset:10240
v_mfma_f32_16x16x32_bf16 v[204:207], a[20:23], a[52:55], v[204:207]
v_mfma_f32_16x16x32_bf16 v[208:211], a[32:35], a[24:27], v[208:211]
ds_read_b128 a[88:91], v7 offset:12288
v_mfma_f32_16x16x32_bf16 v[212:215], a[36:39], a[24:27], v[212:215]
v_mfma_f32_16x16x32_bf16 v[216:219], a[24:27], a[40:43], v[216:219]
ds_read_b128 a[92:95], v7 offset:14336
v_mfma_f32_16x16x32_bf16 v[220:223], a[24:27], a[44:47], v[220:223]
v_mfma_f32_16x16x32_bf16 v[224:227], a[24:27], a[48:51], v[224:227]
v_add_u32 v7, s92, v7
v_mfma_f32_16x16x32_bf16 v[228:231], a[24:27], a[52:55], v[228:231]
v_add_u32 v6, s92, v6
v_mfma_f32_16x16x32_bf16 v[232:235], a[32:35], a[28:31], v[232:235]
s_mov_b32 s17, s92
v_mfma_f32_16x16x32_bf16 v[236:239], a[36:39], a[28:31], v[236:239]
s_mov_b32 s92, s93
v_mfma_f32_16x16x32_bf16 v[240:243], a[28:31], a[40:43], v[240:243]
s_mov_b32 s93, s94
v_mfma_f32_16x16x32_bf16 v[244:247], a[28:31], a[44:47], v[244:247]
s_mov_b32 s94, s17
v_mfma_f32_16x16x32_bf16 v[248:251], a[28:31], a[48:51], v[248:251]
v_mfma_f32_16x16x32_bf16 v[252:255], a[28:31], a[52:55], v[252:255]
s_waitcnt lgkmcnt(0)
v_mfma_f32_16x16x32_bf16 v[64:67], a[96:99], a[64:67], v[64:67]
s_waitcnt vmcnt(0)
s_barrier
v_mfma_f32_16x16x32_bf16 v[68:71], a[100:103], a[64:67], v[68:71]
v_mfma_f32_16x16x32_bf16 v[72:75], a[64:67], a[104:107], v[72:75]
ds_read_b128 a[0:3], v6 offset:0
v_mfma_f32_16x16x32_bf16 v[76:79], a[64:67], a[108:111], v[76:79]
v_mfma_f32_16x16x32_bf16 v[80:83], a[64:67], a[112:115], v[80:83]
ds_read_b64_tr_b16 a[32:33], v8 offset:24576
v_mfma_f32_16x16x32_bf16 v[84:87], a[64:67], a[116:119], v[84:87]
v_mfma_f32_16x16x32_bf16 v[88:91], a[96:99], a[68:71], v[88:91]
ds_read_b64_tr_b16 a[34:35], v8 offset:25088
v_mfma_f32_16x16x32_bf16 v[92:95], a[100:103], a[68:71], v[92:95]
v_mfma_f32_16x16x32_bf16 v[96:99], a[68:71], a[104:107], v[96:99]
ds_read_b64_tr_b16 a[36:37], v9 offset:24576
v_mfma_f32_16x16x32_bf16 v[100:103], a[68:71], a[108:111], v[100:103]
v_mfma_f32_16x16x32_bf16 v[104:107], a[68:71], a[112:115], v[104:107]
ds_read_b64_tr_b16 a[38:39], v9 offset:25088
v_mfma_f32_16x16x32_bf16 v[108:111], a[68:71], a[116:119], v[108:111]
v_mfma_f32_16x16x32_bf16 v[112:115], a[96:99], a[72:75], v[112:115]
ds_read_b64_tr_b16 a[40:41], v8 offset:32768
v_mfma_f32_16x16x32_bf16 v[116:119], a[100:103], a[72:75], v[116:119]
v_mfma_f32_16x16x32_bf16 v[120:123], a[72:75], a[104:107], v[120:123]
ds_read_b64_tr_b16 a[42:43], v8 offset:33280
v_mfma_f32_16x16x32_bf16 v[124:127], a[72:75], a[108:111], v[124:127]
v_mfma_f32_16x16x32_bf16 v[128:131], a[72:75], a[112:115], v[128:131]
ds_read_b64_tr_b16 a[44:45], v9 offset:32768
v_mfma_f32_16x16x32_bf16 v[132:135], a[72:75], a[116:119], v[132:135]
v_mfma_f32_16x16x32_bf16 v[136:139], a[96:99], a[76:79], v[136:139]
ds_read_b64_tr_b16 a[46:47], v9 offset:33280
v_mfma_f32_16x16x32_bf16 v[140:143], a[100:103], a[76:79], v[140:143]
v_mfma_f32_16x16x32_bf16 v[144:147], a[76:79], a[104:107], v[144:147]
ds_read_b64_tr_b16 a[48:49], v8 offset:40960
v_mfma_f32_16x16x32_bf16 v[148:151], a[76:79], a[108:111], v[148:151]
v_mfma_f32_16x16x32_bf16 v[152:155], a[76:79], a[112:115], v[152:155]
ds_read_b64_tr_b16 a[50:51], v8 offset:41472
v_mfma_f32_16x16x32_bf16 v[156:159], a[76:79], a[116:119], v[156:159]
v_mfma_f32_16x16x32_bf16 v[160:163], a[96:99], a[80:83], v[160:163]
ds_read_b64_tr_b16 a[52:53], v9 offset:40960
v_mfma_f32_16x16x32_bf16 v[164:167], a[100:103], a[80:83], v[164:167]
v_mfma_f32_16x16x32_bf16 v[168:171], a[80:83], a[104:107], v[168:171]
ds_read_b64_tr_b16 a[54:55], v9 offset:41472
v_mfma_f32_16x16x32_bf16 v[172:175], a[80:83], a[108:111], v[172:175]
v_mfma_f32_16x16x32_bf16 v[176:179], a[80:83], a[112:115], v[176:179]
ds_read_b128 a[4:7], v6 offset:2048
v_mfma_f32_16x16x32_bf16 v[180:183], a[80:83], a[116:119], v[180:183]
v_mfma_f32_16x16x32_bf16 v[184:187], a[96:99], a[84:87], v[184:187]
ds_read_b128 a[8:11], v6 offset:4096
v_mfma_f32_16x16x32_bf16 v[188:191], a[100:103], a[84:87], v[188:191]
v_mfma_f32_16x16x32_bf16 v[192:195], a[84:87], a[104:107], v[192:195]
ds_read_b128 a[12:15], v6 offset:6144
v_mfma_f32_16x16x32_bf16 v[196:199], a[84:87], a[108:111], v[196:199]
v_mfma_f32_16x16x32_bf16 v[200:203], a[84:87], a[112:115], v[200:203]
ds_read_b128 a[16:19], v6 offset:8192
v_mfma_f32_16x16x32_bf16 v[204:207], a[84:87], a[116:119], v[204:207]
v_mfma_f32_16x16x32_bf16 v[208:211], a[96:99], a[88:91], v[208:211]
ds_read_b128 a[20:23], v6 offset:10240
v_mfma_f32_16x16x32_bf16 v[212:215], a[100:103], a[88:91], v[212:215]
v_mfma_f32_16x16x32_bf16 v[216:219], a[88:91], a[104:107], v[216:219]
ds_read_b128 a[24:27], v6 offset:12288
v_mfma_f32_16x16x32_bf16 v[220:223], a[88:91], a[108:111], v[220:223]
v_mfma_f32_16x16x32_bf16 v[224:227], a[88:91], a[112:115], v[224:227]
ds_read_b128 a[28:31], v6 offset:14336
v_mfma_f32_16x16x32_bf16 v[228:231], a[88:91], a[116:119], v[228:231]
v_mfma_f32_16x16x32_bf16 v[232:235], a[96:99], a[92:95], v[232:235]
v_mfma_f32_16x16x32_bf16 v[236:239], a[100:103], a[92:95], v[236:239]
v_mfma_f32_16x16x32_bf16 v[240:243], a[92:95], a[104:107], v[240:243]
v_mfma_f32_16x16x32_bf16 v[244:247], a[92:95], a[108:111], v[244:247]
v_mfma_f32_16x16x32_bf16 v[248:251], a[92:95], a[112:115], v[248:251]
v_mfma_f32_16x16x32_bf16 v[252:255], a[92:95], a[116:119], v[252:255]
s_waitcnt lgkmcnt(0)
v_mfma_f32_16x16x32_bf16 v[64:67], a[32:35], a[0:3], v[64:67]
ds_read_b128 a[64:67], v7 offset:0
v_mfma_f32_16x16x32_bf16 v[68:71], a[36:39], a[0:3], v[68:71]
v_mfma_f32_16x16x32_bf16 v[72:75], a[0:3], a[40:43], v[72:75]
ds_read_b64_tr_b16 a[96:97], v8 offset:28672
v_mfma_f32_16x16x32_bf16 v[76:79], a[0:3], a[44:47], v[76:79]
v_mfma_f32_16x16x32_bf16 v[80:83], a[0:3], a[48:51], v[80:83]
ds_read_b64_tr_b16 a[98:99], v8 offset:29184
v_mfma_f32_16x16x32_bf16 v[84:87], a[0:3], a[52:55], v[84:87]
v_mfma_f32_16x16x32_bf16 v[88:91], a[32:35], a[4:7], v[88:91]
ds_read_b64_tr_b16 a[100:101], v9 offset:28672
v_mfma_f32_16x16x32_bf16 v[92:95], a[36:39], a[4:7], v[92:95]
v_mfma_f32_16x16x32_bf16 v[96:99], a[4:7], a[40:43], v[96:99]
ds_read_b64_tr_b16 a[102:103], v9 offset:29184
v_mfma_f32_16x16x32_bf16 v[100:103], a[4:7], a[44:47], v[100:103]
v_mfma_f32_16x16x32_bf16 v[104:107], a[4:7], a[48:51], v[104:107]
ds_read_b64_tr_b16 a[104:105], v8 offset:36864
v_mfma_f32_16x16x32_bf16 v[108:111], a[4:7], a[52:55], v[108:111]
v_mfma_f32_16x16x32_bf16 v[112:115], a[32:35], a[8:11], v[112:115]
ds_read_b64_tr_b16 a[106:107], v8 offset:37376
v_mfma_f32_16x16x32_bf16 v[116:119], a[36:39], a[8:11], v[116:119]
v_mfma_f32_16x16x32_bf16 v[120:123], a[8:11], a[40:43], v[120:123]
ds_read_b64_tr_b16 a[108:109], v9 offset:36864
v_mfma_f32_16x16x32_bf16 v[124:127], a[8:11], a[44:47], v[124:127]
v_mfma_f32_16x16x32_bf16 v[128:131], a[8:11], a[48:51], v[128:131]
ds_read_b64_tr_b16 a[110:111], v9 offset:37376
v_mfma_f32_16x16x32_bf16 v[132:135], a[8:11], a[52:55], v[132:135]
v_mfma_f32_16x16x32_bf16 v[136:139], a[32:35], a[12:15], v[136:139]
ds_read_b64_tr_b16 a[112:113], v8 offset:45056
v_mfma_f32_16x16x32_bf16 v[140:143], a[36:39], a[12:15], v[140:143]
v_mfma_f32_16x16x32_bf16 v[144:147], a[12:15], a[40:43], v[144:147]
ds_read_b64_tr_b16 a[114:115], v8 offset:45568
v_mfma_f32_16x16x32_bf16 v[148:151], a[12:15], a[44:47], v[148:151]
v_mfma_f32_16x16x32_bf16 v[152:155], a[12:15], a[48:51], v[152:155]
ds_read_b64_tr_b16 a[116:117], v9 offset:45056
v_mfma_f32_16x16x32_bf16 v[156:159], a[12:15], a[52:55], v[156:159]
v_mfma_f32_16x16x32_bf16 v[160:163], a[32:35], a[16:19], v[160:163]
ds_read_b64_tr_b16 a[118:119], v9 offset:45568
v_mfma_f32_16x16x32_bf16 v[164:167], a[36:39], a[16:19], v[164:167]
v_mfma_f32_16x16x32_bf16 v[168:171], a[16:19], a[40:43], v[168:171]
ds_read_b128 a[68:71], v7 offset:2048
v_mfma_f32_16x16x32_bf16 v[172:175], a[16:19], a[44:47], v[172:175]
v_mfma_f32_16x16x32_bf16 v[176:179], a[16:19], a[48:51], v[176:179]
ds_read_b128 a[72:75], v7 offset:4096
v_mfma_f32_16x16x32_bf16 v[180:183], a[16:19], a[52:55], v[180:183]
v_mfma_f32_16x16x32_bf16 v[184:187], a[32:35], a[20:23], v[184:187]
ds_read_b128 a[76:79], v7 offset:6144
v_mfma_f32_16x16x32_bf16 v[188:191], a[36:39], a[20:23], v[188:191]
v_mfma_f32_16x16x32_bf16 v[192:195], a[20:23], a[40:43], v[192:195]
ds_read_b128 a[80:83], v7 offset:8192
v_mfma_f32_16x16x32_bf16 v[196:199], a[20:23], a[44:47], v[196:199]
v_mfma_f32_16x16x32_bf16 v[200:203], a[20:23], a[48:51], v[200:203]
ds_read_b128 a[84:87], v7 offset:10240
v_mfma_f32_16x16x32_bf16 v[204:207], a[20:23], a[52:55], v[204:207]
v_mfma_f32_16x16x32_bf16 v[208:211], a[32:35], a[24:27], v[208:211]
ds_read_b128 a[88:91], v7 offset:12288
v_mfma_f32_16x16x32_bf16 v[212:215], a[36:39], a[24:27], v[212:215]
v_mfma_f32_16x16x32_bf16 v[216:219], a[24:27], a[40:43], v[216:219]
ds_read_b128 a[92:95], v7 offset:14336
v_mfma_f32_16x16x32_bf16 v[220:223], a[24:27], a[44:47], v[220:223]
v_mfma_f32_16x16x32_bf16 v[224:227], a[24:27], a[48:51], v[224:227]
v_add_u32 v7, s92, v7
v_mfma_f32_16x16x32_bf16 v[228:231], a[24:27], a[52:55], v[228:231]
v_add_u32 v6, s92, v6
v_mfma_f32_16x16x32_bf16 v[232:235], a[32:35], a[28:31], v[232:235]
s_mov_b32 s17, s92
v_mfma_f32_16x16x32_bf16 v[236:239], a[36:39], a[28:31], v[236:239]
s_mov_b32 s92, s93
v_mfma_f32_16x16x32_bf16 v[240:243], a[28:31], a[40:43], v[240:243]
s_mov_b32 s93, s94
v_mfma_f32_16x16x32_bf16 v[244:247], a[28:31], a[44:47], v[244:247]
s_mov_b32 s94, s17
v_mfma_f32_16x16x32_bf16 v[248:251], a[28:31], a[48:51], v[248:251]
v_mfma_f32_16x16x32_bf16 v[252:255], a[28:31], a[52:55], v[252:255]
s_waitcnt lgkmcnt(0)
v_mfma_f32_16x16x32_bf16 v[64:67], a[96:99], a[64:67], v[64:67]
v_mfma_f32_16x16x32_bf16 v[68:71], a[100:103], a[64:67], v[68:71]
v_mfma_f32_16x16x32_bf16 v[72:75], a[64:67], a[104:107], v[72:75]
v_mfma_f32_16x16x32_bf16 v[76:79], a[64:67], a[108:111], v[76:79]
v_mfma_f32_16x16x32_bf16 v[80:83], a[64:67], a[112:115], v[80:83]
v_mfma_f32_16x16x32_bf16 v[84:87], a[64:67], a[116:119], v[84:87]
v_mfma_f32_16x16x32_bf16 v[88:91], a[96:99], a[68:71], v[88:91]
v_mfma_f32_16x16x32_bf16 v[92:95], a[100:103], a[68:71], v[92:95]
v_mfma_f32_16x16x32_bf16 v[96:99], a[68:71], a[104:107], v[96:99]
v_mfma_f32_16x16x32_bf16 v[100:103], a[68:71], a[108:111], v[100:103]
v_mfma_f32_16x16x32_bf16 v[104:107], a[68:71], a[112:115], v[104:107]
v_mfma_f32_16x16x32_bf16 v[108:111], a[68:71], a[116:119], v[108:111]
v_mfma_f32_16x16x32_bf16 v[112:115], a[96:99], a[72:75], v[112:115]
v_mfma_f32_16x16x32_bf16 v[116:119], a[100:103], a[72:75], v[116:119]
v_mfma_f32_16x16x32_bf16 v[120:123], a[72:75], a[104:107], v[120:123]
v_mfma_f32_16x16x32_bf16 v[124:127], a[72:75], a[108:111], v[124:127]
v_mfma_f32_16x16x32_bf16 v[128:131], a[72:75], a[112:115], v[128:131]
v_mfma_f32_16x16x32_bf16 v[132:135], a[72:75], a[116:119], v[132:135]
v_mfma_f32_16x16x32_bf16 v[136:139], a[96:99], a[76:79], v[136:139]
v_mfma_f32_16x16x32_bf16 v[140:143], a[100:103], a[76:79], v[140:143]
v_mfma_f32_16x16x32_bf16 v[144:147], a[76:79], a[104:107], v[144:147]
v_mfma_f32_16x16x32_bf16 v[148:151], a[76:79], a[108:111], v[148:151]
v_mfma_f32_16x16x32_bf16 v[152:155], a[76:79], a[112:115], v[152:155]
v_mfma_f32_16x16x32_bf16 v[156:159], a[76:79], a[116:119], v[156:159]
v_mfma_f32_16x16x32_bf16 v[160:163], a[96:99], a[80:83], v[160:163]
v_mfma_f32_16x16x32_bf16 v[164:167], a[100:103], a[80:83], v[164:167]
v_mfma_f32_16x16x32_bf16 v[168:171], a[80:83], a[104:107], v[168:171]
v_mfma_f32_16x16x32_bf16 v[172:175], a[80:83], a[108:111], v[172:175]
v_mfma_f32_16x16x32_bf16 v[176:179], a[80:83], a[112:115], v[176:179]
v_mfma_f32_16x16x32_bf16 v[180:183], a[80:83], a[116:119], v[180:183]
v_mfma_f32_16x16x32_bf16 v[184:187], a[96:99], a[84:87], v[184:187]
v_mfma_f32_16x16x32_bf16 v[188:191], a[100:103], a[84:87], v[188:191]
v_mfma_f32_16x16x32_bf16 v[192:195], a[84:87], a[104:107], v[192:195]
v_mfma_f32_16x16x32_bf16 v[196:199], a[84:87], a[108:111], v[196:199]
v_mfma_f32_16x16x32_bf16 v[200:203], a[84:87], a[112:115], v[200:203]
v_mfma_f32_16x16x32_bf16 v[204:207], a[84:87], a[116:119], v[204:207]
v_mfma_f32_16x16x32_bf16 v[208:211], a[96:99], a[88:91], v[208:211]
v_mfma_f32_16x16x32_bf16 v[212:215], a[100:103], a[88:91], v[212:215]
v_mfma_f32_16x16x32_bf16 v[216:219], a[88:91], a[104:107], v[216:219]
v_mfma_f32_16x16x32_bf16 v[220:223], a[88:91], a[108:111], v[220:223]
v_mfma_f32_16x16x32_bf16 v[224:227], a[88:91], a[112:115], v[224:227]
v_mfma_f32_16x16x32_bf16 v[228:231], a[88:91], a[116:119], v[228:231]
v_mfma_f32_16x16x32_bf16 v[232:235], a[96:99], a[92:95], v[232:235]
v_mfma_f32_16x16x32_bf16 v[236:239], a[100:103], a[92:95], v[236:239]
v_mfma_f32_16x16x32_bf16 v[240:243], a[92:95], a[104:107], v[240:243]
v_mfma_f32_16x16x32_bf16 v[244:247], a[92:95], a[108:111], v[244:247]
v_mfma_f32_16x16x32_bf16 v[248:251], a[92:95], a[112:115], v[248:251]
v_mfma_f32_16x16x32_bf16 v[252:255], a[92:95], a[116:119], v[252:255]
.Lph2_A:
s_waitcnt vmcnt(0)
s_barrier
s_nop 7
s_lshl_b32 s16, s44, 4
s_add_u32 s16, s16, s45
s_lshl_b32 s16, s16, 2
s_add_u32 s16, s16, s46
s_lshr_b32 s17, s16, 8
s_mul_i32 s17, s17, 24
s_add_u32 s17, s17, 16
s_load_dwordx2 s[20:21], s[0:1], s17
s_and_b32 s16, s16, 255
s_lshl_b32 s16, s16, 13
v_lshlrev_b32 v13, 7, v0
v_add_u32 v13, s16, v13
s_waitcnt lgkmcnt(0)
global_load_dword v12, v13, s[20:21]

s_mov_b32 s18, 1069066811
s_mov_b32 s19, 1069066811
s_mov_b32 s22, 897988541
s_mov_b32 s23, 897988541

v_mov_b32 v40, 0x3f803f80
v_mov_b32 v41, 0x3f803f80
v_mov_b32 v42, 0x3f803f80
v_mov_b32 v43, 0x3f803f80
v_pk_mul_f32 v[44:45], v[72:73], s[18:19]
v_max_f32 v72, 0, v72
v_exp_f32_e64 v44, v44 clamp
v_exp_f32_e64 v45, v45 clamp
v_max_f32 v73, 0, v73
v_pk_add_f32 v[72:73], v[72:73], v[44:45]
v_pk_add_f32 v[72:73], v[72:73], s[22:23]
v_pk_mul_f32 v[46:47], v[74:75], s[18:19]
v_max_f32 v74, 0, v74
v_exp_f32_e64 v46, v46 clamp
v_exp_f32_e64 v47, v47 clamp
v_max_f32 v75, 0, v75
v_pk_add_f32 v[74:75], v[74:75], v[46:47]
v_pk_add_f32 v[74:75], v[74:75], s[22:23]
v_pk_mul_f32 v[48:49], v[96:97], s[18:19]
v_max_f32 v96, 0, v96
v_exp_f32_e64 v48, v48 clamp
v_exp_f32_e64 v49, v49 clamp
v_max_f32 v97, 0, v97
v_pk_add_f32 v[96:97], v[96:97], v[48:49]
v_pk_add_f32 v[96:97], v[96:97], s[22:23]
v_pk_mul_f32 v[50:51], v[98:99], s[18:19]
v_max_f32 v98, 0, v98
v_exp_f32_e64 v50, v50 clamp
v_exp_f32_e64 v51, v51 clamp
v_max_f32 v99, 0, v99
v_pk_add_f32 v[98:99], v[98:99], v[50:51]
v_pk_add_f32 v[98:99], v[98:99], s[22:23]
v_cvt_pk_bf16_f32 v72, v72, v73
v_cvt_pk_bf16_f32 v73, v74, v75
v_cvt_pk_bf16_f32 v74, v96, v97
v_cvt_pk_bf16_f32 v75, v98, v99
v_pk_mul_f32 v[44:45], v[76:77], s[18:19]
v_max_f32 v76, 0, v76
v_exp_f32_e64 v44, v44 clamp
v_exp_f32_e64 v45, v45 clamp
v_max_f32 v77, 0, v77
v_pk_add_f32 v[76:77], v[76:77], v[44:45]
v_pk_add_f32 v[76:77], v[76:77], s[22:23]
v_pk_mul_f32 v[46:47], v[78:79], s[18:19]
v_max_f32 v78, 0, v78
v_exp_f32_e64 v46, v46 clamp
v_exp_f32_e64 v47, v47 clamp
v_max_f32 v79, 0, v79
v_pk_add_f32 v[78:79], v[78:79], v[46:47]
v_pk_add_f32 v[78:79], v[78:79], s[22:23]
v_pk_mul_f32 v[48:49], v[100:101], s[18:19]
v_max_f32 v100, 0, v100
v_exp_f32_e64 v48, v48 clamp
v_exp_f32_e64 v49, v49 clamp
v_max_f32 v101, 0, v101
v_pk_add_f32 v[100:101], v[100:101], v[48:49]
v_pk_add_f32 v[100:101], v[100:101], s[22:23]
v_pk_mul_f32 v[50:51], v[102:103], s[18:19]
v_max_f32 v102, 0, v102
v_exp_f32_e64 v50, v50 clamp
v_exp_f32_e64 v51, v51 clamp
v_max_f32 v103, 0, v103
v_pk_add_f32 v[102:103], v[102:103], v[50:51]
v_pk_add_f32 v[102:103], v[102:103], s[22:23]
v_cvt_pk_bf16_f32 v76, v76, v77
v_cvt_pk_bf16_f32 v77, v78, v79
v_cvt_pk_bf16_f32 v78, v100, v101
v_cvt_pk_bf16_f32 v79, v102, v103
v_cvt_pk_bf16_f32 v80, v80, v81
v_cvt_pk_bf16_f32 v81, v82, v83
v_cvt_pk_bf16_f32 v82, v104, v105
v_cvt_pk_bf16_f32 v83, v106, v107
v_cvt_pk_bf16_f32 v84, v84, v85
v_cvt_pk_bf16_f32 v85, v86, v87
v_cvt_pk_bf16_f32 v86, v108, v109
v_cvt_pk_bf16_f32 v87, v110, v111
s_nop 1
v_mfma_f32_16x16x32_bf16 v[16:19], v[72:75], v[80:83], 0
v_mfma_f32_16x16x32_bf16 v[20:23], v[72:75], v[84:87], 0
v_mfma_f32_16x16x32_bf16 v[32:35], v[72:75], v[40:43], 0
v_mfma_f32_16x16x32_bf16 v[24:27], v[76:79], v[80:83], 0
v_mfma_f32_16x16x32_bf16 v[28:31], v[76:79], v[84:87], 0
v_mfma_f32_16x16x32_bf16 v[36:39], v[76:79], v[40:43], 0
v_pk_mul_f32 v[44:45], v[120:121], s[18:19]
v_max_f32 v120, 0, v120
v_exp_f32_e64 v44, v44 clamp
v_exp_f32_e64 v45, v45 clamp
v_max_f32 v121, 0, v121
v_pk_add_f32 v[120:121], v[120:121], v[44:45]
v_pk_add_f32 v[120:121], v[120:121], s[22:23]
v_pk_mul_f32 v[46:47], v[122:123], s[18:19]
v_max_f32 v122, 0, v122
v_exp_f32_e64 v46, v46 clamp
v_exp_f32_e64 v47, v47 clamp
v_max_f32 v123, 0, v123
v_pk_add_f32 v[122:123], v[122:123], v[46:47]
v_pk_add_f32 v[122:123], v[122:123], s[22:23]
v_pk_mul_f32 v[48:49], v[144:145], s[18:19]
v_max_f32 v144, 0, v144
v_exp_f32_e64 v48, v48 clamp
v_exp_f32_e64 v49, v49 clamp
v_max_f32 v145, 0, v145
v_pk_add_f32 v[144:145], v[144:145], v[48:49]
v_pk_add_f32 v[144:145], v[144:145], s[22:23]
v_pk_mul_f32 v[50:51], v[146:147], s[18:19]
v_max_f32 v146, 0, v146
v_exp_f32_e64 v50, v50 clamp
v_exp_f32_e64 v51, v51 clamp
v_max_f32 v147, 0, v147
v_pk_add_f32 v[146:147], v[146:147], v[50:51]
v_pk_add_f32 v[146:147], v[146:147], s[22:23]
v_cvt_pk_bf16_f32 v120, v120, v121
v_cvt_pk_bf16_f32 v121, v122, v123
v_cvt_pk_bf16_f32 v122, v144, v145
v_cvt_pk_bf16_f32 v123, v146, v147
v_pk_mul_f32 v[44:45], v[124:125], s[18:19]
v_max_f32 v124, 0, v124
v_exp_f32_e64 v44, v44 clamp
v_exp_f32_e64 v45, v45 clamp
v_max_f32 v125, 0, v125
v_pk_add_f32 v[124:125], v[124:125], v[44:45]
v_pk_add_f32 v[124:125], v[124:125], s[22:23]
v_pk_mul_f32 v[46:47], v[126:127], s[18:19]
v_max_f32 v126, 0, v126
v_exp_f32_e64 v46, v46 clamp
v_exp_f32_e64 v47, v47 clamp
v_max_f32 v127, 0, v127
v_pk_add_f32 v[126:127], v[126:127], v[46:47]
v_pk_add_f32 v[126:127], v[126:127], s[22:23]
v_pk_mul_f32 v[48:49], v[148:149], s[18:19]
v_max_f32 v148, 0, v148
v_exp_f32_e64 v48, v48 clamp
v_exp_f32_e64 v49, v49 clamp
v_max_f32 v149, 0, v149
v_pk_add_f32 v[148:149], v[148:149], v[48:49]
v_pk_add_f32 v[148:149], v[148:149], s[22:23]
v_pk_mul_f32 v[50:51], v[150:151], s[18:19]
v_max_f32 v150, 0, v150
v_exp_f32_e64 v50, v50 clamp
v_exp_f32_e64 v51, v51 clamp
v_max_f32 v151, 0, v151
v_pk_add_f32 v[150:151], v[150:151], v[50:51]
v_pk_add_f32 v[150:151], v[150:151], s[22:23]
v_cvt_pk_bf16_f32 v124, v124, v125
v_cvt_pk_bf16_f32 v125, v126, v127
v_cvt_pk_bf16_f32 v126, v148, v149
v_cvt_pk_bf16_f32 v127, v150, v151
v_cvt_pk_bf16_f32 v128, v128, v129
v_cvt_pk_bf16_f32 v129, v130, v131
v_cvt_pk_bf16_f32 v130, v152, v153
v_cvt_pk_bf16_f32 v131, v154, v155
v_cvt_pk_bf16_f32 v132, v132, v133
v_cvt_pk_bf16_f32 v133, v134, v135
v_cvt_pk_bf16_f32 v134, v156, v157
v_cvt_pk_bf16_f32 v135, v158, v159
s_nop 1
v_mfma_f32_16x16x32_bf16 v[16:19], v[120:123], v[128:131], v[16:19]
v_mfma_f32_16x16x32_bf16 v[20:23], v[120:123], v[132:135], v[20:23]
v_mfma_f32_16x16x32_bf16 v[32:35], v[120:123], v[40:43], v[32:35]
v_mfma_f32_16x16x32_bf16 v[24:27], v[124:127], v[128:131], v[24:27]
v_mfma_f32_16x16x32_bf16 v[28:31], v[124:127], v[132:135], v[28:31]
v_mfma_f32_16x16x32_bf16 v[36:39], v[124:127], v[40:43], v[36:39]
v_pk_mul_f32 v[44:45], v[168:169], s[18:19]
v_max_f32 v168, 0, v168
v_exp_f32_e64 v44, v44 clamp
v_exp_f32_e64 v45, v45 clamp
v_max_f32 v169, 0, v169
v_pk_add_f32 v[168:169], v[168:169], v[44:45]
v_pk_add_f32 v[168:169], v[168:169], s[22:23]
v_pk_mul_f32 v[46:47], v[170:171], s[18:19]
v_max_f32 v170, 0, v170
v_exp_f32_e64 v46, v46 clamp
v_exp_f32_e64 v47, v47 clamp
v_max_f32 v171, 0, v171
v_pk_add_f32 v[170:171], v[170:171], v[46:47]
v_pk_add_f32 v[170:171], v[170:171], s[22:23]
v_pk_mul_f32 v[48:49], v[192:193], s[18:19]
v_max_f32 v192, 0, v192
v_exp_f32_e64 v48, v48 clamp
v_exp_f32_e64 v49, v49 clamp
v_max_f32 v193, 0, v193
v_pk_add_f32 v[192:193], v[192:193], v[48:49]
v_pk_add_f32 v[192:193], v[192:193], s[22:23]
v_pk_mul_f32 v[50:51], v[194:195], s[18:19]
v_max_f32 v194, 0, v194
v_exp_f32_e64 v50, v50 clamp
v_exp_f32_e64 v51, v51 clamp
v_max_f32 v195, 0, v195
v_pk_add_f32 v[194:195], v[194:195], v[50:51]
v_pk_add_f32 v[194:195], v[194:195], s[22:23]
v_cvt_pk_bf16_f32 v168, v168, v169
v_cvt_pk_bf16_f32 v169, v170, v171
v_cvt_pk_bf16_f32 v170, v192, v193
v_cvt_pk_bf16_f32 v171, v194, v195
v_pk_mul_f32 v[44:45], v[172:173], s[18:19]
v_max_f32 v172, 0, v172
v_exp_f32_e64 v44, v44 clamp
v_exp_f32_e64 v45, v45 clamp
v_max_f32 v173, 0, v173
v_pk_add_f32 v[172:173], v[172:173], v[44:45]
v_pk_add_f32 v[172:173], v[172:173], s[22:23]
v_pk_mul_f32 v[46:47], v[174:175], s[18:19]
v_max_f32 v174, 0, v174
v_exp_f32_e64 v46, v46 clamp
v_exp_f32_e64 v47, v47 clamp
v_max_f32 v175, 0, v175
v_pk_add_f32 v[174:175], v[174:175], v[46:47]
v_pk_add_f32 v[174:175], v[174:175], s[22:23]
v_pk_mul_f32 v[48:49], v[196:197], s[18:19]
v_max_f32 v196, 0, v196
v_exp_f32_e64 v48, v48 clamp
v_exp_f32_e64 v49, v49 clamp
v_max_f32 v197, 0, v197
v_pk_add_f32 v[196:197], v[196:197], v[48:49]
v_pk_add_f32 v[196:197], v[196:197], s[22:23]
v_pk_mul_f32 v[50:51], v[198:199], s[18:19]
v_max_f32 v198, 0, v198
v_exp_f32_e64 v50, v50 clamp
v_exp_f32_e64 v51, v51 clamp
v_max_f32 v199, 0, v199
v_pk_add_f32 v[198:199], v[198:199], v[50:51]
v_pk_add_f32 v[198:199], v[198:199], s[22:23]
v_cvt_pk_bf16_f32 v172, v172, v173
v_cvt_pk_bf16_f32 v173, v174, v175
v_cvt_pk_bf16_f32 v174, v196, v197
v_cvt_pk_bf16_f32 v175, v198, v199
v_cvt_pk_bf16_f32 v176, v176, v177
v_cvt_pk_bf16_f32 v177, v178, v179
v_cvt_pk_bf16_f32 v178, v200, v201
v_cvt_pk_bf16_f32 v179, v202, v203
v_cvt_pk_bf16_f32 v180, v180, v181
v_cvt_pk_bf16_f32 v181, v182, v183
v_cvt_pk_bf16_f32 v182, v204, v205
v_cvt_pk_bf16_f32 v183, v206, v207
s_nop 1
v_mfma_f32_16x16x32_bf16 v[16:19], v[168:171], v[176:179], v[16:19]
v_mfma_f32_16x16x32_bf16 v[20:23], v[168:171], v[180:183], v[20:23]
v_mfma_f32_16x16x32_bf16 v[32:35], v[168:171], v[40:43], v[32:35]
v_mfma_f32_16x16x32_bf16 v[24:27], v[172:175], v[176:179], v[24:27]
v_mfma_f32_16x16x32_bf16 v[28:31], v[172:175], v[180:183], v[28:31]
v_mfma_f32_16x16x32_bf16 v[36:39], v[172:175], v[40:43], v[36:39]
v_pk_mul_f32 v[44:45], v[216:217], s[18:19]
v_max_f32 v216, 0, v216
v_exp_f32_e64 v44, v44 clamp
v_exp_f32_e64 v45, v45 clamp
v_max_f32 v217, 0, v217
v_pk_add_f32 v[216:217], v[216:217], v[44:45]
v_pk_add_f32 v[216:217], v[216:217], s[22:23]
v_pk_mul_f32 v[46:47], v[218:219], s[18:19]
v_max_f32 v218, 0, v218
v_exp_f32_e64 v46, v46 clamp
v_exp_f32_e64 v47, v47 clamp
v_max_f32 v219, 0, v219
v_pk_add_f32 v[218:219], v[218:219], v[46:47]
v_pk_add_f32 v[218:219], v[218:219], s[22:23]
v_pk_mul_f32 v[48:49], v[240:241], s[18:19]
v_max_f32 v240, 0, v240
v_exp_f32_e64 v48, v48 clamp
v_exp_f32_e64 v49, v49 clamp
v_max_f32 v241, 0, v241
v_pk_add_f32 v[240:241], v[240:241], v[48:49]
v_pk_add_f32 v[240:241], v[240:241], s[22:23]
v_pk_mul_f32 v[50:51], v[242:243], s[18:19]
v_max_f32 v242, 0, v242
v_exp_f32_e64 v50, v50 clamp
v_exp_f32_e64 v51, v51 clamp
v_max_f32 v243, 0, v243
v_pk_add_f32 v[242:243], v[242:243], v[50:51]
v_pk_add_f32 v[242:243], v[242:243], s[22:23]
v_cvt_pk_bf16_f32 v216, v216, v217
v_cvt_pk_bf16_f32 v217, v218, v219
v_cvt_pk_bf16_f32 v218, v240, v241
v_cvt_pk_bf16_f32 v219, v242, v243
v_pk_mul_f32 v[44:45], v[220:221], s[18:19]
v_max_f32 v220, 0, v220
v_exp_f32_e64 v44, v44 clamp
v_exp_f32_e64 v45, v45 clamp
v_max_f32 v221, 0, v221
v_pk_add_f32 v[220:221], v[220:221], v[44:45]
v_pk_add_f32 v[220:221], v[220:221], s[22:23]
v_pk_mul_f32 v[46:47], v[222:223], s[18:19]
v_max_f32 v222, 0, v222
v_exp_f32_e64 v46, v46 clamp
v_exp_f32_e64 v47, v47 clamp
v_max_f32 v223, 0, v223
v_pk_add_f32 v[222:223], v[222:223], v[46:47]
v_pk_add_f32 v[222:223], v[222:223], s[22:23]
v_pk_mul_f32 v[48:49], v[244:245], s[18:19]
v_max_f32 v244, 0, v244
v_exp_f32_e64 v48, v48 clamp
v_exp_f32_e64 v49, v49 clamp
v_max_f32 v245, 0, v245
v_pk_add_f32 v[244:245], v[244:245], v[48:49]
v_pk_add_f32 v[244:245], v[244:245], s[22:23]
v_pk_mul_f32 v[50:51], v[246:247], s[18:19]
v_max_f32 v246, 0, v246
v_exp_f32_e64 v50, v50 clamp
v_exp_f32_e64 v51, v51 clamp
v_max_f32 v247, 0, v247
v_pk_add_f32 v[246:247], v[246:247], v[50:51]
v_pk_add_f32 v[246:247], v[246:247], s[22:23]
v_cvt_pk_bf16_f32 v220, v220, v221
v_cvt_pk_bf16_f32 v221, v222, v223
v_cvt_pk_bf16_f32 v222, v244, v245
v_cvt_pk_bf16_f32 v223, v246, v247
v_cvt_pk_bf16_f32 v224, v224, v225
v_cvt_pk_bf16_f32 v225, v226, v227
v_cvt_pk_bf16_f32 v226, v248, v249
v_cvt_pk_bf16_f32 v227, v250, v251
v_cvt_pk_bf16_f32 v228, v228, v229
v_cvt_pk_bf16_f32 v229, v230, v231
v_cvt_pk_bf16_f32 v230, v252, v253
v_cvt_pk_bf16_f32 v231, v254, v255
s_nop 1
v_mfma_f32_16x16x32_bf16 v[16:19], v[216:219], v[224:227], v[16:19]
v_mfma_f32_16x16x32_bf16 v[20:23], v[216:219], v[228:231], v[20:23]
v_mfma_f32_16x16x32_bf16 v[32:35], v[216:219], v[40:43], v[32:35]
v_mfma_f32_16x16x32_bf16 v[24:27], v[220:223], v[224:227], v[24:27]
v_mfma_f32_16x16x32_bf16 v[28:31], v[220:223], v[228:231], v[28:31]
v_mfma_f32_16x16x32_bf16 v[36:39], v[220:223], v[40:43], v[36:39]
v_lshlrev_b32 v44, 4, v0
s_and_b32 s16, s46, 1
s_mul_i32 s16, s16, 6144
v_add_u32 v44, s16, v44
s_nop 7
s_cmp_lt_u32 s46, 2
s_cbranch_scc1 .LA_skipw

ds_write_b128 v44, v[16:19] offset:0
ds_write_b128 v44, v[20:23] offset:1024
ds_write_b128 v44, v[24:27] offset:2048
ds_write_b128 v44, v[28:31] offset:3072
ds_write_b128 v44, v[32:35] offset:4096
ds_write_b128 v44, v[36:39] offset:5120
.LA_skipw:
s_waitcnt lgkmcnt(0)
s_barrier
s_cmp_ge_u32 s46, 2
s_cbranch_scc1 .LA_skipr
ds_read_b128 a[0:3], v44 offset:0
ds_read_b128 a[4:7], v44 offset:1024
ds_read_b128 a[8:11], v44 offset:2048
ds_read_b128 a[12:15], v44 offset:3072
ds_read_b128 a[16:19], v44 offset:4096
ds_read_b128 a[20:23], v44 offset:5120
s_waitcnt lgkmcnt(0)
v_accvgpr_read_b32 v46, a0
v_add_f32 v16, v16, v46
v_accvgpr_read_b32 v47, a1
v_add_f32 v17, v17, v47
v_accvgpr_read_b32 v46, a2
v_add_f32 v18, v18, v46
v_accvgpr_read_b32 v47, a3
v_add_f32 v19, v19, v47
v_accvgpr_read_b32 v46, a4
v_add_f32 v20, v20, v46
v_accvgpr_read_b32 v47, a5
v_add_f32 v21, v21, v47
v_accvgpr_read_b32 v46, a6
v_add_f32 v22, v22, v46
v_accvgpr_read_b32 v47, a7
v_add_f32 v23, v23, v47
v_accvgpr_read_b32 v46, a8
v_add_f32 v24, v24, v46
v_accvgpr_read_b32 v47, a9
v_add_f32 v25, v25, v47
v_accvgpr_read_b32 v46, a10
v_add_f32 v26, v26, v46
v_accvgpr_read_b32 v47, a11
v_add_f32 v27, v27, v47
v_accvgpr_read_b32 v46, a12
v_add_f32 v28, v28, v46
v_accvgpr_read_b32 v47, a13
v_add_f32 v29, v29, v47
v_accvgpr_read_b32 v46, a14
v_add_f32 v30, v30, v46
v_accvgpr_read_b32 v47, a15
v_add_f32 v31, v31, v47
v_accvgpr_read_b32 v46, a16
v_add_f32 v32, v32, v46
v_accvgpr_read_b32 v47, a17
v_add_f32 v33, v33, v47
v_accvgpr_read_b32 v46, a18
v_add_f32 v34, v34, v46
v_accvgpr_read_b32 v47, a19
v_add_f32 v35, v35, v47
v_accvgpr_read_b32 v46, a20
v_add_f32 v36, v36, v46
v_accvgpr_read_b32 v47, a21
v_add_f32 v37, v37, v47
v_accvgpr_read_b32 v46, a22
v_add_f32 v38, v38, v46
v_accvgpr_read_b32 v47, a23
v_add_f32 v39, v39, v47
s_lshl_b32 s16, s45, 1
s_and_b32 s17, s46, 1
s_add_u32 s16, s16, s17
s_lshl_b32 s17, s44, 5
s_add_u32 s16, s16, s17
s_lshl_b32 s16, s16, 13
s_add_u32 s16, s16, 25165824
v_lshlrev_b32 v45, 4, v0

buffer_store_dwordx4 v[16:19], v45, s[12:15], s16 offen offset:0 sc1
buffer_store_dwordx4 v[20:23], v45, s[12:15], s16 offen offset:1024 sc1
buffer_store_dwordx4 v[24:27], v45, s[12:15], s16 offen offset:2048 sc1
buffer_store_dwordx4 v[28:31], v45, s[12:15], s16 offen offset:3072 sc1
v_lshrrev_b32 v46, 4, v0
v_lshlrev_b32 v46, 4, v46
v_and_b32 v47, 15, v0
v_cmp_eq_u32 vcc, 0, v47
s_add_u32 s16, s16, 4096
s_and_saveexec_b64 s[20:21], vcc
buffer_store_dwordx4 v[32:35], v46, s[12:15], s16 offen sc1
buffer_store_dwordx4 v[36:39], v46, s[12:15], s16 offen offset:64 sc1
s_mov_b64 exec, s[20:21]

.LA_skipr:
v_pk_mul_f32 v[44:45], v[64:65], s[18:19]
v_max_f32 v64, 0, v64
v_exp_f32_e64 v44, v44 clamp
v_exp_f32_e64 v45, v45 clamp
v_max_f32 v65, 0, v65
v_pk_add_f32 v[64:65], v[64:65], v[44:45]
v_pk_add_f32 v[64:65], v[64:65], s[22:23]
v_pk_mul_f32 v[46:47], v[66:67], s[18:19]
v_max_f32 v66, 0, v66
v_exp_f32_e64 v46, v46 clamp
v_exp_f32_e64 v47, v47 clamp
v_max_f32 v67, 0, v67
v_pk_add_f32 v[66:67], v[66:67], v[46:47]
v_pk_add_f32 v[66:67], v[66:67], s[22:23]
v_pk_mul_f32 v[48:49], v[68:69], s[18:19]
v_max_f32 v68, 0, v68
v_exp_f32_e64 v48, v48 clamp
v_exp_f32_e64 v49, v49 clamp
v_max_f32 v69, 0, v69
v_pk_add_f32 v[68:69], v[68:69], v[48:49]
v_pk_add_f32 v[68:69], v[68:69], s[22:23]
v_pk_mul_f32 v[50:51], v[70:71], s[18:19]
v_max_f32 v70, 0, v70
v_exp_f32_e64 v50, v50 clamp
v_exp_f32_e64 v51, v51 clamp
v_max_f32 v71, 0, v71
v_pk_add_f32 v[70:71], v[70:71], v[50:51]
v_pk_add_f32 v[70:71], v[70:71], s[22:23]
v_cvt_pk_bf16_f32 v64, v64, v65
v_cvt_pk_bf16_f32 v65, v66, v67
v_cvt_pk_bf16_f32 v66, v68, v69
v_cvt_pk_bf16_f32 v67, v70, v71
v_pk_mul_f32 v[44:45], v[88:89], s[18:19]
v_max_f32 v88, 0, v88
v_exp_f32_e64 v44, v44 clamp
v_exp_f32_e64 v45, v45 clamp
v_max_f32 v89, 0, v89
v_pk_add_f32 v[88:89], v[88:89], v[44:45]
v_pk_add_f32 v[88:89], v[88:89], s[22:23]
v_pk_mul_f32 v[46:47], v[90:91], s[18:19]
v_max_f32 v90, 0, v90
v_exp_f32_e64 v46, v46 clamp
v_exp_f32_e64 v47, v47 clamp
v_max_f32 v91, 0, v91
v_pk_add_f32 v[90:91], v[90:91], v[46:47]
v_pk_add_f32 v[90:91], v[90:91], s[22:23]
v_pk_mul_f32 v[48:49], v[92:93], s[18:19]
v_max_f32 v92, 0, v92
v_exp_f32_e64 v48, v48 clamp
v_exp_f32_e64 v49, v49 clamp
v_max_f32 v93, 0, v93
v_pk_add_f32 v[92:93], v[92:93], v[48:49]
v_pk_add_f32 v[92:93], v[92:93], s[22:23]
v_pk_mul_f32 v[50:51], v[94:95], s[18:19]
v_max_f32 v94, 0, v94
v_exp_f32_e64 v50, v50 clamp
v_exp_f32_e64 v51, v51 clamp
v_max_f32 v95, 0, v95
v_pk_add_f32 v[94:95], v[94:95], v[50:51]
v_pk_add_f32 v[94:95], v[94:95], s[22:23]
v_cvt_pk_bf16_f32 v88, v88, v89
v_cvt_pk_bf16_f32 v89, v90, v91
v_cvt_pk_bf16_f32 v90, v92, v93
v_cvt_pk_bf16_f32 v91, v94, v95
v_pk_mul_f32 v[44:45], v[112:113], s[18:19]
v_max_f32 v112, 0, v112
v_exp_f32_e64 v44, v44 clamp
v_exp_f32_e64 v45, v45 clamp
v_max_f32 v113, 0, v113
v_pk_add_f32 v[112:113], v[112:113], v[44:45]
v_pk_add_f32 v[112:113], v[112:113], s[22:23]
v_pk_mul_f32 v[46:47], v[114:115], s[18:19]
v_max_f32 v114, 0, v114
v_exp_f32_e64 v46, v46 clamp
v_exp_f32_e64 v47, v47 clamp
v_max_f32 v115, 0, v115
v_pk_add_f32 v[114:115], v[114:115], v[46:47]
v_pk_add_f32 v[114:115], v[114:115], s[22:23]
v_pk_mul_f32 v[48:49], v[116:117], s[18:19]
v_max_f32 v116, 0, v116
v_exp_f32_e64 v48, v48 clamp
v_exp_f32_e64 v49, v49 clamp
v_max_f32 v117, 0, v117
v_pk_add_f32 v[116:117], v[116:117], v[48:49]
v_pk_add_f32 v[116:117], v[116:117], s[22:23]
v_pk_mul_f32 v[50:51], v[118:119], s[18:19]
v_max_f32 v118, 0, v118
v_exp_f32_e64 v50, v50 clamp
v_exp_f32_e64 v51, v51 clamp
v_max_f32 v119, 0, v119
v_pk_add_f32 v[118:119], v[118:119], v[50:51]
v_pk_add_f32 v[118:119], v[118:119], s[22:23]
v_cvt_pk_bf16_f32 v112, v112, v113
v_cvt_pk_bf16_f32 v113, v114, v115
v_cvt_pk_bf16_f32 v114, v116, v117
v_cvt_pk_bf16_f32 v115, v118, v119
v_pk_mul_f32 v[44:45], v[136:137], s[18:19]
v_max_f32 v136, 0, v136
v_exp_f32_e64 v44, v44 clamp
v_exp_f32_e64 v45, v45 clamp
v_max_f32 v137, 0, v137
v_pk_add_f32 v[136:137], v[136:137], v[44:45]
v_pk_add_f32 v[136:137], v[136:137], s[22:23]
v_pk_mul_f32 v[46:47], v[138:139], s[18:19]
v_max_f32 v138, 0, v138
v_exp_f32_e64 v46, v46 clamp
v_exp_f32_e64 v47, v47 clamp
v_max_f32 v139, 0, v139
v_pk_add_f32 v[138:139], v[138:139], v[46:47]
v_pk_add_f32 v[138:139], v[138:139], s[22:23]
v_pk_mul_f32 v[48:49], v[140:141], s[18:19]
v_max_f32 v140, 0, v140
v_exp_f32_e64 v48, v48 clamp
v_exp_f32_e64 v49, v49 clamp
v_max_f32 v141, 0, v141
v_pk_add_f32 v[140:141], v[140:141], v[48:49]
v_pk_add_f32 v[140:141], v[140:141], s[22:23]
v_pk_mul_f32 v[50:51], v[142:143], s[18:19]
v_max_f32 v142, 0, v142
v_exp_f32_e64 v50, v50 clamp
v_exp_f32_e64 v51, v51 clamp
v_max_f32 v143, 0, v143
v_pk_add_f32 v[142:143], v[142:143], v[50:51]
v_pk_add_f32 v[142:143], v[142:143], s[22:23]
v_cvt_pk_bf16_f32 v136, v136, v137
v_cvt_pk_bf16_f32 v137, v138, v139
v_cvt_pk_bf16_f32 v138, v140, v141
v_cvt_pk_bf16_f32 v139, v142, v143
v_pk_mul_f32 v[44:45], v[160:161], s[18:19]
v_max_f32 v160, 0, v160
v_exp_f32_e64 v44, v44 clamp
v_exp_f32_e64 v45, v45 clamp
v_max_f32 v161, 0, v161
v_pk_add_f32 v[160:161], v[160:161], v[44:45]
v_pk_add_f32 v[160:161], v[160:161], s[22:23]
v_pk_mul_f32 v[46:47], v[162:163], s[18:19]
v_max_f32 v162, 0, v162
v_exp_f32_e64 v46, v46 clamp
v_exp_f32_e64 v47, v47 clamp
v_max_f32 v163, 0, v163
v_pk_add_f32 v[162:163], v[162:163], v[46:47]
v_pk_add_f32 v[162:163], v[162:163], s[22:23]
v_pk_mul_f32 v[48:49], v[164:165], s[18:19]
v_max_f32 v164, 0, v164
v_exp_f32_e64 v48, v48 clamp
v_exp_f32_e64 v49, v49 clamp
v_max_f32 v165, 0, v165
v_pk_add_f32 v[164:165], v[164:165], v[48:49]
v_pk_add_f32 v[164:165], v[164:165], s[22:23]
v_pk_mul_f32 v[50:51], v[166:167], s[18:19]
v_max_f32 v166, 0, v166
v_exp_f32_e64 v50, v50 clamp
v_exp_f32_e64 v51, v51 clamp
v_max_f32 v167, 0, v167
v_pk_add_f32 v[166:167], v[166:167], v[50:51]
v_pk_add_f32 v[166:167], v[166:167], s[22:23]
v_cvt_pk_bf16_f32 v160, v160, v161
v_cvt_pk_bf16_f32 v161, v162, v163
v_cvt_pk_bf16_f32 v162, v164, v165
v_cvt_pk_bf16_f32 v163, v166, v167
v_pk_mul_f32 v[44:45], v[184:185], s[18:19]
v_max_f32 v184, 0, v184
v_exp_f32_e64 v44, v44 clamp
v_exp_f32_e64 v45, v45 clamp
v_max_f32 v185, 0, v185
v_pk_add_f32 v[184:185], v[184:185], v[44:45]
v_pk_add_f32 v[184:185], v[184:185], s[22:23]
v_pk_mul_f32 v[46:47], v[186:187], s[18:19]
v_max_f32 v186, 0, v186
v_exp_f32_e64 v46, v46 clamp
v_exp_f32_e64 v47, v47 clamp
v_max_f32 v187, 0, v187
v_pk_add_f32 v[186:187], v[186:187], v[46:47]
v_pk_add_f32 v[186:187], v[186:187], s[22:23]
v_pk_mul_f32 v[48:49], v[188:189], s[18:19]
v_max_f32 v188, 0, v188
v_exp_f32_e64 v48, v48 clamp
v_exp_f32_e64 v49, v49 clamp
v_max_f32 v189, 0, v189
v_pk_add_f32 v[188:189], v[188:189], v[48:49]
v_pk_add_f32 v[188:189], v[188:189], s[22:23]
v_pk_mul_f32 v[50:51], v[190:191], s[18:19]
v_max_f32 v190, 0, v190
v_exp_f32_e64 v50, v50 clamp
v_exp_f32_e64 v51, v51 clamp
v_max_f32 v191, 0, v191
v_pk_add_f32 v[190:191], v[190:191], v[50:51]
v_pk_add_f32 v[190:191], v[190:191], s[22:23]
v_cvt_pk_bf16_f32 v184, v184, v185
v_cvt_pk_bf16_f32 v185, v186, v187
v_cvt_pk_bf16_f32 v186, v188, v189
v_cvt_pk_bf16_f32 v187, v190, v191
v_pk_mul_f32 v[44:45], v[208:209], s[18:19]
v_max_f32 v208, 0, v208
v_exp_f32_e64 v44, v44 clamp
v_exp_f32_e64 v45, v45 clamp
v_max_f32 v209, 0, v209
v_pk_add_f32 v[208:209], v[208:209], v[44:45]
v_pk_add_f32 v[208:209], v[208:209], s[22:23]
v_pk_mul_f32 v[46:47], v[210:211], s[18:19]
v_max_f32 v210, 0, v210
v_exp_f32_e64 v46, v46 clamp
v_exp_f32_e64 v47, v47 clamp
v_max_f32 v211, 0, v211
v_pk_add_f32 v[210:211], v[210:211], v[46:47]
v_pk_add_f32 v[210:211], v[210:211], s[22:23]
v_pk_mul_f32 v[48:49], v[212:213], s[18:19]
v_max_f32 v212, 0, v212
v_exp_f32_e64 v48, v48 clamp
v_exp_f32_e64 v49, v49 clamp
v_max_f32 v213, 0, v213
v_pk_add_f32 v[212:213], v[212:213], v[48:49]
v_pk_add_f32 v[212:213], v[212:213], s[22:23]
v_pk_mul_f32 v[50:51], v[214:215], s[18:19]
v_max_f32 v214, 0, v214
v_exp_f32_e64 v50, v50 clamp
v_exp_f32_e64 v51, v51 clamp
v_max_f32 v215, 0, v215
v_pk_add_f32 v[214:215], v[214:215], v[50:51]
v_pk_add_f32 v[214:215], v[214:215], s[22:23]
v_cvt_pk_bf16_f32 v208, v208, v209
v_cvt_pk_bf16_f32 v209, v210, v211
v_cvt_pk_bf16_f32 v210, v212, v213
v_cvt_pk_bf16_f32 v211, v214, v215
v_pk_mul_f32 v[44:45], v[232:233], s[18:19]
v_max_f32 v232, 0, v232
v_exp_f32_e64 v44, v44 clamp
v_exp_f32_e64 v45, v45 clamp
v_max_f32 v233, 0, v233
v_pk_add_f32 v[232:233], v[232:233], v[44:45]
v_pk_add_f32 v[232:233], v[232:233], s[22:23]
v_pk_mul_f32 v[46:47], v[234:235], s[18:19]
v_max_f32 v234, 0, v234
v_exp_f32_e64 v46, v46 clamp
v_exp_f32_e64 v47, v47 clamp
v_max_f32 v235, 0, v235
v_pk_add_f32 v[234:235], v[234:235], v[46:47]
v_pk_add_f32 v[234:235], v[234:235], s[22:23]
v_pk_mul_f32 v[48:49], v[236:237], s[18:19]
v_max_f32 v236, 0, v236
v_exp_f32_e64 v48, v48 clamp
v_exp_f32_e64 v49, v49 clamp
v_max_f32 v237, 0, v237
v_pk_add_f32 v[236:237], v[236:237], v[48:49]
v_pk_add_f32 v[236:237], v[236:237], s[22:23]
v_pk_mul_f32 v[50:51], v[238:239], s[18:19]
v_max_f32 v238, 0, v238
v_exp_f32_e64 v50, v50 clamp
v_exp_f32_e64 v51, v51 clamp
v_max_f32 v239, 0, v239
v_pk_add_f32 v[238:239], v[238:239], v[50:51]
v_pk_add_f32 v[238:239], v[238:239], s[22:23]
v_cvt_pk_bf16_f32 v232, v232, v233
v_cvt_pk_bf16_f32 v233, v234, v235
v_cvt_pk_bf16_f32 v234, v236, v237
v_cvt_pk_bf16_f32 v235, v238, v239
s_waitcnt vmcnt(0)
s_barrier
s_lshl_b32 s20, s45, 2
s_add_u32 s20, s20, 128
s_mov_b32 s21, 1
s_cmp_lg_u32 s46, 0
s_cbranch_scc1 .Lsig_A_end
s_add_u32 s30, s30, 1
v_mov_b32 v60, s30
v_mov_b32 v61, s21
s_mov_b64 exec, 1
buffer_store_dword v60, off, s[12:15], s32 sc1
buffer_atomic_add v61, off, s[60:63], s20
s_mov_b64 exec, -1
.Lsig_A_end:
s_cmp_lg_u32 s46, 0
s_cbranch_scc1 .Lpoll_A_end
s_mov_b32 s17, 0
.Lpoll_A:
buffer_load_dword v60, v63, s[12:15], 0 offen sc1
s_waitcnt vmcnt(0)
v_cmp_ne_u32 vcc, v60, v62
s_nop 1
s_and_b32 s16, vcc_lo, 0xff
s_cmp_eq_u32 s16, 0xff
s_cbranch_scc1 .Lpoll_A_end
s_add_u32 s17, s17, 1
s_and_b32 s16, s17, 15
s_cmp_lg_u32 s16, 0
s_cbranch_scc1 .Lpoll_A
buffer_load_dword v60, off, s[60:63], s20 sc1
s_waitcnt vmcnt(0)
v_readfirstlane_b32 s16, v60
s_nop 0
s_cmp_ge_u32 s16, 8
s_cbranch_scc1 .Lpoll_A_end
s_cmp_lt_u32 s17, 200000
s_cbranch_scc1 .Lpoll_A
.Lpoll_A_end:
s_barrier
s_lshl_b32 s16, s45, 1
s_and_b32 s17, s46, 1
s_add_u32 s16, s16, s17
s_lshr_b32 s17, s46, 1
s_lshl_b32 s17, s17, 7
s_add_u32 s16, s16, s17
s_lshl_b32 s16, s16, 13
s_add_u32 s16, s16, 25165824
v_lshlrev_b32 v45, 4, v0
v_lshrrev_b32 v46, 4, v0
v_lshlrev_b32 v46, 4, v46
v_add_u32 v46, 4096, v46

buffer_load_dwordx4 a[0:3], v45, s[12:15], s16 offen offset:0 sc1
buffer_load_dwordx4 a[4:7], v45, s[12:15], s16 offen offset:1024 sc1
buffer_load_dwordx4 a[8:11], v45, s[12:15], s16 offen offset:2048 sc1
buffer_load_dwordx4 a[12:15], v45, s[12:15], s16 offen offset:3072 sc1
buffer_load_dwordx4 a[16:19], v46, s[12:15], s16 offen offset:0 sc1
buffer_load_dwordx4 a[20:23], v46, s[12:15], s16 offen offset:64 sc1
s_add_u32 s16, s16, 262144
buffer_load_dwordx4 a[24:27], v45, s[12:15], s16 offen offset:0 sc1
buffer_load_dwordx4 a[28:31], v45, s[12:15], s16 offen offset:1024 sc1
buffer_load_dwordx4 a[32:35], v45, s[12:15], s16 offen offset:2048 sc1
buffer_load_dwordx4 a[36:39], v45, s[12:15], s16 offen offset:3072 sc1
buffer_load_dwordx4 a[40:43], v46, s[12:15], s16 offen offset:0 sc1
buffer_load_dwordx4 a[44:47], v46, s[12:15], s16 offen offset:64 sc1
s_add_u32 s16, s16, 262144
buffer_load_dwordx4 a[48:51], v45, s[12:15], s16 offen offset:0 sc1
buffer_load_dwordx4 a[52:55], v45, s[12:15], s16 offen offset:1024 sc1
buffer_load_dwordx4 a[56:59], v45, s[12:15], s16 offen offset:2048 sc1
buffer_load_dwordx4 a[60:63], v45, s[12:15], s16 offen offset:3072 sc1
buffer_load_dwordx4 a[64:67], v46, s[12:15], s16 offen offset:0 sc1
buffer_load_dwordx4 a[68:71], v46, s[12:15], s16 offen offset:64 sc1
s_add_u32 s16, s16, 262144
buffer_load_dwordx4 a[72:75], v45, s[12:15], s16 offen offset:0 sc1
buffer_load_dwordx4 a[76:79], v45, s[12:15], s16 offen offset:1024 sc1
buffer_load_dwordx4 a[80:83], v45, s[12:15], s16 offen offset:2048 sc1
buffer_load_dwordx4 a[84:87], v45, s[12:15], s16 offen offset:3072 sc1
buffer_load_dwordx4 a[88:91], v46, s[12:15], s16 offen offset:0 sc1
buffer_load_dwordx4 a[92:95], v46, s[12:15], s16 offen offset:64 sc1
s_waitcnt vmcnt(0)
v_accvgpr_read_b32 v16, a0
v_accvgpr_read_b32 v46, a24
v_accvgpr_read_b32 v47, a48
v_accvgpr_read_b32 v48, a72
v_add_f32 v16, v16, v46
v_add_f32 v47, v47, v48
v_add_f32 v16, v16, v47
v_accvgpr_read_b32 v17, a1
v_accvgpr_read_b32 v46, a25
v_accvgpr_read_b32 v47, a49
v_accvgpr_read_b32 v48, a73
v_add_f32 v17, v17, v46
v_add_f32 v47, v47, v48
v_add_f32 v17, v17, v47
v_accvgpr_read_b32 v18, a2
v_accvgpr_read_b32 v46, a26
v_accvgpr_read_b32 v47, a50
v_accvgpr_read_b32 v48, a74
v_add_f32 v18, v18, v46
v_add_f32 v47, v47, v48
v_add_f32 v18, v18, v47
v_accvgpr_read_b32 v19, a3
v_accvgpr_read_b32 v46, a27
v_accvgpr_read_b32 v47, a51
v_accvgpr_read_b32 v48, a75
v_add_f32 v19, v19, v46
v_add_f32 v47, v47, v48
v_add_f32 v19, v19, v47
v_accvgpr_read_b32 v20, a4
v_accvgpr_read_b32 v46, a28
v_accvgpr_read_b32 v47, a52
v_accvgpr_read_b32 v48, a76
v_add_f32 v20, v20, v46
v_add_f32 v47, v47, v48
v_add_f32 v20, v20, v47
v_accvgpr_read_b32 v21, a5
v_accvgpr_read_b32 v46, a29
v_accvgpr_read_b32 v47, a53
v_accvgpr_read_b32 v48, a77
v_add_f32 v21, v21, v46
v_add_f32 v47, v47, v48
v_add_f32 v21, v21, v47
v_accvgpr_read_b32 v22, a6
v_accvgpr_read_b32 v46, a30
v_accvgpr_read_b32 v47, a54
v_accvgpr_read_b32 v48, a78
v_add_f32 v22, v22, v46
v_add_f32 v47, v47, v48
v_add_f32 v22, v22, v47
v_accvgpr_read_b32 v23, a7
v_accvgpr_read_b32 v46, a31
v_accvgpr_read_b32 v47, a55
v_accvgpr_read_b32 v48, a79
v_add_f32 v23, v23, v46
v_add_f32 v47, v47, v48
v_add_f32 v23, v23, v47
v_accvgpr_read_b32 v24, a8
v_accvgpr_read_b32 v46, a32
v_accvgpr_read_b32 v47, a56
v_accvgpr_read_b32 v48, a80
v_add_f32 v24, v24, v46
v_add_f32 v47, v47, v48
v_add_f32 v24, v24, v47
v_accvgpr_read_b32 v25, a9
v_accvgpr_read_b32 v46, a33
v_accvgpr_read_b32 v47, a57
v_accvgpr_read_b32 v48, a81
v_add_f32 v25, v25, v46
v_add_f32 v47, v47, v48
v_add_f32 v25, v25, v47
v_accvgpr_read_b32 v26, a10
v_accvgpr_read_b32 v46, a34
v_accvgpr_read_b32 v47, a58
v_accvgpr_read_b32 v48, a82
v_add_f32 v26, v26, v46
v_add_f32 v47, v47, v48
v_add_f32 v26, v26, v47
v_accvgpr_read_b32 v27, a11
v_accvgpr_read_b32 v46, a35
v_accvgpr_read_b32 v47, a59
v_accvgpr_read_b32 v48, a83
v_add_f32 v27, v27, v46
v_add_f32 v47, v47, v48
v_add_f32 v27, v27, v47
v_accvgpr_read_b32 v28, a12
v_accvgpr_read_b32 v46, a36
v_accvgpr_read_b32 v47, a60
v_accvgpr_read_b32 v48, a84
v_add_f32 v28, v28, v46
v_add_f32 v47, v47, v48
v_add_f32 v28, v28, v47
v_accvgpr_read_b32 v29, a13
v_accvgpr_read_b32 v46, a37
v_accvgpr_read_b32 v47, a61
v_accvgpr_read_b32 v48, a85
v_add_f32 v29, v29, v46
v_add_f32 v47, v47, v48
v_add_f32 v29, v29, v47
v_accvgpr_read_b32 v30, a14
v_accvgpr_read_b32 v46, a38
v_accvgpr_read_b32 v47, a62
v_accvgpr_read_b32 v48, a86
v_add_f32 v30, v30, v46
v_add_f32 v47, v47, v48
v_add_f32 v30, v30, v47
v_accvgpr_read_b32 v31, a15
v_accvgpr_read_b32 v46, a39
v_accvgpr_read_b32 v47, a63
v_accvgpr_read_b32 v48, a87
v_add_f32 v31, v31, v46
v_add_f32 v47, v47, v48
v_add_f32 v31, v31, v47
v_accvgpr_read_b32 v32, a16
v_accvgpr_read_b32 v46, a40
v_accvgpr_read_b32 v47, a64
v_accvgpr_read_b32 v48, a88
v_add_f32 v32, v32, v46
v_add_f32 v47, v47, v48
v_add_f32 v32, v32, v47
v_accvgpr_read_b32 v33, a17
v_accvgpr_read_b32 v46, a41
v_accvgpr_read_b32 v47, a65
v_accvgpr_read_b32 v48, a89
v_add_f32 v33, v33, v46
v_add_f32 v47, v47, v48
v_add_f32 v33, v33, v47
v_accvgpr_read_b32 v34, a18
v_accvgpr_read_b32 v46, a42
v_accvgpr_read_b32 v47, a66
v_accvgpr_read_b32 v48, a90
v_add_f32 v34, v34, v46
v_add_f32 v47, v47, v48
v_add_f32 v34, v34, v47
v_accvgpr_read_b32 v35, a19
v_accvgpr_read_b32 v46, a43
v_accvgpr_read_b32 v47, a67
v_accvgpr_read_b32 v48, a91
v_add_f32 v35, v35, v46
v_add_f32 v47, v47, v48
v_add_f32 v35, v35, v47
v_accvgpr_read_b32 v36, a20
v_accvgpr_read_b32 v46, a44
v_accvgpr_read_b32 v47, a68
v_accvgpr_read_b32 v48, a92
v_add_f32 v36, v36, v46
v_add_f32 v47, v47, v48
v_add_f32 v36, v36, v47
v_accvgpr_read_b32 v37, a21
v_accvgpr_read_b32 v46, a45
v_accvgpr_read_b32 v47, a69
v_accvgpr_read_b32 v48, a93
v_add_f32 v37, v37, v46
v_add_f32 v47, v47, v48
v_add_f32 v37, v37, v47
v_accvgpr_read_b32 v38, a22
v_accvgpr_read_b32 v46, a46
v_accvgpr_read_b32 v47, a70
v_accvgpr_read_b32 v48, a94
v_add_f32 v38, v38, v46
v_add_f32 v47, v47, v48
v_add_f32 v38, v38, v47
v_accvgpr_read_b32 v39, a23
v_accvgpr_read_b32 v46, a47
v_accvgpr_read_b32 v47, a71
v_accvgpr_read_b32 v48, a95
v_add_f32 v39, v39, v46
v_add_f32 v47, v47, v48
v_add_f32 v39, v39, v47
v_lshlrev_b32 v44, 4, v0
s_mul_i32 s16, s46, 6144
v_add_u32 v45, s16, v44
s_xor_b32 s17, s46, 2
s_mul_i32 s16, s17, 6144
v_add_u32 v44, s16, v44

ds_write_b128 v45, v[16:19] offset:16384
ds_write_b128 v45, v[20:23] offset:17408
ds_write_b128 v45, v[24:27] offset:18432
ds_write_b128 v45, v[28:31] offset:19456
ds_write_b128 v45, v[32:35] offset:20480
ds_write_b128 v45, v[36:39] offset:21504
s_waitcnt lgkmcnt(0)
s_barrier
ds_read_b128 a[0:3], v44 offset:16384
ds_read_b128 a[4:7], v44 offset:17408
ds_read_b128 a[8:11], v44 offset:18432
ds_read_b128 a[12:15], v44 offset:19456
ds_read_b128 a[16:19], v44 offset:20480
ds_read_b128 a[20:23], v44 offset:21504
s_waitcnt lgkmcnt(0)
v_accvgpr_read_b32 v46, a0
v_add_f32 v16, v16, v46
v_accvgpr_read_b32 v47, a1
v_add_f32 v17, v17, v47
v_accvgpr_read_b32 v46, a2
v_add_f32 v18, v18, v46
v_accvgpr_read_b32 v47, a3
v_add_f32 v19, v19, v47
v_accvgpr_read_b32 v46, a4
v_add_f32 v20, v20, v46
v_accvgpr_read_b32 v47, a5
v_add_f32 v21, v21, v47
v_accvgpr_read_b32 v46, a6
v_add_f32 v22, v22, v46
v_accvgpr_read_b32 v47, a7
v_add_f32 v23, v23, v47
v_accvgpr_read_b32 v46, a8
v_add_f32 v24, v24, v46
v_accvgpr_read_b32 v47, a9
v_add_f32 v25, v25, v47
v_accvgpr_read_b32 v46, a10
v_add_f32 v26, v26, v46
v_accvgpr_read_b32 v47, a11
v_add_f32 v27, v27, v47
v_accvgpr_read_b32 v46, a12
v_add_f32 v28, v28, v46
v_accvgpr_read_b32 v47, a13
v_add_f32 v29, v29, v47
v_accvgpr_read_b32 v46, a14
v_add_f32 v30, v30, v46
v_accvgpr_read_b32 v47, a15
v_add_f32 v31, v31, v47
v_accvgpr_read_b32 v46, a16
v_add_f32 v32, v32, v46
v_accvgpr_read_b32 v47, a17
v_add_f32 v33, v33, v47
v_accvgpr_read_b32 v46, a18
v_add_f32 v34, v34, v46
v_accvgpr_read_b32 v47, a19
v_add_f32 v35, v35, v47
v_accvgpr_read_b32 v46, a20
v_add_f32 v36, v36, v46
v_accvgpr_read_b32 v47, a21
v_add_f32 v37, v37, v47
v_accvgpr_read_b32 v46, a22
v_add_f32 v38, v38, v46
v_accvgpr_read_b32 v47, a23
v_add_f32 v39, v39, v47
v_cvt_pk_bf16_f32 v48, v16, v17
v_cvt_pk_bf16_f32 v49, v18, v19
v_cvt_pk_bf16_f32 v50, v24, v25
v_cvt_pk_bf16_f32 v51, v26, v27
v_cvt_pk_bf16_f32 v52, v20, v21
v_cvt_pk_bf16_f32 v53, v22, v23
v_cvt_pk_bf16_f32 v54, v28, v29
v_cvt_pk_bf16_f32 v55, v30, v31
v_cvt_pk_bf16_f32 v56, v32, v33
v_cvt_pk_bf16_f32 v57, v34, v35
v_cvt_pk_bf16_f32 v58, v36, v37
v_cvt_pk_bf16_f32 v59, v38, v39
s_nop 1
v_mfma_f32_16x16x32_bf16 v[72:75], v[48:51], v[64:67], 0
v_mfma_f32_16x16x32_bf16 v[76:79], v[52:55], v[64:67], 0
v_mfma_f32_16x16x32_bf16 v[80:83], v[56:59], v[64:67], 0
v_mfma_f32_16x16x32_bf16 v[96:99], v[48:51], v[88:91], 0
v_mfma_f32_16x16x32_bf16 v[100:103], v[52:55], v[88:91], 0
v_mfma_f32_16x16x32_bf16 v[104:107], v[56:59], v[88:91], 0
v_mfma_f32_16x16x32_bf16 v[120:123], v[48:51], v[112:115], 0
v_mfma_f32_16x16x32_bf16 v[124:127], v[52:55], v[112:115], 0
v_mfma_f32_16x16x32_bf16 v[128:131], v[56:59], v[112:115], 0
v_mfma_f32_16x16x32_bf16 v[144:147], v[48:51], v[136:139], 0
v_mfma_f32_16x16x32_bf16 v[148:151], v[52:55], v[136:139], 0
v_mfma_f32_16x16x32_bf16 v[152:155], v[56:59], v[136:139], 0
v_mfma_f32_16x16x32_bf16 v[168:171], v[48:51], v[160:163], 0
v_mfma_f32_16x16x32_bf16 v[172:175], v[52:55], v[160:163], 0
v_mfma_f32_16x16x32_bf16 v[176:179], v[56:59], v[160:163], 0
v_mfma_f32_16x16x32_bf16 v[192:195], v[48:51], v[184:187], 0
v_mfma_f32_16x16x32_bf16 v[196:199], v[52:55], v[184:187], 0
v_mfma_f32_16x16x32_bf16 v[200:203], v[56:59], v[184:187], 0
v_mfma_f32_16x16x32_bf16 v[216:219], v[48:51], v[208:211], 0
v_mfma_f32_16x16x32_bf16 v[220:223], v[52:55], v[208:211], 0
v_mfma_f32_16x16x32_bf16 v[224:227], v[56:59], v[208:211], 0
v_mfma_f32_16x16x32_bf16 v[240:243], v[48:51], v[232:235], 0
v_mfma_f32_16x16x32_bf16 v[244:247], v[52:55], v[232:235], 0
v_mfma_f32_16x16x32_bf16 v[248:251], v[56:59], v[232:235], 0
s_lshl_b32 s16, s44, 4
s_lshr_b32 s17, s46, 1
s_lshl_b32 s17, s17, 3
s_add_u32 s16, s16, s17
s_lshl_b32 s16, s16, 5
s_lshl_b32 s17, s45, 1
s_add_u32 s16, s16, s17
s_and_b32 s17, s46, 1
s_add_u32 s16, s16, s17
s_lshl_b32 s16, s16, 10
s_add_u32 s16, s16, 33554432
v_lshlrev_b32 v45, 4, v0

v_add_f32 v81, 897988541, v80
v_rcp_f32 v81, v81
s_nop 0
v_mul_f32 v72, v72, v81
v_mul_f32 v73, v73, v81
v_mul_f32 v74, v74, v81
v_mul_f32 v75, v75, v81
v_mul_f32 v76, v76, v81
v_mul_f32 v77, v77, v81
v_mul_f32 v78, v78, v81
v_mul_f32 v79, v79, v81
v_cvt_pk_bf16_f32 v84, v72, v73
v_cvt_pk_bf16_f32 v85, v74, v75
v_cvt_pk_bf16_f32 v86, v76, v77
v_cvt_pk_bf16_f32 v87, v78, v79
buffer_store_dwordx4 v[84:87], v45, s[12:15], s16 offen sc1
s_add_u32 s16, s16, 32768
v_add_f32 v105, 897988541, v104
v_rcp_f32 v105, v105
s_nop 0
v_mul_f32 v96, v96, v105
v_mul_f32 v97, v97, v105
v_mul_f32 v98, v98, v105
v_mul_f32 v99, v99, v105
v_mul_f32 v100, v100, v105
v_mul_f32 v101, v101, v105
v_mul_f32 v102, v102, v105
v_mul_f32 v103, v103, v105
v_cvt_pk_bf16_f32 v108, v96, v97
v_cvt_pk_bf16_f32 v109, v98, v99
v_cvt_pk_bf16_f32 v110, v100, v101
v_cvt_pk_bf16_f32 v111, v102, v103
buffer_store_dwordx4 v[108:111], v45, s[12:15], s16 offen sc1
s_add_u32 s16, s16, 32768
v_add_f32 v129, 897988541, v128
v_rcp_f32 v129, v129
s_nop 0
v_mul_f32 v120, v120, v129
v_mul_f32 v121, v121, v129
v_mul_f32 v122, v122, v129
v_mul_f32 v123, v123, v129
v_mul_f32 v124, v124, v129
v_mul_f32 v125, v125, v129
v_mul_f32 v126, v126, v129
v_mul_f32 v127, v127, v129
v_cvt_pk_bf16_f32 v132, v120, v121
v_cvt_pk_bf16_f32 v133, v122, v123
v_cvt_pk_bf16_f32 v134, v124, v125
v_cvt_pk_bf16_f32 v135, v126, v127
buffer_store_dwordx4 v[132:135], v45, s[12:15], s16 offen sc1
s_add_u32 s16, s16, 32768
v_add_f32 v153, 897988541, v152
v_rcp_f32 v153, v153
s_nop 0
v_mul_f32 v144, v144, v153
v_mul_f32 v145, v145, v153
v_mul_f32 v146, v146, v153
v_mul_f32 v147, v147, v153
v_mul_f32 v148, v148, v153
v_mul_f32 v149, v149, v153
v_mul_f32 v150, v150, v153
v_mul_f32 v151, v151, v153
v_cvt_pk_bf16_f32 v156, v144, v145
v_cvt_pk_bf16_f32 v157, v146, v147
v_cvt_pk_bf16_f32 v158, v148, v149
v_cvt_pk_bf16_f32 v159, v150, v151
buffer_store_dwordx4 v[156:159], v45, s[12:15], s16 offen sc1
s_add_u32 s16, s16, 32768
v_add_f32 v177, 897988541, v176
v_rcp_f32 v177, v177
s_nop 0
v_mul_f32 v168, v168, v177
v_mul_f32 v169, v169, v177
v_mul_f32 v170, v170, v177
v_mul_f32 v171, v171, v177
v_mul_f32 v172, v172, v177
v_mul_f32 v173, v173, v177
v_mul_f32 v174, v174, v177
v_mul_f32 v175, v175, v177
v_cvt_pk_bf16_f32 v180, v168, v169
v_cvt_pk_bf16_f32 v181, v170, v171
v_cvt_pk_bf16_f32 v182, v172, v173
v_cvt_pk_bf16_f32 v183, v174, v175
buffer_store_dwordx4 v[180:183], v45, s[12:15], s16 offen sc1
s_add_u32 s16, s16, 32768
v_add_f32 v201, 897988541, v200
v_rcp_f32 v201, v201
s_nop 0
v_mul_f32 v192, v192, v201
v_mul_f32 v193, v193, v201
v_mul_f32 v194, v194, v201
v_mul_f32 v195, v195, v201
v_mul_f32 v196, v196, v201
v_mul_f32 v197, v197, v201
v_mul_f32 v198, v198, v201
v_mul_f32 v199, v199, v201
v_cvt_pk_bf16_f32 v204, v192, v193
v_cvt_pk_bf16_f32 v205, v194, v195
v_cvt_pk_bf16_f32 v206, v196, v197
v_cvt_pk_bf16_f32 v207, v198, v199
buffer_store_dwordx4 v[204:207], v45, s[12:15], s16 offen sc1
s_add_u32 s16, s16, 32768
v_add_f32 v225, 897988541, v224
v_rcp_f32 v225, v225
s_nop 0
v_mul_f32 v216, v216, v225
v_mul_f32 v217, v217, v225
v_mul_f32 v218, v218, v225
v_mul_f32 v219, v219, v225
v_mul_f32 v220, v220, v225
v_mul_f32 v221, v221, v225
v_mul_f32 v222, v222, v225
v_mul_f32 v223, v223, v225
v_cvt_pk_bf16_f32 v228, v216, v217
v_cvt_pk_bf16_f32 v229, v218, v219
v_cvt_pk_bf16_f32 v230, v220, v221
v_cvt_pk_bf16_f32 v231, v222, v223
buffer_store_dwordx4 v[228:231], v45, s[12:15], s16 offen sc1
s_add_u32 s16, s16, 32768
v_add_f32 v249, 897988541, v248
v_rcp_f32 v249, v249
s_nop 0
v_mul_f32 v240, v240, v249
v_mul_f32 v241, v241, v249
v_mul_f32 v242, v242, v249
v_mul_f32 v243, v243, v249
v_mul_f32 v244, v244, v249
v_mul_f32 v245, v245, v249
v_mul_f32 v246, v246, v249
v_mul_f32 v247, v247, v249
v_cvt_pk_bf16_f32 v252, v240, v241
v_cvt_pk_bf16_f32 v253, v242, v243
v_cvt_pk_bf16_f32 v254, v244, v245
v_cvt_pk_bf16_f32 v255, v246, v247
buffer_store_dwordx4 v[252:255], v45, s[12:15], s16 offen sc1
s_branch .Lph3
.Lph2_B:
s_nop 7
s_nop 1
v_permlane16_swap_b32 v220, v222
v_permlane16_swap_b32 v221, v223
buffer_store_dwordx4 v[220:223], v2, s[24:27], s5 offen offset:256 sc1
ds_write_b128 v24, v[220:223] offset:2304
v_cvt_pk_bf16_f32 v196, v120, v121
v_cvt_pk_bf16_f32 v197, v122, v123
v_cvt_pk_bf16_f32 v198, v124, v125
v_cvt_pk_bf16_f32 v199, v126, v127
v_permlane32_swap_b32 v228, v230
v_permlane32_swap_b32 v229, v231
buffer_store_dwordx4 v[228:231], v3, s[24:27], s5 offen offset:1024 sc1
ds_write_b128 v25, v[228:231] offset:3072
v_cvt_pk_bf16_f32 v204, v128, v129
v_cvt_pk_bf16_f32 v205, v130, v131
v_cvt_pk_bf16_f32 v206, v132, v133
v_cvt_pk_bf16_f32 v207, v134, v135
v_permlane16_swap_b32 v196, v198
v_permlane16_swap_b32 v197, v199
buffer_store_dwordx4 v[196:199], v2, s[24:27], s5 offen offset:0 sc1
ds_write_b128 v24, v[196:199] offset:2048
v_pk_mul_f32 v[232:233], v[232:233], s[22:23]
v_pk_mul_f32 v[234:235], v[234:235], s[22:23]
v_pk_mul_f32 v[236:237], v[236:237], s[22:23]
v_pk_mul_f32 v[238:239], v[238:239], s[22:23]
v_cvt_pk_bf16_f32 v232, v232, v233
v_cvt_pk_bf16_f32 v233, v234, v235
v_cvt_pk_bf16_f32 v234, v236, v237
v_cvt_pk_bf16_f32 v235, v238, v239
v_permlane32_swap_b32 v204, v206
v_permlane32_swap_b32 v205, v207
buffer_store_dwordx4 v[204:207], v3, s[24:27], s5 offen offset:0 sc1
ds_write_b128 v25, v[204:207] offset:2048
v_pk_mul_f32 v[208:209], v[208:209], s[22:23]
v_pk_mul_f32 v[210:211], v[210:211], s[22:23]
v_pk_mul_f32 v[212:213], v[212:213], s[22:23]
v_pk_mul_f32 v[214:215], v[214:215], s[22:23]
v_cvt_pk_bf16_f32 v208, v208, v209
v_cvt_pk_bf16_f32 v209, v210, v211
v_cvt_pk_bf16_f32 v210, v212, v213
v_cvt_pk_bf16_f32 v211, v214, v215
v_permlane16_swap_b32 v232, v234
v_permlane16_swap_b32 v233, v235
ds_write_b128 v26, v[232:235] offset:6400
v_cvt_pk_bf16_f32 v232, v96, v97
v_cvt_pk_bf16_f32 v233, v98, v99
v_cvt_pk_bf16_f32 v234, v100, v101
v_cvt_pk_bf16_f32 v235, v102, v103
v_permlane16_swap_b32 v208, v210
v_permlane16_swap_b32 v209, v211
ds_write_b128 v26, v[208:211] offset:6144
v_cvt_pk_bf16_f32 v236, v104, v105
v_cvt_pk_bf16_f32 v237, v106, v107
v_cvt_pk_bf16_f32 v238, v108, v109
v_cvt_pk_bf16_f32 v239, v110, v111
v_permlane16_swap_b32 v232, v234
v_permlane16_swap_b32 v233, v235
buffer_store_dwordx4 v[232:235], v2, s[24:27], s4 offen offset:256 sc1
ds_write_b128 v24, v[232:235] offset:256
v_cvt_pk_bf16_f32 v208, v72, v73
v_cvt_pk_bf16_f32 v209, v74, v75
v_cvt_pk_bf16_f32 v210, v76, v77
v_cvt_pk_bf16_f32 v211, v78, v79
v_permlane32_swap_b32 v236, v238
v_permlane32_swap_b32 v237, v239
buffer_store_dwordx4 v[236:239], v3, s[24:27], s4 offen offset:1024 sc1
ds_write_b128 v25, v[236:239] offset:1024
v_cvt_pk_bf16_f32 v212, v80, v81
v_cvt_pk_bf16_f32 v213, v82, v83
v_cvt_pk_bf16_f32 v214, v84, v85
v_cvt_pk_bf16_f32 v215, v86, v87
v_permlane16_swap_b32 v208, v210
v_permlane16_swap_b32 v209, v211
buffer_store_dwordx4 v[208:211], v2, s[24:27], s4 offen offset:0 sc1
ds_write_b128 v24, v[208:211] offset:0
v_pk_mul_f32 v[184:185], v[184:185], s[22:23]
v_pk_mul_f32 v[186:187], v[186:187], s[22:23]
v_pk_mul_f32 v[188:189], v[188:189], s[22:23]
v_pk_mul_f32 v[190:191], v[190:191], s[22:23]
v_cvt_pk_bf16_f32 v184, v184, v185
v_cvt_pk_bf16_f32 v185, v186, v187
v_cvt_pk_bf16_f32 v186, v188, v189
v_cvt_pk_bf16_f32 v187, v190, v191
v_permlane32_swap_b32 v212, v214
v_permlane32_swap_b32 v213, v215
buffer_store_dwordx4 v[212:215], v3, s[24:27], s4 offen offset:0 sc1
ds_write_b128 v25, v[212:215] offset:0
v_pk_mul_f32 v[160:161], v[160:161], s[22:23]
v_pk_mul_f32 v[162:163], v[162:163], s[22:23]
v_pk_mul_f32 v[164:165], v[164:165], s[22:23]
v_pk_mul_f32 v[166:167], v[166:167], s[22:23]
v_cvt_pk_bf16_f32 v160, v160, v161
v_cvt_pk_bf16_f32 v161, v162, v163
v_cvt_pk_bf16_f32 v162, v164, v165
v_cvt_pk_bf16_f32 v163, v166, v167
v_permlane16_swap_b32 v184, v186
v_permlane16_swap_b32 v185, v187
ds_write_b128 v26, v[184:187] offset:4352
v_pk_mul_f32 v[136:137], v[136:137], s[22:23]
v_pk_mul_f32 v[138:139], v[138:139], s[22:23]
v_pk_mul_f32 v[140:141], v[140:141], s[22:23]
v_pk_mul_f32 v[142:143], v[142:143], s[22:23]
v_cvt_pk_bf16_f32 v136, v136, v137
v_cvt_pk_bf16_f32 v137, v138, v139
v_cvt_pk_bf16_f32 v138, v140, v141
v_cvt_pk_bf16_f32 v139, v142, v143
v_permlane16_swap_b32 v160, v162
v_permlane16_swap_b32 v161, v163
ds_write_b128 v26, v[160:163] offset:4096
v_pk_mul_f32 v[112:113], v[112:113], s[22:23]
v_pk_mul_f32 v[114:115], v[114:115], s[22:23]
v_pk_mul_f32 v[116:117], v[116:117], s[22:23]
v_pk_mul_f32 v[118:119], v[118:119], s[22:23]
v_cvt_pk_bf16_f32 v112, v112, v113
v_cvt_pk_bf16_f32 v113, v114, v115
v_cvt_pk_bf16_f32 v114, v116, v117
v_cvt_pk_bf16_f32 v115, v118, v119
v_permlane16_swap_b32 v136, v138
v_permlane16_swap_b32 v137, v139
ds_write_b128 v26, v[136:139] offset:2304
v_pk_mul_f32 v[88:89], v[88:89], s[22:23]
v_pk_mul_f32 v[90:91], v[90:91], s[22:23]
v_pk_mul_f32 v[92:93], v[92:93], s[22:23]
v_pk_mul_f32 v[94:95], v[94:95], s[22:23]
v_cvt_pk_bf16_f32 v88, v88, v89
v_cvt_pk_bf16_f32 v89, v90, v91
v_cvt_pk_bf16_f32 v90, v92, v93
v_cvt_pk_bf16_f32 v91, v94, v95
v_permlane16_swap_b32 v112, v114
v_permlane16_swap_b32 v113, v115
ds_write_b128 v26, v[112:115] offset:2048
v_pk_mul_f32 v[64:65], v[64:65], s[22:23]
v_pk_mul_f32 v[66:67], v[66:67], s[22:23]
v_pk_mul_f32 v[68:69], v[68:69], s[22:23]
v_pk_mul_f32 v[70:71], v[70:71], s[22:23]
v_cvt_pk_bf16_f32 v64, v64, v65
v_cvt_pk_bf16_f32 v65, v66, v67
v_cvt_pk_bf16_f32 v66, v68, v69
v_cvt_pk_bf16_f32 v67, v70, v71
v_permlane16_swap_b32 v88, v90
v_permlane16_swap_b32 v89, v91
ds_write_b128 v26, v[88:91] offset:256
s_nop 1
v_permlane16_swap_b32 v64, v66
v_permlane16_swap_b32 v65, v67
ds_write_b128 v26, v[64:67] offset:0
v_cmp_le_i32 s[64:65], 0, v15
v_cmp_le_i32 s[66:67], 1, v15
v_cmp_le_i32 s[68:69], 2, v15
v_cmp_le_i32 s[70:71], 3, v15
v_cmp_le_i32 s[72:73], 8, v15
v_cmp_le_i32 s[74:75], 9, v15
v_cmp_le_i32 s[76:77], 10, v15
v_cmp_le_i32 s[78:79], 11, v15
v_cmp_le_i32 s[80:81], 16, v15
v_cmp_le_i32 s[82:83], 17, v15
v_cmp_le_i32 s[84:85], 18, v15
v_cmp_le_i32 s[86:87], 19, v15
v_cmp_le_i32 s[88:89], 24, v15
v_cmp_le_i32 s[90:91], 25, v15
v_cmp_le_i32 s[92:93], 26, v15
v_cmp_le_i32 s[94:95], 27, v15
v_mov_b32 v10, 0x3f803f80
v_accvgpr_write_b32 a208, v10
v_accvgpr_write_b32 a209, v10
v_accvgpr_write_b32 a210, v10
v_accvgpr_write_b32 a211, v10
s_lshl_b32 s16, s44, 3
s_lshr_b32 s17, s46, 1
s_add_u32 s16, s16, s17
s_lshl_b32 s16, s16, 16
s_lshl_b32 s17, s45, 1
s_and_b32 s18, s46, 1
s_add_u32 s17, s17, s18
s_lshl_b32 s17, s17, 10
s_add_u32 s16, s16, s17
s_add_u32 s97, s16, 37748736
s_mov_b32 s96, 0
s_mov_b32 s98, 0x33800000
s_mov_b32 s99, 0x53800000
s_waitcnt lgkmcnt(0)
s_barrier

s_sub_u32 s20, s44, 1
s_max_i32 s20, s20, 0
s_lshl_b32 s20, s20, 4
s_add_u32 s20, s20, s45
s_lshl_b32 s20, s20, 16
s_add_u32 s20, s20, 16777216
s_and_b32 s17, s46, 1
s_lshl_b32 s16, s17, 14
s_add_u32 s35, s20, s16
s_add_u32 s37, s35, 32768
s_lshl_b32 s29, s17, 15
s_add_u32 s38, s29, 65536
s_lshl_b32 s16, s46, 14
s_add_u32 s39, s20, s16
s_lshr_b32 s16, s46, 1
s_lshl_b32 s16, s16, 16
s_add_u32 s47, s16, s29
s_cmp_eq_u32 s44, 0
s_cselect_b32 s26, 0, 0x10000000

ds_read_b128 a[128:131], v31 offset:0
ds_read_b128 a[132:135], v31 offset:1024
ds_read_b128 a[136:139], v31 offset:4096
ds_read_b128 a[140:143], v31 offset:5120
ds_read_b128 a[144:147], v31 offset:8192
ds_read_b128 a[148:151], v31 offset:9216
ds_read_b128 a[152:155], v31 offset:12288
ds_read_b128 a[156:159], v31 offset:13312
s_waitcnt lgkmcnt(0)
ds_read_b128 a[160:163], v28 offset:26624
ds_read_b128 a[164:167], v28 offset:27648
s_waitcnt lgkmcnt(1)
v_mfma_f32_32x32x16_bf16 v[64:79], a[160:163], a[152:155], 0
ds_read_b128 a[168:171], v28 offset:24576
s_waitcnt lgkmcnt(1)
v_mfma_f32_32x32x16_bf16 v[64:79], a[164:167], a[156:159], v[64:79]
ds_read_b128 a[172:175], v28 offset:25600
s_cmp_lt_u32 s46, 2
s_cbranch_scc1 .LB_sh1
s_waitcnt vmcnt(0)
.LB_sh1:
s_barrier
s_cmp_eq_u32 s44, 7
s_cbranch_scc1 .LB_nosigH
s_lshl_b32 s20, s45, 2
s_lshl_b32 s21, 1, s44
s_mov_b32 s23, s32
s_cmp_lg_u32 s46, 2
s_cbranch_scc1 .Lsig_BH_end
s_add_u32 s30, s30, 1
v_mov_b32 v10, s30
v_mov_b32 v11, s21
s_mov_b64 exec, 1
buffer_store_dword v10, off, s[12:15], s23 sc1
buffer_atomic_add v11, off, s[60:63], s20
s_mov_b64 exec, -1
.Lsig_BH_end:
.LB_nosigH:
s_nop 7
s_nop 3
s_waitcnt lgkmcnt(1)
v_mfma_f32_32x32x16_bf16 v[80:95], a[168:171], a[152:155], 0
ds_read_b128 a[160:163], v28 offset:22528
ds_read_b128 a[164:167], v28 offset:23552
v_exp_f32 v64, v64
v_exp_f32 v65, v65
v_exp_f32 v66, v66
v_cvt_pk_bf16_f32 v112, v64, v65
v_exp_f32 v67, v67
v_exp_f32 v68, v68
v_cvt_pk_bf16_f32 v113, v66, v67
v_exp_f32 v69, v69
v_exp_f32 v70, v70
v_cvt_pk_bf16_f32 v114, v68, v69
v_exp_f32 v71, v71
v_exp_f32 v72, v72
s_waitcnt lgkmcnt(2)
v_mfma_f32_32x32x16_bf16 v[80:95], a[172:175], a[156:159], v[80:95]
ds_read_b128 a[184:187], v29 offset:26624
ds_read_b128 a[188:191], v29 offset:27648
s_cmp_ge_u32 s46, 2
s_cbranch_scc1 .LBc1
s_add_u32 s19, s36, 6144
buffer_store_dwordx4 v[240:243], v2, s[12:15], s19 offen offset:256 sc1
s_add_u32 s19, s36, 6144
buffer_store_dwordx4 v[248:251], v3, s[12:15], s19 offen offset:1024 sc1
s_add_u32 s19, s36, 6144
buffer_store_dwordx4 v[216:219], v2, s[12:15], s19 offen offset:0 sc1
s_add_u32 s19, s36, 6144
buffer_store_dwordx4 v[224:227], v3, s[12:15], s19 offen offset:0 sc1
.LBc1:
v_cvt_pk_bf16_f32 v115, v70, v71
v_exp_f32 v73, v73
v_exp_f32 v74, v74
v_cvt_pk_bf16_f32 v116, v72, v73
v_exp_f32 v75, v75
v_exp_f32 v76, v76
v_cvt_pk_bf16_f32 v117, v74, v75
v_exp_f32 v77, v77
v_exp_f32 v78, v78
v_exp_f32 v79, v79
v_cvt_pk_bf16_f32 v118, v76, v77
v_cvt_pk_bf16_f32 v119, v78, v79
s_waitcnt lgkmcnt(3)
v_mfma_f32_32x32x16_bf16 v[64:79], a[160:163], a[144:147], 0
ds_read_b128 a[192:195], v29 offset:24576
v_exp_f32 v80, v80
v_exp_f32 v81, v81
v_exp_f32 v82, v82
v_cvt_pk_bf16_f32 v120, v80, v81
s_waitcnt lgkmcnt(2)
v_mfma_f32_32x32x16_bf16 v[176:191], a[184:187], v[112:115], 0
ds_read_b128 a[196:199], v29 offset:25600
v_exp_f32 v83, v83
v_exp_f32 v84, v84
v_cvt_pk_bf16_f32 v121, v82, v83
v_exp_f32 v85, v85
v_mfma_f32_32x32x16_bf16 v[64:79], a[164:167], a[148:151], v[64:79]
v_exp_f32 v86, v86
v_cvt_pk_bf16_f32 v122, v84, v85
v_exp_f32 v87, v87
v_exp_f32 v88, v88
v_mfma_f32_32x32x16_bf16 a[112:127], a[208:211], v[112:115], 0
s_cmp_ge_u32 s46, 2
s_cbranch_scc1 .LBc2
s_add_u32 s19, s36, 4096
buffer_store_dwordx4 v[192:195], v2, s[12:15], s19 offen offset:256 sc1
s_add_u32 s19, s36, 4096
buffer_store_dwordx4 v[200:203], v3, s[12:15], s19 offen offset:1024 sc1
s_add_u32 s19, s36, 4096
buffer_store_dwordx4 v[244:247], v2, s[12:15], s19 offen offset:0 sc1
s_add_u32 s19, s36, 4096
buffer_store_dwordx4 v[252:255], v3, s[12:15], s19 offen offset:0 sc1
.LBc2:
v_cvt_pk_bf16_f32 v123, v86, v87
v_exp_f32 v89, v89
v_exp_f32 v90, v90
s_waitcnt lgkmcnt(2)
v_mfma_f32_32x32x16_bf16 v[176:191], a[188:191], v[116:119], v[176:191]
v_cvt_pk_bf16_f32 v124, v88, v89
v_exp_f32 v91, v91
v_exp_f32 v92, v92
v_cvt_pk_bf16_f32 v125, v90, v91
v_exp_f32 v93, v93
v_mfma_f32_32x32x16_bf16 a[112:127], a[208:211], v[116:119], a[112:127]
v_exp_f32 v94, v94
v_exp_f32 v95, v95
v_cvt_pk_bf16_f32 v126, v92, v93
v_cvt_pk_bf16_f32 v127, v94, v95
v_mfma_f32_32x32x16_bf16 v[80:95], a[160:163], a[152:155], 0
ds_read_b128 a[168:171], v28 offset:20480
v_exp_f32 v64, v64
v_exp_f32 v65, v65
v_exp_f32 v66, v66
v_cvt_pk_bf16_f32 v112, v64, v65
s_waitcnt lgkmcnt(2)
v_mfma_f32_32x32x16_bf16 v[176:191], a[192:195], v[120:123], v[176:191]
ds_read_b128 a[172:175], v28 offset:21504
v_exp_f32 v67, v67
v_exp_f32 v68, v68
v_cvt_pk_bf16_f32 v113, v66, v67
v_exp_f32 v69, v69
v_mfma_f32_32x32x16_bf16 v[80:95], a[164:167], a[156:159], v[80:95]
ds_read_b128 a[184:187], v29 offset:22528
v_exp_f32 v70, v70
v_cvt_pk_bf16_f32 v114, v68, v69
v_exp_f32 v71, v71
v_exp_f32 v72, v72
v_mfma_f32_32x32x16_bf16 a[112:127], a[208:211], v[120:123], a[112:127]
ds_read_b128 a[188:191], v29 offset:23552
s_cmp_ge_u32 s46, 2
s_cbranch_scc1 .LBc3
s_add_u32 s19, s36, 2048
buffer_store_dwordx4 v[220:223], v2, s[12:15], s19 offen offset:256 sc1
s_add_u32 s19, s36, 2048
buffer_store_dwordx4 v[228:231], v3, s[12:15], s19 offen offset:1024 sc1
s_add_u32 s19, s36, 2048
buffer_store_dwordx4 v[196:199], v2, s[12:15], s19 offen offset:0 sc1
s_add_u32 s19, s36, 2048
buffer_store_dwordx4 v[204:207], v3, s[12:15], s19 offen offset:0 sc1
.LBc3:
v_cvt_pk_bf16_f32 v115, v70, v71
v_exp_f32 v73, v73
v_exp_f32 v74, v74
s_waitcnt lgkmcnt(4)
v_mfma_f32_32x32x16_bf16 v[176:191], a[196:199], v[124:127], v[176:191]
v_cvt_pk_bf16_f32 v116, v72, v73
v_exp_f32 v75, v75
v_exp_f32 v76, v76
v_cvt_pk_bf16_f32 v117, v74, v75
v_exp_f32 v77, v77
v_mfma_f32_32x32x16_bf16 a[112:127], a[208:211], v[124:127], a[112:127]
v_exp_f32 v78, v78
v_exp_f32 v79, v79
v_cvt_pk_bf16_f32 v118, v76, v77
v_cvt_pk_bf16_f32 v119, v78, v79
s_waitcnt lgkmcnt(3)
v_mfma_f32_32x32x16_bf16 v[64:79], a[168:171], a[144:147], 0
v_exp_f32 v80, v80
v_exp_f32 v81, v81
v_exp_f32 v82, v82
v_cvt_pk_bf16_f32 v120, v80, v81
s_waitcnt lgkmcnt(1)
v_mfma_f32_32x32x16_bf16 v[160:175], a[184:187], v[112:115], 0
v_exp_f32 v83, v83
v_exp_f32 v84, v84
v_cvt_pk_bf16_f32 v121, v82, v83
v_exp_f32 v85, v85
v_mfma_f32_32x32x16_bf16 v[64:79], a[172:175], a[148:151], v[64:79]
s_cmp_ge_u32 s46, 2
s_cbranch_scc1 .LBc4
s_add_u32 s19, s36, 0
buffer_store_dwordx4 v[232:235], v2, s[12:15], s19 offen offset:256 sc1
s_add_u32 s19, s36, 0
buffer_store_dwordx4 v[236:239], v3, s[12:15], s19 offen offset:1024 sc1
s_add_u32 s19, s36, 0
buffer_store_dwordx4 v[208:211], v2, s[12:15], s19 offen offset:0 sc1
s_add_u32 s19, s36, 0
buffer_store_dwordx4 v[212:215], v3, s[12:15], s19 offen offset:0 sc1
.LBc4:
v_exp_f32 v86, v86
v_cvt_pk_bf16_f32 v122, v84, v85
v_exp_f32 v87, v87
v_exp_f32 v88, v88
v_mfma_f32_32x32x16_bf16 a[96:111], a[208:211], v[112:115], 0
v_cvt_pk_bf16_f32 v123, v86, v87
v_exp_f32 v89, v89
v_exp_f32 v90, v90
v_cvt_pk_bf16_f32 v124, v88, v89
s_waitcnt lgkmcnt(0)
v_mfma_f32_32x32x16_bf16 v[160:175], a[188:191], v[116:119], v[160:175]
s_cmp_lt_u32 s46, 2
s_cbranch_scc1 .LBc11
s_add_u32 s18, s33, 0
buffer_load_dword v8, off, s[12:15], s18 sc1
.LBc11:
v_exp_f32 v91, v91
v_exp_f32 v92, v92
v_cvt_pk_bf16_f32 v125, v90, v91
v_exp_f32 v93, v93
v_mfma_f32_32x32x16_bf16 a[96:111], a[208:211], v[116:119], a[96:111]
v_exp_f32 v94, v94
v_exp_f32 v95, v95
v_cvt_pk_bf16_f32 v126, v92, v93
v_cvt_pk_bf16_f32 v127, v94, v95
v_mfma_f32_32x32x16_bf16 v[80:95], a[168:171], a[152:155], 0
ds_read_b128 a[160:163], v28 offset:18432
v_exp_f32 v64, v64
v_exp_f32 v65, v65
v_exp_f32 v66, v66
v_cvt_pk_bf16_f32 v112, v64, v65
v_mfma_f32_32x32x16_bf16 v[176:191], a[184:187], v[120:123], v[176:191]
ds_read_b128 a[164:167], v28 offset:19456
v_exp_f32 v67, v67
v_exp_f32 v68, v68
v_cvt_pk_bf16_f32 v113, v66, v67
v_exp_f32 v69, v69
v_mfma_f32_32x32x16_bf16 v[80:95], a[172:175], a[156:159], v[80:95]
ds_read_b128 a[192:195], v29 offset:20480
v_exp_f32 v70, v70
v_cvt_pk_bf16_f32 v114, v68, v69
v_exp_f32 v71, v71
v_exp_f32 v72, v72
v_mfma_f32_32x32x16_bf16 a[112:127], a[208:211], v[120:123], a[112:127]
ds_read_b128 a[196:199], v29 offset:21504
v_cvt_pk_bf16_f32 v115, v70, v71
v_exp_f32 v73, v73
v_exp_f32 v74, v74
v_cvt_pk_bf16_f32 v116, v72, v73
v_mfma_f32_32x32x16_bf16 v[176:191], a[188:191], v[124:127], v[176:191]
v_exp_f32 v75, v75
v_exp_f32 v76, v76
v_cvt_pk_bf16_f32 v117, v74, v75
v_exp_f32 v77, v77
v_mfma_f32_32x32x16_bf16 a[112:127], a[208:211], v[124:127], a[112:127]
v_exp_f32 v78, v78
v_exp_f32 v79, v79
v_cvt_pk_bf16_f32 v118, v76, v77
v_cvt_pk_bf16_f32 v119, v78, v79
s_cmp_lt_u32 s46, 2
s_cbranch_scc1 .LB_skipH
s_cmp_eq_u32 s44, 0
s_cbranch_scc1 .LB_nopollH
s_lshl_b32 s20, s45, 2
s_add_u32 s22, s44, -1
s_add_u32 s23, s33, 0
s_waitcnt vmcnt(0)
v_readfirstlane_b32 s16, v8
s_nop 0
s_cmp_lg_u32 s16, s31
s_cbranch_scc1 .Lpoll_BH_end
s_mov_b32 s17, 0
.Lpoll_BH:
buffer_load_dword v10, off, s[12:15], s23 sc1
s_waitcnt vmcnt(0)
v_readfirstlane_b32 s16, v10
s_nop 0
s_cmp_lg_u32 s16, s31
s_cbranch_scc1 .Lpoll_BH_end
s_add_u32 s17, s17, 1
s_and_b32 s16, s17, 15
s_cmp_lg_u32 s16, 0
s_cbranch_scc1 .Lpoll_BH
buffer_load_dword v10, off, s[60:63], s20 sc1
s_waitcnt vmcnt(0)
v_readfirstlane_b32 s16, v10
s_nop 0
s_bitcmp1_b32 s16, s22
s_cbranch_scc1 .Lpoll_BH_end
s_cmp_lt_u32 s17, 200000
s_cbranch_scc1 .Lpoll_BH
.Lpoll_BH_end:
.LB_nopollH:
.LB_skipH:
s_waitcnt lgkmcnt(3)
v_mfma_f32_32x32x16_bf16 v[64:79], a[160:163], a[136:139], 0
v_exp_f32 v80, v80
v_exp_f32 v81, v81
v_exp_f32 v82, v82
v_cvt_pk_bf16_f32 v120, v80, v81
s_waitcnt lgkmcnt(1)
v_mfma_f32_32x32x16_bf16 v[160:175], a[192:195], v[112:115], v[160:175]
v_exp_f32 v83, v83
v_exp_f32 v84, v84
v_cvt_pk_bf16_f32 v121, v82, v83
v_exp_f32 v85, v85
v_mfma_f32_32x32x16_bf16 v[64:79], a[164:167], a[140:143], v[64:79]
v_exp_f32 v86, v86
v_cvt_pk_bf16_f32 v122, v84, v85
v_exp_f32 v87, v87
v_exp_f32 v88, v88
v_mfma_f32_32x32x16_bf16 a[96:111], a[208:211], v[112:115], a[96:111]
s_cmp_lt_u32 s46, 2
s_cbranch_scc1 .LBc5
s_add_u32 s19, s35, 8192
s_add_u32 m0, s29, 8192
s_nop 0
buffer_load_dwordx4 v27, s[24:27], s19 offen offset:0 sc1 lds
buffer_load_dwordx4 v27, s[24:27], s19 offen offset:1024 sc1 lds
buffer_load_dwordx4 v27, s[24:27], s19 offen offset:2048 sc1 lds
buffer_load_dwordx4 v27, s[24:27], s19 offen offset:3072 sc1 lds
s_add_u32 s19, s35, 12288
s_add_u32 m0, s29, 12288
s_nop 0
buffer_load_dwordx4 v27, s[24:27], s19 offen offset:0 sc1 lds
buffer_load_dwordx4 v27, s[24:27], s19 offen offset:1024 sc1 lds
buffer_load_dwordx4 v27, s[24:27], s19 offen offset:2048 sc1 lds
buffer_load_dwordx4 v27, s[24:27], s19 offen offset:3072 sc1 lds
.LBc5:
v_cvt_pk_bf16_f32 v123, v86, v87
v_exp_f32 v89, v89
v_exp_f32 v90, v90
s_waitcnt lgkmcnt(0)
v_mfma_f32_32x32x16_bf16 v[160:175], a[196:199], v[116:119], v[160:175]
v_cvt_pk_bf16_f32 v124, v88, v89
v_exp_f32 v91, v91
v_exp_f32 v92, v92
v_cvt_pk_bf16_f32 v125, v90, v91
v_exp_f32 v93, v93
v_mfma_f32_32x32x16_bf16 a[96:111], a[208:211], v[116:119], a[96:111]
v_exp_f32 v94, v94
v_exp_f32 v95, v95
v_cvt_pk_bf16_f32 v126, v92, v93
v_cvt_pk_bf16_f32 v127, v94, v95
v_mfma_f32_32x32x16_bf16 v[80:95], a[160:163], a[144:147], 0
ds_read_b128 a[184:187], v29 offset:18432
v_exp_f32 v64, v64
v_exp_f32 v65, v65
v_exp_f32 v66, v66
v_cvt_pk_bf16_f32 v112, v64, v65
v_mfma_f32_32x32x16_bf16 v[176:191], a[192:195], v[120:123], v[176:191]
ds_read_b128 a[188:191], v29 offset:19456
v_exp_f32 v67, v67
v_exp_f32 v68, v68
v_cvt_pk_bf16_f32 v113, v66, v67
v_exp_f32 v69, v69
v_mfma_f32_32x32x16_bf16 v[80:95], a[164:167], a[148:151], v[80:95]
v_exp_f32 v70, v70
v_cvt_pk_bf16_f32 v114, v68, v69
v_exp_f32 v71, v71
v_exp_f32 v72, v72
v_mfma_f32_32x32x16_bf16 a[112:127], a[208:211], v[120:123], a[112:127]
s_cmp_lt_u32 s46, 2
s_cbranch_scc1 .LBc6
s_add_u32 s19, s37, 8192
s_add_u32 m0, s38, 8192
s_nop 0
buffer_load_dwordx4 v27, s[24:27], s19 offen offset:0 sc1 lds
buffer_load_dwordx4 v27, s[24:27], s19 offen offset:1024 sc1 lds
buffer_load_dwordx4 v27, s[24:27], s19 offen offset:2048 sc1 lds
buffer_load_dwordx4 v27, s[24:27], s19 offen offset:3072 sc1 lds
s_add_u32 s19, s37, 12288
s_add_u32 m0, s38, 12288
s_nop 0
buffer_load_dwordx4 v27, s[24:27], s19 offen offset:0 sc1 lds
buffer_load_dwordx4 v27, s[24:27], s19 offen offset:1024 sc1 lds
buffer_load_dwordx4 v27, s[24:27], s19 offen offset:2048 sc1 lds
buffer_load_dwordx4 v27, s[24:27], s19 offen offset:3072 sc1 lds
.LBc6:
v_cvt_pk_bf16_f32 v115, v70, v71
v_exp_f32 v73, v73
v_exp_f32 v74, v74
v_mfma_f32_32x32x16_bf16 v[176:191], a[196:199], v[124:127], v[176:191]
v_cvt_pk_bf16_f32 v116, v72, v73
v_exp_f32 v75, v75
v_exp_f32 v76, v76
v_cvt_pk_bf16_f32 v117, v74, v75
v_exp_f32 v77, v77
v_mfma_f32_32x32x16_bf16 a[112:127], a[208:211], v[124:127], a[112:127]
v_exp_f32 v78, v78
v_exp_f32 v79, v79
v_cvt_pk_bf16_f32 v118, v76, v77
v_cvt_pk_bf16_f32 v119, v78, v79
s_cmp_ge_u32 s46, 2
s_cbranch_scc1 .LB_sl1
s_waitcnt vmcnt(0)
.LB_sl1:
s_barrier
s_cmp_eq_u32 s44, 7
s_cbranch_scc1 .LB_nosigL
s_lshl_b32 s20, s45, 2
s_add_u32 s22, s44, 8
s_lshl_b32 s21, 1, s22
s_add_u32 s23, s32, 0x8000
s_cmp_lg_u32 s46, 3
s_cbranch_scc1 .Lsig_BL_end
s_add_u32 s3, s3, 1
v_mov_b32 v10, s3
v_mov_b32 v11, s21
s_mov_b64 exec, 1
buffer_store_dword v10, off, s[12:15], s23 sc1
buffer_atomic_add v11, off, s[60:63], s20
s_mov_b64 exec, -1
.Lsig_BL_end:
.LB_nosigL:
v_mfma_f32_32x32x16_bf16 v[64:79], a[160:163], a[152:155], 0
ds_read_b128 a[168:171], v28 offset:16384
v_exp_f32 v80, v80
v_exp_f32 v81, v81
v_exp_f32 v82, v82
v_cvt_pk_bf16_f32 v120, v80, v81
s_waitcnt lgkmcnt(2)
v_mfma_f32_32x32x16_bf16 v[144:159], a[184:187], v[112:115], 0
ds_read_b128 a[172:175], v28 offset:17408
v_exp_f32 v83, v83
v_exp_f32 v84, v84
v_cvt_pk_bf16_f32 v121, v82, v83
v_exp_f32 v85, v85
v_mfma_f32_32x32x16_bf16 v[64:79], a[164:167], a[156:159], v[64:79]
v_exp_f32 v86, v86
v_cvt_pk_bf16_f32 v122, v84, v85
v_exp_f32 v87, v87
v_exp_f32 v88, v88
v_mfma_f32_32x32x16_bf16 a[80:95], a[208:211], v[112:115], 0
v_cvt_pk_bf16_f32 v123, v86, v87
v_exp_f32 v89, v89
v_exp_f32 v90, v90
v_cvt_pk_bf16_f32 v124, v88, v89
s_waitcnt lgkmcnt(2)
v_mfma_f32_32x32x16_bf16 v[144:159], a[188:191], v[116:119], v[144:159]
v_exp_f32 v91, v91
v_exp_f32 v92, v92
v_cvt_pk_bf16_f32 v125, v90, v91
v_exp_f32 v93, v93
v_mfma_f32_32x32x16_bf16 a[80:95], a[208:211], v[116:119], a[80:95]
v_exp_f32 v94, v94
v_exp_f32 v95, v95
v_cvt_pk_bf16_f32 v126, v92, v93
v_cvt_pk_bf16_f32 v127, v94, v95
s_waitcnt lgkmcnt(1)
v_mfma_f32_32x32x16_bf16 v[80:95], a[168:171], a[136:139], 0
v_exp_f32 v64, v64
v_exp_f32 v65, v65
v_exp_f32 v66, v66
v_cvt_pk_bf16_f32 v112, v64, v65
v_mfma_f32_32x32x16_bf16 v[160:175], a[184:187], v[120:123], v[160:175]
v_exp_f32 v67, v67
v_exp_f32 v68, v68
v_cvt_pk_bf16_f32 v113, v66, v67
v_exp_f32 v69, v69
s_waitcnt lgkmcnt(0)
v_mfma_f32_32x32x16_bf16 v[80:95], a[172:175], a[140:143], v[80:95]
v_exp_f32 v70, v70
v_cvt_pk_bf16_f32 v114, v68, v69
v_exp_f32 v71, v71
v_exp_f32 v72, v72
v_mfma_f32_32x32x16_bf16 a[96:111], a[208:211], v[120:123], a[96:111]
v_cvt_pk_bf16_f32 v115, v70, v71
v_exp_f32 v73, v73
v_exp_f32 v74, v74
v_cvt_pk_bf16_f32 v116, v72, v73
v_mfma_f32_32x32x16_bf16 v[160:175], a[188:191], v[124:127], v[160:175]
v_exp_f32 v75, v75
v_exp_f32 v76, v76
v_cvt_pk_bf16_f32 v117, v74, v75
v_exp_f32 v77, v77
v_mfma_f32_32x32x16_bf16 a[96:111], a[208:211], v[124:127], a[96:111]
v_exp_f32 v78, v78
v_exp_f32 v79, v79
v_cvt_pk_bf16_f32 v118, v76, v77
v_cvt_pk_bf16_f32 v119, v78, v79
v_mfma_f32_32x32x16_bf16 v[64:79], a[168:171], a[144:147], 0
ds_read_b128 a[192:195], v29 offset:16384
v_exp_f32 v80, v80
v_exp_f32 v81, v81
v_exp_f32 v82, v82
v_cvt_pk_bf16_f32 v120, v80, v81
v_mfma_f32_32x32x16_bf16 v[176:191], a[184:187], v[112:115], v[176:191]
ds_read_b128 a[196:199], v29 offset:17408
v_exp_f32 v83, v83
v_exp_f32 v84, v84
v_cvt_pk_bf16_f32 v121, v82, v83
v_exp_f32 v85, v85
v_mfma_f32_32x32x16_bf16 v[64:79], a[172:175], a[148:151], v[64:79]
v_exp_f32 v86, v86
v_cvt_pk_bf16_f32 v122, v84, v85
v_exp_f32 v87, v87
v_exp_f32 v88, v88
v_mfma_f32_32x32x16_bf16 a[112:127], a[208:211], v[112:115], a[112:127]
v_cvt_pk_bf16_f32 v123, v86, v87
v_exp_f32 v89, v89
v_exp_f32 v90, v90
v_cvt_pk_bf16_f32 v124, v88, v89
v_mfma_f32_32x32x16_bf16 v[176:191], a[188:191], v[116:119], v[176:191]
v_exp_f32 v91, v91
v_exp_f32 v92, v92
v_cvt_pk_bf16_f32 v125, v90, v91
v_exp_f32 v93, v93
v_mfma_f32_32x32x16_bf16 a[112:127], a[208:211], v[116:119], a[112:127]
v_exp_f32 v94, v94
v_exp_f32 v95, v95
v_cvt_pk_bf16_f32 v126, v92, v93
v_cvt_pk_bf16_f32 v127, v94, v95
s_waitcnt vmcnt(0)
s_barrier
v_mfma_f32_32x32x16_bf16 v[80:95], a[168:171], a[152:155], 0
ds_read_b128 a[160:163], v28 offset:14336
v_exp_f32 v64, v64
v_exp_f32 v65, v65
v_exp_f32 v66, v66
v_cvt_pk_bf16_f32 v112, v64, v65
s_waitcnt lgkmcnt(2)
v_mfma_f32_32x32x16_bf16 v[144:159], a[192:195], v[120:123], v[144:159]
ds_read_b128 a[164:167], v28 offset:15360
v_exp_f32 v67, v67
v_exp_f32 v68, v68
v_cvt_pk_bf16_f32 v113, v66, v67
v_exp_f32 v69, v69
v_mfma_f32_32x32x16_bf16 v[80:95], a[172:175], a[156:159], v[80:95]
v_exp_f32 v70, v70
v_cvt_pk_bf16_f32 v114, v68, v69
v_exp_f32 v71, v71
v_exp_f32 v72, v72
v_mfma_f32_32x32x16_bf16 a[80:95], a[208:211], v[120:123], a[80:95]
v_cvt_pk_bf16_f32 v115, v70, v71
v_exp_f32 v73, v73
v_exp_f32 v74, v74
v_cvt_pk_bf16_f32 v116, v72, v73
s_waitcnt lgkmcnt(2)
v_mfma_f32_32x32x16_bf16 v[144:159], a[196:199], v[124:127], v[144:159]
v_exp_f32 v75, v75
v_exp_f32 v76, v76
v_cvt_pk_bf16_f32 v117, v74, v75
v_exp_f32 v77, v77
v_mfma_f32_32x32x16_bf16 a[80:95], a[208:211], v[124:127], a[80:95]
v_exp_f32 v78, v78
v_exp_f32 v79, v79
v_cvt_pk_bf16_f32 v118, v76, v77
v_cvt_pk_bf16_f32 v119, v78, v79
s_waitcnt lgkmcnt(1)
v_mfma_f32_32x32x16_bf16 v[64:79], a[160:163], a[128:131], v[32:47]
v_exp_f32 v80, v80
v_exp_f32 v81, v81
v_exp_f32 v82, v82
v_cvt_pk_bf16_f32 v120, v80, v81
v_mfma_f32_32x32x16_bf16 v[160:175], a[192:195], v[112:115], v[160:175]
v_exp_f32 v83, v83
v_exp_f32 v84, v84
v_cvt_pk_bf16_f32 v121, v82, v83
v_exp_f32 v85, v85
s_waitcnt lgkmcnt(0)
v_mfma_f32_32x32x16_bf16 v[64:79], a[164:167], a[132:135], v[64:79]
s_add_u32 s18, s33, 0x8000
v_exp_f32 v86, v86
v_cvt_pk_bf16_f32 v122, v84, v85
v_exp_f32 v87, v87
v_exp_f32 v88, v88
v_mfma_f32_32x32x16_bf16 a[96:111], a[208:211], v[112:115], a[96:111]
v_cvt_pk_bf16_f32 v123, v86, v87
v_exp_f32 v89, v89
v_exp_f32 v90, v90
v_cvt_pk_bf16_f32 v124, v88, v89
v_mfma_f32_32x32x16_bf16 v[160:175], a[196:199], v[116:119], v[160:175]
buffer_load_dword v8, off, s[12:15], s18 sc1
v_exp_f32 v91, v91
v_exp_f32 v92, v92
v_cvt_pk_bf16_f32 v125, v90, v91
v_exp_f32 v93, v93
v_mfma_f32_32x32x16_bf16 a[96:111], a[208:211], v[116:119], a[96:111]
v_exp_f32 v94, v94
v_exp_f32 v95, v95
v_cvt_pk_bf16_f32 v126, v92, v93
v_cvt_pk_bf16_f32 v127, v94, v95
v_mfma_f32_32x32x16_bf16 v[80:95], a[160:163], a[136:139], v[32:47]
ds_read_b128 a[184:187], v29 offset:14336
v_exp_f32 v64, v64
v_exp_f32 v65, v65
v_exp_f32 v66, v66
v_cvt_pk_bf16_f32 v112, v64, v65
v_mfma_f32_32x32x16_bf16 v[176:191], a[192:195], v[120:123], v[176:191]
ds_read_b128 a[188:191], v29 offset:15360
v_exp_f32 v67, v67
v_exp_f32 v68, v68
v_cvt_pk_bf16_f32 v113, v66, v67
v_exp_f32 v69, v69
v_mfma_f32_32x32x16_bf16 v[80:95], a[164:167], a[140:143], v[80:95]
v_exp_f32 v70, v70
v_cvt_pk_bf16_f32 v114, v68, v69
v_exp_f32 v71, v71
v_exp_f32 v72, v72
v_mfma_f32_32x32x16_bf16 a[112:127], a[208:211], v[120:123], a[112:127]
v_cvt_pk_bf16_f32 v115, v70, v71
v_exp_f32 v73, v73
v_exp_f32 v74, v74
v_cvt_pk_bf16_f32 v116, v72, v73
v_mfma_f32_32x32x16_bf16 v[176:191], a[196:199], v[124:127], v[176:191]
v_exp_f32 v75, v75
v_exp_f32 v76, v76
v_cvt_pk_bf16_f32 v117, v74, v75
v_exp_f32 v77, v77
v_mfma_f32_32x32x16_bf16 a[112:127], a[208:211], v[124:127], a[112:127]
v_exp_f32 v78, v78
v_exp_f32 v79, v79
v_cvt_pk_bf16_f32 v118, v76, v77
v_cvt_pk_bf16_f32 v119, v78, v79
s_cmp_eq_u32 s44, 0
s_cbranch_scc1 .LB_nopollL
s_lshl_b32 s20, s45, 2
s_add_u32 s22, s44, 7
s_add_u32 s23, s33, 32768
s_waitcnt vmcnt(0)
v_readfirstlane_b32 s16, v8
s_nop 0
s_cmp_lg_u32 s16, s34
s_cbranch_scc1 .Lpoll_BL_end
s_mov_b32 s17, 0
.Lpoll_BL:
buffer_load_dword v10, off, s[12:15], s23 sc1
s_waitcnt vmcnt(0)
v_readfirstlane_b32 s16, v10
s_nop 0
s_cmp_lg_u32 s16, s34
s_cbranch_scc1 .Lpoll_BL_end
s_add_u32 s17, s17, 1
s_and_b32 s16, s17, 15
s_cmp_lg_u32 s16, 0
s_cbranch_scc1 .Lpoll_BL
buffer_load_dword v10, off, s[60:63], s20 sc1
s_waitcnt vmcnt(0)
v_readfirstlane_b32 s16, v10
s_nop 0
s_bitcmp1_b32 s16, s22
s_cbranch_scc1 .Lpoll_BL_end
s_cmp_lt_u32 s17, 200000
s_cbranch_scc1 .Lpoll_BL
.Lpoll_BL_end:
.LB_nopollL:
v_mfma_f32_32x32x16_bf16 v[64:79], a[160:163], a[144:147], v[32:47]
v_exp_f32 v80, v80
v_exp_f32 v81, v81
v_exp_f32 v82, v82
v_cvt_pk_bf16_f32 v120, v80, v81
s_waitcnt lgkmcnt(1)
v_mfma_f32_32x32x16_bf16 v[128:143], a[184:187], v[112:115], 0
v_exp_f32 v83, v83
v_exp_f32 v84, v84
v_cvt_pk_bf16_f32 v121, v82, v83
v_exp_f32 v85, v85
v_mfma_f32_32x32x16_bf16 v[64:79], a[164:167], a[148:151], v[64:79]
v_exp_f32 v86, v86
v_cvt_pk_bf16_f32 v122, v84, v85
v_exp_f32 v87, v87
v_exp_f32 v88, v88
v_mfma_f32_32x32x16_bf16 a[64:79], a[208:211], v[112:115], 0
s_cmp_lg_u32 s46, 0
s_cbranch_scc1 .LBc7
s_add_u32 s19, s39, 0
s_add_u32 m0, s47, 0
s_nop 0
buffer_load_dwordx4 v27, s[24:27], s19 offen offset:0 sc1 lds
buffer_load_dwordx4 v27, s[24:27], s19 offen offset:1024 sc1 lds
buffer_load_dwordx4 v27, s[24:27], s19 offen offset:2048 sc1 lds
buffer_load_dwordx4 v27, s[24:27], s19 offen offset:3072 sc1 lds
s_add_u32 s19, s39, 4096
s_add_u32 m0, s47, 4096
s_nop 0
buffer_load_dwordx4 v27, s[24:27], s19 offen offset:0 sc1 lds
buffer_load_dwordx4 v27, s[24:27], s19 offen offset:1024 sc1 lds
buffer_load_dwordx4 v27, s[24:27], s19 offen offset:2048 sc1 lds
buffer_load_dwordx4 v27, s[24:27], s19 offen offset:3072 sc1 lds
.LBc7:
v_cvt_pk_bf16_f32 v123, v86, v87
v_exp_f32 v89, v89
v_exp_f32 v90, v90
s_waitcnt lgkmcnt(0)
v_mfma_f32_32x32x16_bf16 v[128:143], a[188:191], v[116:119], v[128:143]
v_cvt_pk_bf16_f32 v124, v88, v89
v_exp_f32 v91, v91
v_exp_f32 v92, v92
v_cvt_pk_bf16_f32 v125, v90, v91
v_exp_f32 v93, v93
v_mfma_f32_32x32x16_bf16 a[64:79], a[208:211], v[116:119], a[64:79]
v_exp_f32 v94, v94
v_exp_f32 v95, v95
v_cvt_pk_bf16_f32 v126, v92, v93
v_cvt_pk_bf16_f32 v127, v94, v95
v_mfma_f32_32x32x16_bf16 v[80:95], a[160:163], a[152:155], v[32:47]
ds_read_b128 a[168:171], v28 offset:12288
v_exp_f32 v64, v64
v_exp_f32 v65, v65
v_exp_f32 v66, v66
v_cvt_pk_bf16_f32 v112, v64, v65
v_mfma_f32_32x32x16_bf16 v[144:159], a[184:187], v[120:123], v[144:159]
ds_read_b128 a[172:175], v28 offset:13312
v_exp_f32 v67, v67
v_exp_f32 v68, v68
v_cvt_pk_bf16_f32 v113, v66, v67
v_exp_f32 v69, v69
v_mfma_f32_32x32x16_bf16 v[80:95], a[164:167], a[156:159], v[80:95]
v_exp_f32 v70, v70
v_cvt_pk_bf16_f32 v114, v68, v69
v_exp_f32 v71, v71
v_exp_f32 v72, v72
v_mfma_f32_32x32x16_bf16 a[80:95], a[208:211], v[120:123], a[80:95]
s_cmp_lg_u32 s46, 1
s_cbranch_scc1 .LBc8
s_add_u32 s19, s39, 0
s_add_u32 m0, s47, 0
s_nop 0
buffer_load_dwordx4 v27, s[24:27], s19 offen offset:0 sc1 lds
buffer_load_dwordx4 v27, s[24:27], s19 offen offset:1024 sc1 lds
buffer_load_dwordx4 v27, s[24:27], s19 offen offset:2048 sc1 lds
buffer_load_dwordx4 v27, s[24:27], s19 offen offset:3072 sc1 lds
s_add_u32 s19, s39, 4096
s_add_u32 m0, s47, 4096
s_nop 0
buffer_load_dwordx4 v27, s[24:27], s19 offen offset:0 sc1 lds
buffer_load_dwordx4 v27, s[24:27], s19 offen offset:1024 sc1 lds
buffer_load_dwordx4 v27, s[24:27], s19 offen offset:2048 sc1 lds
buffer_load_dwordx4 v27, s[24:27], s19 offen offset:3072 sc1 lds
.LBc8:
v_cvt_pk_bf16_f32 v115, v70, v71
v_exp_f32 v73, v73
v_exp_f32 v74, v74
v_mfma_f32_32x32x16_bf16 v[144:159], a[188:191], v[124:127], v[144:159]
v_cvt_pk_bf16_f32 v116, v72, v73
v_exp_f32 v75, v75
v_exp_f32 v76, v76
v_cvt_pk_bf16_f32 v117, v74, v75
v_exp_f32 v77, v77
v_mfma_f32_32x32x16_bf16 a[80:95], a[208:211], v[124:127], a[80:95]
v_exp_f32 v78, v78
v_exp_f32 v79, v79
v_cvt_pk_bf16_f32 v118, v76, v77
v_cvt_pk_bf16_f32 v119, v78, v79
s_waitcnt lgkmcnt(1)
v_mfma_f32_32x32x16_bf16 v[64:79], a[168:171], a[128:131], v[48:63]
v_exp_f32 v80, v80
v_exp_f32 v81, v81
v_exp_f32 v82, v82
v_cvt_pk_bf16_f32 v120, v80, v81
v_mfma_f32_32x32x16_bf16 v[160:175], a[184:187], v[112:115], v[160:175]
v_exp_f32 v83, v83
v_exp_f32 v84, v84
v_cvt_pk_bf16_f32 v121, v82, v83
v_exp_f32 v85, v85
s_waitcnt lgkmcnt(0)
v_mfma_f32_32x32x16_bf16 v[64:79], a[172:175], a[132:135], v[64:79]
v_exp_f32 v86, v86
v_cvt_pk_bf16_f32 v122, v84, v85
v_exp_f32 v87, v87
v_exp_f32 v88, v88
v_mfma_f32_32x32x16_bf16 a[96:111], a[208:211], v[112:115], a[96:111]
s_cmp_lg_u32 s46, 2
s_cbranch_scc1 .LBc9
s_add_u32 s19, s39, 0
s_add_u32 m0, s47, 0
s_nop 0
buffer_load_dwordx4 v27, s[24:27], s19 offen offset:0 sc1 lds
buffer_load_dwordx4 v27, s[24:27], s19 offen offset:1024 sc1 lds
buffer_load_dwordx4 v27, s[24:27], s19 offen offset:2048 sc1 lds
buffer_load_dwordx4 v27, s[24:27], s19 offen offset:3072 sc1 lds
s_add_u32 s19, s39, 4096
s_add_u32 m0, s47, 4096
s_nop 0
buffer_load_dwordx4 v27, s[24:27], s19 offen offset:0 sc1 lds
buffer_load_dwordx4 v27, s[24:27], s19 offen offset:1024 sc1 lds
buffer_load_dwordx4 v27, s[24:27], s19 offen offset:2048 sc1 lds
buffer_load_dwordx4 v27, s[24:27], s19 offen offset:3072 sc1 lds
.LBc9:
v_cvt_pk_bf16_f32 v123, v86, v87
v_exp_f32 v89, v89
v_exp_f32 v90, v90
v_mfma_f32_32x32x16_bf16 v[160:175], a[188:191], v[116:119], v[160:175]
v_cvt_pk_bf16_f32 v124, v88, v89
v_exp_f32 v91, v91
v_exp_f32 v92, v92
v_cvt_pk_bf16_f32 v125, v90, v91
v_exp_f32 v93, v93
v_mfma_f32_32x32x16_bf16 a[96:111], a[208:211], v[116:119], a[96:111]
v_exp_f32 v94, v94
v_exp_f32 v95, v95
v_cvt_pk_bf16_f32 v126, v92, v93
v_cvt_pk_bf16_f32 v127, v94, v95
v_mfma_f32_32x32x16_bf16 v[80:95], a[168:171], a[136:139], v[48:63]
ds_read_b128 a[192:195], v29 offset:12288
v_exp_f32 v64, v64
v_exp_f32 v65, v65
v_exp_f32 v66, v66
v_cvt_pk_bf16_f32 v112, v64, v65
v_mfma_f32_32x32x16_bf16 v[176:191], a[184:187], v[120:123], v[176:191]
ds_read_b128 a[196:199], v29 offset:13312
v_exp_f32 v67, v67
v_exp_f32 v68, v68
v_cvt_pk_bf16_f32 v113, v66, v67
v_exp_f32 v69, v69
v_mfma_f32_32x32x16_bf16 v[80:95], a[172:175], a[140:143], v[80:95]
v_exp_f32 v70, v70
v_cvt_pk_bf16_f32 v114, v68, v69
v_exp_f32 v71, v71
v_exp_f32 v72, v72
v_mfma_f32_32x32x16_bf16 a[112:127], a[208:211], v[120:123], a[112:127]
s_cmp_lg_u32 s46, 3
s_cbranch_scc1 .LBc10
s_add_u32 s19, s39, 0
s_add_u32 m0, s47, 0
s_nop 0
buffer_load_dwordx4 v27, s[24:27], s19 offen offset:0 sc1 lds
buffer_load_dwordx4 v27, s[24:27], s19 offen offset:1024 sc1 lds
buffer_load_dwordx4 v27, s[24:27], s19 offen offset:2048 sc1 lds
buffer_load_dwordx4 v27, s[24:27], s19 offen offset:3072 sc1 lds
s_add_u32 s19, s39, 4096
s_add_u32 m0, s47, 4096
s_nop 0
buffer_load_dwordx4 v27, s[24:27], s19 offen offset:0 sc1 lds
buffer_load_dwordx4 v27, s[24:27], s19 offen offset:1024 sc1 lds
buffer_load_dwordx4 v27, s[24:27], s19 offen offset:2048 sc1 lds
buffer_load_dwordx4 v27, s[24:27], s19 offen offset:3072 sc1 lds
.LBc10:
v_cvt_pk_bf16_f32 v115, v70, v71
v_exp_f32 v73, v73
v_exp_f32 v74, v74
v_mfma_f32_32x32x16_bf16 v[176:191], a[188:191], v[124:127], v[176:191]
v_cvt_pk_bf16_f32 v116, v72, v73
v_exp_f32 v75, v75
v_exp_f32 v76, v76
v_cvt_pk_bf16_f32 v117, v74, v75
v_exp_f32 v77, v77
v_mfma_f32_32x32x16_bf16 a[112:127], a[208:211], v[124:127], a[112:127]
v_exp_f32 v78, v78
v_exp_f32 v79, v79
v_cvt_pk_bf16_f32 v118, v76, v77
v_cvt_pk_bf16_f32 v119, v78, v79
v_mfma_f32_32x32x16_bf16 v[64:79], a[168:171], a[144:147], v[48:63]
ds_read_b128 a[160:163], v28 offset:28672
v_exp_f32 v80, v80
v_exp_f32 v81, v81
v_exp_f32 v82, v82
v_cvt_pk_bf16_f32 v120, v80, v81
s_waitcnt lgkmcnt(2)
v_mfma_f32_32x32x16_bf16 v[128:143], a[192:195], v[112:115], v[128:143]
ds_read_b128 a[164:167], v28 offset:29696
v_exp_f32 v83, v83
v_exp_f32 v84, v84
v_cvt_pk_bf16_f32 v121, v82, v83
v_exp_f32 v85, v85
v_mfma_f32_32x32x16_bf16 v[64:79], a[172:175], a[148:151], v[64:79]
ds_read_b128 a[176:179], v28 offset:12288
v_exp_f32 v86, v86
v_cvt_pk_bf16_f32 v122, v84, v85
v_exp_f32 v87, v87
v_exp_f32 v88, v88
v_mfma_f32_32x32x16_bf16 a[64:79], a[208:211], v[112:115], a[64:79]
ds_read_b128 a[180:183], v28 offset:13312
v_cvt_pk_bf16_f32 v123, v86, v87
v_exp_f32 v89, v89
v_exp_f32 v90, v90
v_cvt_pk_bf16_f32 v124, v88, v89
s_waitcnt lgkmcnt(4)
v_mfma_f32_32x32x16_bf16 v[128:143], a[196:199], v[116:119], v[128:143]
v_exp_f32 v91, v91
v_exp_f32 v92, v92
v_cvt_pk_bf16_f32 v125, v90, v91
v_exp_f32 v93, v93
v_mfma_f32_32x32x16_bf16 a[64:79], a[208:211], v[116:119], a[64:79]
v_exp_f32 v94, v94
v_exp_f32 v95, v95
v_cvt_pk_bf16_f32 v126, v92, v93
v_cvt_pk_bf16_f32 v127, v94, v95
s_waitcnt lgkmcnt(3)
v_mfma_f32_32x32x16_bf16 v[80:95], a[160:163], a[152:155], 0
ds_read_b128 a[168:171], v28 offset:10240
v_exp_f32 v64, v64
v_exp_f32 v65, v65
v_exp_f32 v66, v66
v_mfma_f32_32x32x16_bf16 v[144:159], a[192:195], v[120:123], v[144:159]
ds_read_b128 a[172:175], v28 offset:11264
v_cvt_pk_bf16_f32 v112, v64, v65
v_exp_f32 v67, v67
v_exp_f32 v68, v68
s_waitcnt lgkmcnt(4)
v_mfma_f32_32x32x16_bf16 v[80:95], a[164:167], a[156:159], v[80:95]
v_cvt_pk_bf16_f32 v113, v66, v67
v_exp_f32 v69, v69
v_exp_f32 v70, v70
v_mfma_f32_32x32x16_bf16 a[80:95], a[208:211], v[120:123], a[80:95]
v_cvt_pk_bf16_f32 v114, v68, v69
v_exp_f32 v71, v71
v_exp_f32 v72, v72
s_waitcnt lgkmcnt(3)
v_mfma_f32_32x32x16_bf16 v[96:111], a[176:179], a[152:155], v[48:63]
v_cvt_pk_bf16_f32 v115, v70, v71
v_exp_f32 v73, v73
v_exp_f32 v74, v74
v_mfma_f32_32x32x16_bf16 v[144:159], a[196:199], v[124:127], v[144:159]
v_cvt_pk_bf16_f32 v116, v72, v73
v_exp_f32 v75, v75
v_exp_f32 v76, v76
s_waitcnt lgkmcnt(2)
v_mfma_f32_32x32x16_bf16 v[96:111], a[180:183], a[156:159], v[96:111]
v_cvt_pk_bf16_f32 v117, v74, v75
v_exp_f32 v77, v77
v_exp_f32 v78, v78
v_mfma_f32_32x32x16_bf16 a[80:95], a[208:211], v[124:127], a[80:95]
v_exp_f32 v79, v79
v_cvt_pk_bf16_f32 v118, v76, v77
v_cvt_pk_bf16_f32 v119, v78, v79
s_waitcnt lgkmcnt(1)
v_mfma_f32_32x32x16_bf16 v[64:79], a[168:171], a[128:131], v[48:63]
ds_read_b128 a[184:187], v29 offset:28672
s_nop 1
v_cndmask_b32 v80, v96, v80, s[64:65]
v_cndmask_b32 v81, v97, v81, s[66:67]
v_cndmask_b32 v82, v98, v82, s[68:69]
v_cndmask_b32 v83, v99, v83, s[70:71]
v_cndmask_b32 v84, v100, v84, s[72:73]
v_cndmask_b32 v85, v101, v85, s[74:75]
v_cndmask_b32 v86, v102, v86, s[76:77]
v_cndmask_b32 v87, v103, v87, s[78:79]
v_cndmask_b32 v88, v104, v88, s[80:81]
v_cndmask_b32 v89, v105, v89, s[82:83]
v_mfma_f32_32x32x16_bf16 v[160:175], a[192:195], v[112:115], v[160:175]
ds_read_b128 a[188:191], v29 offset:29696
v_cndmask_b32 v90, v106, v90, s[84:85]
v_cndmask_b32 v91, v107, v91, s[86:87]
v_cndmask_b32 v92, v108, v92, s[88:89]
v_cndmask_b32 v93, v109, v93, s[90:91]
v_cndmask_b32 v94, v110, v94, s[92:93]
v_cndmask_b32 v95, v111, v95, s[94:95]
v_exp_f32 v80, v80
v_exp_f32 v81, v81
v_exp_f32 v82, v82
v_cvt_pk_bf16_f32 v120, v80, v81
s_waitcnt lgkmcnt(2)
v_mfma_f32_32x32x16_bf16 v[64:79], a[172:175], a[132:135], v[64:79]
ds_read_b128 a[200:203], v29 offset:12288
v_exp_f32 v83, v83
v_exp_f32 v84, v84
v_cvt_pk_bf16_f32 v121, v82, v83
v_exp_f32 v85, v85
v_exp_f32 v86, v86
v_cvt_pk_bf16_f32 v122, v84, v85
v_exp_f32 v87, v87
v_mfma_f32_32x32x16_bf16 a[96:111], a[208:211], v[112:115], a[96:111]
ds_read_b128 a[204:207], v29 offset:13312
v_exp_f32 v88, v88
v_cvt_pk_bf16_f32 v123, v86, v87
v_exp_f32 v89, v89
v_exp_f32 v90, v90
v_cvt_pk_bf16_f32 v124, v88, v89
v_exp_f32 v91, v91
v_exp_f32 v92, v92
v_mfma_f32_32x32x16_bf16 v[160:175], a[196:199], v[116:119], v[160:175]
v_cvt_pk_bf16_f32 v125, v90, v91
v_exp_f32 v93, v93
v_exp_f32 v94, v94
v_exp_f32 v95, v95
v_cvt_pk_bf16_f32 v126, v92, v93
v_cvt_pk_bf16_f32 v127, v94, v95
v_and_b32 v216, v16, v120
v_bfi_b32 v192, v16, 0, v120
v_and_b32 v217, v17, v121
v_bfi_b32 v193, v17, 0, v121
v_mfma_f32_32x32x16_bf16 a[96:111], a[208:211], v[116:119], a[96:111]
v_and_b32 v218, v18, v122
v_bfi_b32 v194, v18, 0, v122
v_and_b32 v219, v19, v123
v_bfi_b32 v195, v19, 0, v123
v_and_b32 v220, v20, v124
v_bfi_b32 v196, v20, 0, v124
v_and_b32 v221, v21, v125
v_bfi_b32 v197, v21, 0, v125
v_and_b32 v222, v22, v126
v_bfi_b32 v198, v22, 0, v126
v_and_b32 v223, v23, v127
v_bfi_b32 v199, v23, 0, v127
v_mfma_f32_32x32x16_bf16 v[80:95], a[168:171], a[136:139], v[48:63]
ds_read_b128 a[192:195], v29 offset:10240
v_exp_f32 v64, v64
v_exp_f32 v65, v65
v_exp_f32 v66, v66
s_waitcnt lgkmcnt(4)
v_mfma_f32_32x32x16_bf16 v[176:191], a[184:187], v[216:219], v[176:191]
ds_read_b128 a[196:199], v29 offset:11264
v_cvt_pk_bf16_f32 v112, v64, v65
v_exp_f32 v67, v67
v_exp_f32 v68, v68
v_mfma_f32_32x32x16_bf16 v[80:95], a[172:175], a[140:143], v[80:95]
v_cvt_pk_bf16_f32 v113, v66, v67
v_exp_f32 v69, v69
v_exp_f32 v70, v70
v_mfma_f32_32x32x16_bf16 a[112:127], a[208:211], v[120:123], a[112:127]
v_cvt_pk_bf16_f32 v114, v68, v69
v_exp_f32 v71, v71
v_exp_f32 v72, v72
s_waitcnt lgkmcnt(4)
v_mfma_f32_32x32x16_bf16 v[176:191], a[188:191], v[220:223], v[176:191]
v_cvt_pk_bf16_f32 v115, v70, v71
v_exp_f32 v73, v73
v_exp_f32 v74, v74
v_mfma_f32_32x32x16_bf16 a[112:127], a[208:211], v[124:127], a[112:127]
v_cvt_pk_bf16_f32 v116, v72, v73
v_exp_f32 v75, v75
v_exp_f32 v76, v76
s_waitcnt lgkmcnt(3)
v_mfma_f32_32x32x16_bf16 v[176:191], a[200:203], v[192:195], v[176:191]
v_cvt_pk_bf16_f32 v117, v74, v75
v_exp_f32 v77, v77
v_exp_f32 v78, v78
s_waitcnt lgkmcnt(2)
v_mfma_f32_32x32x16_bf16 v[176:191], a[204:207], v[196:199], v[176:191]
v_exp_f32 v79, v79
v_cvt_pk_bf16_f32 v118, v76, v77
v_cvt_pk_bf16_f32 v119, v78, v79
v_mfma_f32_32x32x16_bf16 v[64:79], a[168:171], a[144:147], v[48:63]
ds_read_b128 a[160:163], v28 offset:8192
v_exp_f32 v80, v80
v_exp_f32 v81, v81
v_exp_f32 v82, v82
v_cvt_pk_bf16_f32 v120, v80, v81
v_exp_f32 v83, v83
v_exp_f32 v84, v84
v_cvt_pk_bf16_f32 v121, v82, v83
v_exp_f32 v85, v85
s_waitcnt lgkmcnt(2)
v_mfma_f32_32x32x16_bf16 v[128:143], a[192:195], v[112:115], v[128:143]
ds_read_b128 a[164:167], v28 offset:9216
v_exp_f32 v86, v86
v_cvt_pk_bf16_f32 v122, v84, v85
v_exp_f32 v87, v87
v_exp_f32 v88, v88
v_cvt_pk_bf16_f32 v123, v86, v87
v_exp_f32 v89, v89
v_exp_f32 v90, v90
v_cvt_pk_bf16_f32 v124, v88, v89
v_exp_f32 v91, v91
v_mfma_f32_32x32x16_bf16 v[64:79], a[172:175], a[148:151], v[64:79]
v_exp_f32 v92, v92
v_cvt_pk_bf16_f32 v125, v90, v91
v_exp_f32 v93, v93
v_exp_f32 v94, v94
v_exp_f32 v95, v95
v_cvt_pk_bf16_f32 v126, v92, v93
v_cvt_pk_bf16_f32 v127, v94, v95
v_accvgpr_read_b32 v200, a112
v_mov_b32 v203, 0x7f7fffff
v_cmp_nle_f32 vcc, s98, v200
v_mfma_f32_32x32x16_bf16 a[64:79], a[208:211], v[112:115], a[64:79]
v_rcp_f32 v201, v200
v_cmp_nge_f32 s[20:21], s99, v200
s_or_b64 s[100:101], s[20:21], vcc
v_mul_f32 v176, v176, v201
v_mul_f32 v177, v177, v201
v_mul_f32 v178, v178, v201
v_mul_f32 v179, v179, v201
v_mul_f32 v180, v180, v201
v_mul_f32 v181, v181, v201
v_mul_f32 v182, v182, v201
v_mul_f32 v183, v183, v201
v_mul_f32 v184, v184, v201
v_mul_f32 v185, v185, v201
s_waitcnt lgkmcnt(2)
v_mfma_f32_32x32x16_bf16 v[128:143], a[196:199], v[116:119], v[128:143]
v_mul_f32 v186, v186, v201
v_mul_f32 v187, v187, v201
v_mul_f32 v188, v188, v201
v_mul_f32 v189, v189, v201
v_mul_f32 v190, v190, v201
v_mul_f32 v191, v191, v201
v_max3_f32 v202, abs(v176), abs(v177), abs(v178)
v_max3_f32 v202, v202, abs(v179), abs(v180)
v_max3_f32 v202, v202, abs(v181), abs(v182)
v_max3_f32 v202, v202, abs(v183), abs(v184)
v_max3_f32 v202, v202, abs(v185), abs(v186)
v_max3_f32 v202, v202, abs(v187), abs(v188)
v_max3_f32 v202, v202, abs(v189), abs(v190)
v_max_f32 v202, v202, abs(v191)
v_cvt_pk_bf16_f32 v204, v176, v177
v_mfma_f32_32x32x16_bf16 a[64:79], a[208:211], v[116:119], a[64:79]
v_cvt_pk_bf16_f32 v205, v178, v179
v_cvt_pk_bf16_f32 v206, v184, v185
v_cvt_pk_bf16_f32 v207, v186, v187
v_cvt_pk_bf16_f32 v208, v180, v181
v_cvt_pk_bf16_f32 v209, v182, v183
v_cvt_pk_bf16_f32 v210, v188, v189
v_cvt_pk_bf16_f32 v211, v190, v191
v_cmp_nle_f32 vcc, v202, v203
s_add_u32 s21, s97, 393216
s_or_b64 s[100:101], s[100:101], vcc
buffer_store_dwordx4 v[204:207], v30, s[12:15], s21 offen sc1
buffer_store_dwordx4 v[208:211], v30, s[12:15], s21 offen offset:512 sc1
s_cmp_lg_u64 s[100:101], 0
s_cselect_b32 s96, 1, s96
s_waitcnt lgkmcnt(1)
v_mfma_f32_32x32x16_bf16 v[80:95], a[160:163], a[128:131], v[48:63]
v_exp_f32 v64, v64
v_exp_f32 v65, v65
v_exp_f32 v66, v66
v_cvt_pk_bf16_f32 v112, v64, v65
v_mfma_f32_32x32x16_bf16 v[144:159], a[192:195], v[120:123], v[144:159]
v_exp_f32 v67, v67
v_exp_f32 v68, v68
v_cvt_pk_bf16_f32 v113, v66, v67
v_exp_f32 v69, v69
s_waitcnt lgkmcnt(0)
v_mfma_f32_32x32x16_bf16 v[80:95], a[164:167], a[132:135], v[80:95]
v_exp_f32 v70, v70
v_cvt_pk_bf16_f32 v114, v68, v69
v_exp_f32 v71, v71
v_exp_f32 v72, v72
v_mfma_f32_32x32x16_bf16 a[80:95], a[208:211], v[120:123], a[80:95]
v_cvt_pk_bf16_f32 v115, v70, v71
v_exp_f32 v73, v73
v_exp_f32 v74, v74
v_cvt_pk_bf16_f32 v116, v72, v73
v_mfma_f32_32x32x16_bf16 v[144:159], a[196:199], v[124:127], v[144:159]
v_exp_f32 v75, v75
v_exp_f32 v76, v76
v_cvt_pk_bf16_f32 v117, v74, v75
v_exp_f32 v77, v77
v_mfma_f32_32x32x16_bf16 a[80:95], a[208:211], v[124:127], a[80:95]
v_exp_f32 v78, v78
v_exp_f32 v79, v79
v_cvt_pk_bf16_f32 v118, v76, v77
v_cvt_pk_bf16_f32 v119, v78, v79
v_mfma_f32_32x32x16_bf16 v[64:79], a[160:163], a[136:139], v[48:63]
ds_read_b128 a[168:171], v28 offset:24576
v_exp_f32 v80, v80
v_exp_f32 v81, v81
v_exp_f32 v82, v82
v_cvt_pk_bf16_f32 v120, v80, v81
v_mfma_f32_32x32x16_bf16 v[160:175], a[192:195], v[112:115], v[160:175]
ds_read_b128 a[172:175], v28 offset:25600
v_exp_f32 v83, v83
v_exp_f32 v84, v84
v_cvt_pk_bf16_f32 v121, v82, v83
v_exp_f32 v85, v85
v_mfma_f32_32x32x16_bf16 v[64:79], a[164:167], a[140:143], v[64:79]
ds_read_b128 a[176:179], v28 offset:8192
v_exp_f32 v86, v86
v_cvt_pk_bf16_f32 v122, v84, v85
v_exp_f32 v87, v87
v_exp_f32 v88, v88
v_mfma_f32_32x32x16_bf16 a[96:111], a[208:211], v[112:115], a[96:111]
ds_read_b128 a[180:183], v28 offset:9216
v_cvt_pk_bf16_f32 v123, v86, v87
v_exp_f32 v89, v89
v_exp_f32 v90, v90
v_cvt_pk_bf16_f32 v124, v88, v89
v_mfma_f32_32x32x16_bf16 v[160:175], a[196:199], v[116:119], v[160:175]
ds_read_b128 a[184:187], v29 offset:8192
v_exp_f32 v91, v91
v_exp_f32 v92, v92
v_cvt_pk_bf16_f32 v125, v90, v91
v_exp_f32 v93, v93
v_mfma_f32_32x32x16_bf16 a[96:111], a[208:211], v[116:119], a[96:111]
ds_read_b128 a[188:191], v29 offset:9216
v_exp_f32 v94, v94
v_exp_f32 v95, v95
v_cvt_pk_bf16_f32 v126, v92, v93
v_cvt_pk_bf16_f32 v127, v94, v95
s_waitcnt vmcnt(0)
s_barrier
s_waitcnt lgkmcnt(5)
v_mfma_f32_32x32x16_bf16 v[80:95], a[168:171], a[144:147], 0
ds_read_b128 a[160:163], v28 offset:6144
v_exp_f32 v64, v64
v_exp_f32 v65, v65
v_exp_f32 v66, v66
s_waitcnt lgkmcnt(2)
v_mfma_f32_32x32x16_bf16 v[128:143], a[184:187], v[120:123], v[128:143]
ds_read_b128 a[164:167], v28 offset:7168
v_cvt_pk_bf16_f32 v112, v64, v65
v_exp_f32 v67, v67
v_exp_f32 v68, v68
v_mfma_f32_32x32x16_bf16 v[80:95], a[172:175], a[148:151], v[80:95]
v_cvt_pk_bf16_f32 v113, v66, v67
v_exp_f32 v69, v69
v_exp_f32 v70, v70
v_mfma_f32_32x32x16_bf16 a[64:79], a[208:211], v[120:123], a[64:79]
v_cvt_pk_bf16_f32 v114, v68, v69
v_exp_f32 v71, v71
v_exp_f32 v72, v72
v_mfma_f32_32x32x16_bf16 v[96:111], a[176:179], a[144:147], v[48:63]
v_cvt_pk_bf16_f32 v115, v70, v71
v_exp_f32 v73, v73
v_exp_f32 v74, v74
s_waitcnt lgkmcnt(2)
v_mfma_f32_32x32x16_bf16 v[128:143], a[188:191], v[124:127], v[128:143]
v_cvt_pk_bf16_f32 v116, v72, v73
v_exp_f32 v75, v75
v_exp_f32 v76, v76
v_mfma_f32_32x32x16_bf16 v[96:111], a[180:183], a[148:151], v[96:111]
v_cvt_pk_bf16_f32 v117, v74, v75
v_exp_f32 v77, v77
v_exp_f32 v78, v78
v_mfma_f32_32x32x16_bf16 a[64:79], a[208:211], v[124:127], a[64:79]
v_exp_f32 v79, v79
v_cvt_pk_bf16_f32 v118, v76, v77
v_cvt_pk_bf16_f32 v119, v78, v79
s_waitcnt lgkmcnt(1)
v_mfma_f32_32x32x16_bf16 v[64:79], a[160:163], a[128:131], v[48:63]
ds_read_b128 a[192:195], v29 offset:24576
s_nop 1
v_cndmask_b32 v80, v96, v80, s[64:65]
v_cndmask_b32 v81, v97, v81, s[66:67]
v_cndmask_b32 v82, v98, v82, s[68:69]
v_cndmask_b32 v83, v99, v83, s[70:71]
v_cndmask_b32 v84, v100, v84, s[72:73]
v_cndmask_b32 v85, v101, v85, s[74:75]
v_cndmask_b32 v86, v102, v86, s[76:77]
v_cndmask_b32 v87, v103, v87, s[78:79]
v_cndmask_b32 v88, v104, v88, s[80:81]
v_cndmask_b32 v89, v105, v89, s[82:83]
v_mfma_f32_32x32x16_bf16 v[144:159], a[184:187], v[112:115], v[144:159]
ds_read_b128 a[196:199], v29 offset:25600
v_cndmask_b32 v90, v106, v90, s[84:85]
v_cndmask_b32 v91, v107, v91, s[86:87]
v_cndmask_b32 v92, v108, v92, s[88:89]
v_cndmask_b32 v93, v109, v93, s[90:91]
v_cndmask_b32 v94, v110, v94, s[92:93]
v_cndmask_b32 v95, v111, v95, s[94:95]
v_exp_f32 v80, v80
v_exp_f32 v81, v81
v_exp_f32 v82, v82
v_cvt_pk_bf16_f32 v120, v80, v81
s_waitcnt lgkmcnt(2)
v_mfma_f32_32x32x16_bf16 v[64:79], a[164:167], a[132:135], v[64:79]
ds_read_b128 a[200:203], v29 offset:8192
v_exp_f32 v83, v83
v_exp_f32 v84, v84
v_cvt_pk_bf16_f32 v121, v82, v83
v_exp_f32 v85, v85
v_exp_f32 v86, v86
v_cvt_pk_bf16_f32 v122, v84, v85
v_exp_f32 v87, v87
v_mfma_f32_32x32x16_bf16 a[80:95], a[208:211], v[112:115], a[80:95]
ds_read_b128 a[204:207], v29 offset:9216
v_exp_f32 v88, v88
v_cvt_pk_bf16_f32 v123, v86, v87
v_exp_f32 v89, v89
v_exp_f32 v90, v90
v_cvt_pk_bf16_f32 v124, v88, v89
v_exp_f32 v91, v91
v_exp_f32 v92, v92
v_mfma_f32_32x32x16_bf16 v[144:159], a[188:191], v[116:119], v[144:159]
v_cvt_pk_bf16_f32 v125, v90, v91
v_exp_f32 v93, v93
v_exp_f32 v94, v94
v_exp_f32 v95, v95
v_cvt_pk_bf16_f32 v126, v92, v93
v_cvt_pk_bf16_f32 v127, v94, v95
v_and_b32 v216, v16, v120
v_bfi_b32 v192, v16, 0, v120
v_and_b32 v217, v17, v121
v_bfi_b32 v193, v17, 0, v121
v_mfma_f32_32x32x16_bf16 a[80:95], a[208:211], v[116:119], a[80:95]
v_and_b32 v218, v18, v122
v_bfi_b32 v194, v18, 0, v122
v_and_b32 v219, v19, v123
v_bfi_b32 v195, v19, 0, v123
v_and_b32 v220, v20, v124
v_bfi_b32 v196, v20, 0, v124
v_and_b32 v221, v21, v125
v_bfi_b32 v197, v21, 0, v125
v_and_b32 v222, v22, v126
v_bfi_b32 v198, v22, 0, v126
v_and_b32 v223, v23, v127
v_bfi_b32 v199, v23, 0, v127
v_mfma_f32_32x32x16_bf16 v[80:95], a[160:163], a[136:139], v[48:63]
ds_read_b128 a[168:171], v28 offset:4096
v_exp_f32 v64, v64
v_exp_f32 v65, v65
v_exp_f32 v66, v66
s_waitcnt lgkmcnt(4)
v_mfma_f32_32x32x16_bf16 v[160:175], a[192:195], v[216:219], v[160:175]
ds_read_b128 a[172:175], v28 offset:5120
v_cvt_pk_bf16_f32 v112, v64, v65
v_exp_f32 v67, v67
v_exp_f32 v68, v68
v_mfma_f32_32x32x16_bf16 v[80:95], a[164:167], a[140:143], v[80:95]
ds_read_b128 a[184:187], v29 offset:6144
v_cvt_pk_bf16_f32 v113, v66, v67
v_exp_f32 v69, v69
v_exp_f32 v70, v70
v_mfma_f32_32x32x16_bf16 a[96:111], a[208:211], v[120:123], a[96:111]
ds_read_b128 a[188:191], v29 offset:7168
v_cvt_pk_bf16_f32 v114, v68, v69
v_exp_f32 v71, v71
v_exp_f32 v72, v72
s_waitcnt lgkmcnt(6)
v_mfma_f32_32x32x16_bf16 v[160:175], a[196:199], v[220:223], v[160:175]
v_cvt_pk_bf16_f32 v115, v70, v71
v_exp_f32 v73, v73
v_exp_f32 v74, v74
v_mfma_f32_32x32x16_bf16 a[96:111], a[208:211], v[124:127], a[96:111]
v_cvt_pk_bf16_f32 v116, v72, v73
v_exp_f32 v75, v75
v_exp_f32 v76, v76
s_waitcnt lgkmcnt(5)
v_mfma_f32_32x32x16_bf16 v[160:175], a[200:203], v[192:195], v[160:175]
v_cvt_pk_bf16_f32 v117, v74, v75
v_exp_f32 v77, v77
v_exp_f32 v78, v78
s_waitcnt lgkmcnt(4)
v_mfma_f32_32x32x16_bf16 v[160:175], a[204:207], v[196:199], v[160:175]
v_exp_f32 v79, v79
v_cvt_pk_bf16_f32 v118, v76, v77
v_cvt_pk_bf16_f32 v119, v78, v79
s_waitcnt lgkmcnt(3)
v_mfma_f32_32x32x16_bf16 v[64:79], a[168:171], a[128:131], v[48:63]
ds_read_b128 a[160:163], v28 offset:20480
v_exp_f32 v80, v80
v_exp_f32 v81, v81
v_exp_f32 v82, v82
v_cvt_pk_bf16_f32 v120, v80, v81
v_exp_f32 v83, v83
v_exp_f32 v84, v84
v_cvt_pk_bf16_f32 v121, v82, v83
v_exp_f32 v85, v85
s_waitcnt lgkmcnt(2)
v_mfma_f32_32x32x16_bf16 v[128:143], a[184:187], v[112:115], v[128:143]
ds_read_b128 a[164:167], v28 offset:21504
v_exp_f32 v86, v86
v_cvt_pk_bf16_f32 v122, v84, v85
v_exp_f32 v87, v87
v_exp_f32 v88, v88
v_cvt_pk_bf16_f32 v123, v86, v87
v_exp_f32 v89, v89
v_exp_f32 v90, v90
v_cvt_pk_bf16_f32 v124, v88, v89
v_exp_f32 v91, v91
v_mfma_f32_32x32x16_bf16 v[64:79], a[172:175], a[132:135], v[64:79]
ds_read_b128 a[176:179], v28 offset:4096
v_exp_f32 v92, v92
v_cvt_pk_bf16_f32 v125, v90, v91
v_exp_f32 v93, v93
v_exp_f32 v94, v94
v_exp_f32 v95, v95
v_cvt_pk_bf16_f32 v126, v92, v93
v_cvt_pk_bf16_f32 v127, v94, v95
v_accvgpr_read_b32 v200, a96
v_mov_b32 v203, 0x7f7fffff
v_cmp_nle_f32 vcc, s98, v200
v_mfma_f32_32x32x16_bf16 a[64:79], a[208:211], v[112:115], a[64:79]
ds_read_b128 a[180:183], v28 offset:5120
v_rcp_f32 v201, v200
v_cmp_nge_f32 s[20:21], s99, v200
s_or_b64 s[100:101], s[20:21], vcc
v_mul_f32 v160, v160, v201
v_mul_f32 v161, v161, v201
v_mul_f32 v162, v162, v201
v_mul_f32 v163, v163, v201
v_mul_f32 v164, v164, v201
v_mul_f32 v165, v165, v201
v_mul_f32 v166, v166, v201
v_mul_f32 v167, v167, v201
v_mul_f32 v168, v168, v201
v_mul_f32 v169, v169, v201
s_waitcnt lgkmcnt(4)
v_mfma_f32_32x32x16_bf16 v[128:143], a[188:191], v[116:119], v[128:143]
v_mul_f32 v170, v170, v201
v_mul_f32 v171, v171, v201
v_mul_f32 v172, v172, v201
v_mul_f32 v173, v173, v201
v_mul_f32 v174, v174, v201
v_mul_f32 v175, v175, v201
v_max3_f32 v202, abs(v160), abs(v161), abs(v162)
v_max3_f32 v202, v202, abs(v163), abs(v164)
v_max3_f32 v202, v202, abs(v165), abs(v166)
v_max3_f32 v202, v202, abs(v167), abs(v168)
v_max3_f32 v202, v202, abs(v169), abs(v170)
v_max3_f32 v202, v202, abs(v171), abs(v172)
v_max3_f32 v202, v202, abs(v173), abs(v174)
v_max_f32 v202, v202, abs(v175)
v_cvt_pk_bf16_f32 v204, v160, v161
v_mfma_f32_32x32x16_bf16 a[64:79], a[208:211], v[116:119], a[64:79]
v_cvt_pk_bf16_f32 v205, v162, v163
v_cvt_pk_bf16_f32 v206, v168, v169
v_cvt_pk_bf16_f32 v207, v170, v171
v_cvt_pk_bf16_f32 v208, v164, v165
v_cvt_pk_bf16_f32 v209, v166, v167
v_cvt_pk_bf16_f32 v210, v172, v173
v_cvt_pk_bf16_f32 v211, v174, v175
v_cmp_nle_f32 vcc, v202, v203
s_add_u32 s21, s97, 262144
s_or_b64 s[100:101], s[100:101], vcc
buffer_store_dwordx4 v[204:207], v30, s[12:15], s21 offen sc1
buffer_store_dwordx4 v[208:211], v30, s[12:15], s21 offen offset:512 sc1
s_cmp_lg_u64 s[100:101], 0
s_cselect_b32 s96, 1, s96
s_waitcnt lgkmcnt(3)
v_mfma_f32_32x32x16_bf16 v[80:95], a[160:163], a[136:139], 0
ds_read_b128 a[168:171], v28 offset:2048
v_exp_f32 v64, v64
v_exp_f32 v65, v65
v_exp_f32 v66, v66
v_mfma_f32_32x32x16_bf16 v[144:159], a[184:187], v[120:123], v[144:159]
ds_read_b128 a[172:175], v28 offset:3072
v_cvt_pk_bf16_f32 v112, v64, v65
v_exp_f32 v67, v67
v_exp_f32 v68, v68
s_waitcnt lgkmcnt(4)
v_mfma_f32_32x32x16_bf16 v[80:95], a[164:167], a[140:143], v[80:95]
ds_read_b128 a[192:195], v29 offset:4096
v_cvt_pk_bf16_f32 v113, v66, v67
v_exp_f32 v69, v69
v_exp_f32 v70, v70
v_mfma_f32_32x32x16_bf16 a[80:95], a[208:211], v[120:123], a[80:95]
ds_read_b128 a[196:199], v29 offset:5120
v_cvt_pk_bf16_f32 v114, v68, v69
v_exp_f32 v71, v71
v_exp_f32 v72, v72
s_waitcnt lgkmcnt(5)
v_mfma_f32_32x32x16_bf16 v[96:111], a[176:179], a[136:139], v[48:63]
v_cvt_pk_bf16_f32 v115, v70, v71
v_exp_f32 v73, v73
v_exp_f32 v74, v74
v_mfma_f32_32x32x16_bf16 v[144:159], a[188:191], v[124:127], v[144:159]
v_cvt_pk_bf16_f32 v116, v72, v73
v_exp_f32 v75, v75
v_exp_f32 v76, v76
s_waitcnt lgkmcnt(4)
v_mfma_f32_32x32x16_bf16 v[96:111], a[180:183], a[140:143], v[96:111]
v_cvt_pk_bf16_f32 v117, v74, v75
v_exp_f32 v77, v77
v_exp_f32 v78, v78
v_mfma_f32_32x32x16_bf16 a[80:95], a[208:211], v[124:127], a[80:95]
v_exp_f32 v79, v79
v_cvt_pk_bf16_f32 v118, v76, v77
v_cvt_pk_bf16_f32 v119, v78, v79
s_waitcnt lgkmcnt(3)
v_mfma_f32_32x32x16_bf16 v[64:79], a[168:171], a[128:131], v[48:63]
ds_read_b128 a[160:163], v28 offset:16384
ds_read_b128 a[164:167], v28 offset:17408
s_nop 1
v_cndmask_b32 v80, v96, v80, s[64:65]
v_cndmask_b32 v81, v97, v81, s[66:67]
v_cndmask_b32 v82, v98, v82, s[68:69]
v_cndmask_b32 v83, v99, v83, s[70:71]
v_cndmask_b32 v84, v100, v84, s[72:73]
v_cndmask_b32 v85, v101, v85, s[74:75]
v_cndmask_b32 v86, v102, v86, s[76:77]
v_cndmask_b32 v87, v103, v87, s[78:79]
v_cndmask_b32 v88, v104, v88, s[80:81]
v_cndmask_b32 v89, v105, v89, s[82:83]
s_waitcnt lgkmcnt(3)
v_mfma_f32_32x32x16_bf16 v[128:143], a[192:195], v[112:115], v[128:143]
ds_read_b128 a[176:179], v28 offset:0
ds_read_b128 a[180:183], v28 offset:1024
v_cndmask_b32 v90, v106, v90, s[84:85]
v_cndmask_b32 v91, v107, v91, s[86:87]
v_cndmask_b32 v92, v108, v92, s[88:89]
v_cndmask_b32 v93, v109, v93, s[90:91]
v_cndmask_b32 v94, v110, v94, s[92:93]
v_cndmask_b32 v95, v111, v95, s[94:95]
v_exp_f32 v80, v80
v_exp_f32 v81, v81
v_exp_f32 v82, v82
v_cvt_pk_bf16_f32 v120, v80, v81
v_mfma_f32_32x32x16_bf16 v[64:79], a[172:175], a[132:135], v[64:79]
ds_read_b128 a[184:187], v29 offset:20480
v_exp_f32 v83, v83
v_exp_f32 v84, v84
v_cvt_pk_bf16_f32 v121, v82, v83
v_exp_f32 v85, v85
v_exp_f32 v86, v86
v_cvt_pk_bf16_f32 v122, v84, v85
v_exp_f32 v87, v87
v_mfma_f32_32x32x16_bf16 a[64:79], a[208:211], v[112:115], a[64:79]
ds_read_b128 a[188:191], v29 offset:21504
v_exp_f32 v88, v88
v_cvt_pk_bf16_f32 v123, v86, v87
v_exp_f32 v89, v89
v_exp_f32 v90, v90
v_cvt_pk_bf16_f32 v124, v88, v89
v_exp_f32 v91, v91
v_exp_f32 v92, v92
s_waitcnt lgkmcnt(6)
v_mfma_f32_32x32x16_bf16 v[128:143], a[196:199], v[116:119], v[128:143]
ds_read_b128 a[200:203], v29 offset:4096
v_cvt_pk_bf16_f32 v125, v90, v91
v_exp_f32 v93, v93
v_exp_f32 v94, v94
v_exp_f32 v95, v95
v_cvt_pk_bf16_f32 v126, v92, v93
v_cvt_pk_bf16_f32 v127, v94, v95
v_and_b32 v216, v16, v120
v_bfi_b32 v192, v16, 0, v120
v_and_b32 v217, v17, v121
v_bfi_b32 v193, v17, 0, v121
v_mfma_f32_32x32x16_bf16 a[64:79], a[208:211], v[116:119], a[64:79]
ds_read_b128 a[204:207], v29 offset:5120
v_and_b32 v218, v18, v122
v_bfi_b32 v194, v18, 0, v122
v_and_b32 v219, v19, v123
v_bfi_b32 v195, v19, 0, v123
v_and_b32 v220, v20, v124
v_bfi_b32 v196, v20, 0, v124
v_and_b32 v221, v21, v125
v_bfi_b32 v197, v21, 0, v125
v_and_b32 v222, v22, v126
v_bfi_b32 v198, v22, 0, v126
v_and_b32 v223, v23, v127
v_bfi_b32 v199, v23, 0, v127
s_waitcnt lgkmcnt(7)
v_mfma_f32_32x32x16_bf16 v[80:95], a[160:163], a[128:131], 0
ds_read_b128 a[192:195], v29 offset:2048
v_exp_f32 v64, v64
v_exp_f32 v65, v65
s_waitcnt lgkmcnt(4)
v_mfma_f32_32x32x16_bf16 v[144:159], a[184:187], v[216:219], v[144:159]
ds_read_b128 a[196:199], v29 offset:3072
v_exp_f32 v66, v66
v_cvt_pk_bf16_f32 v112, v64, v65
v_exp_f32 v67, v67
v_mfma_f32_32x32x16_bf16 v[80:95], a[164:167], a[132:135], v[80:95]
v_exp_f32 v68, v68
v_cvt_pk_bf16_f32 v113, v66, v67
v_mfma_f32_32x32x16_bf16 a[80:95], a[208:211], v[120:123], a[80:95]
v_exp_f32 v69, v69
v_exp_f32 v70, v70
v_mfma_f32_32x32x16_bf16 v[96:111], a[176:179], a[128:131], v[48:63]
v_cvt_pk_bf16_f32 v114, v68, v69
v_exp_f32 v71, v71
v_exp_f32 v72, v72
s_waitcnt lgkmcnt(4)
v_mfma_f32_32x32x16_bf16 v[144:159], a[188:191], v[220:223], v[144:159]
v_cvt_pk_bf16_f32 v115, v70, v71
v_exp_f32 v73, v73
v_mfma_f32_32x32x16_bf16 v[96:111], a[180:183], a[132:135], v[96:111]
v_exp_f32 v74, v74
v_cvt_pk_bf16_f32 v116, v72, v73
v_exp_f32 v75, v75
v_mfma_f32_32x32x16_bf16 a[80:95], a[208:211], v[124:127], a[80:95]
v_exp_f32 v76, v76
v_cvt_pk_bf16_f32 v117, v74, v75
s_waitcnt lgkmcnt(3)
v_mfma_f32_32x32x16_bf16 v[144:159], a[200:203], v[192:195], v[144:159]
v_exp_f32 v77, v77
v_exp_f32 v78, v78
s_waitcnt lgkmcnt(2)
v_mfma_f32_32x32x16_bf16 v[144:159], a[204:207], v[196:199], v[144:159]
v_exp_f32 v79, v79
v_cvt_pk_bf16_f32 v118, v76, v77
v_cvt_pk_bf16_f32 v119, v78, v79
s_waitcnt lgkmcnt(1)
v_mfma_f32_32x32x16_bf16 v[128:143], a[192:195], v[112:115], v[128:143]
ds_read_b128 a[184:187], v29 offset:16384
s_nop 1
v_cndmask_b32 v80, v96, v80, s[64:65]
v_cndmask_b32 v81, v97, v81, s[66:67]
v_cndmask_b32 v82, v98, v82, s[68:69]
v_cndmask_b32 v83, v99, v83, s[70:71]
v_cndmask_b32 v84, v100, v84, s[72:73]
v_cndmask_b32 v85, v101, v85, s[74:75]
v_cndmask_b32 v86, v102, v86, s[76:77]
v_cndmask_b32 v87, v103, v87, s[78:79]
v_cndmask_b32 v88, v104, v88, s[80:81]
v_cndmask_b32 v89, v105, v89, s[82:83]
v_cndmask_b32 v90, v106, v90, s[84:85]
v_cndmask_b32 v91, v107, v91, s[86:87]
v_cndmask_b32 v92, v108, v92, s[88:89]
v_cndmask_b32 v93, v109, v93, s[90:91]
v_cndmask_b32 v94, v110, v94, s[92:93]
v_cndmask_b32 v95, v111, v95, s[94:95]
v_exp_f32 v80, v80
v_exp_f32 v81, v81
v_exp_f32 v82, v82
v_cvt_pk_bf16_f32 v120, v80, v81
v_exp_f32 v83, v83
v_exp_f32 v84, v84
v_cvt_pk_bf16_f32 v121, v82, v83
v_mfma_f32_32x32x16_bf16 a[64:79], a[208:211], v[112:115], a[64:79]
ds_read_b128 a[188:191], v29 offset:17408
v_exp_f32 v85, v85
v_exp_f32 v86, v86
v_cvt_pk_bf16_f32 v122, v84, v85
v_exp_f32 v87, v87
v_exp_f32 v88, v88
v_cvt_pk_bf16_f32 v123, v86, v87
v_exp_f32 v89, v89
v_exp_f32 v90, v90
v_cvt_pk_bf16_f32 v124, v88, v89
v_exp_f32 v91, v91
v_exp_f32 v92, v92
v_cvt_pk_bf16_f32 v125, v90, v91
v_exp_f32 v93, v93
v_exp_f32 v94, v94
v_exp_f32 v95, v95
v_cvt_pk_bf16_f32 v126, v92, v93
v_cvt_pk_bf16_f32 v127, v94, v95
v_and_b32 v216, v16, v120
v_bfi_b32 v192, v16, 0, v120
s_waitcnt lgkmcnt(2)
v_mfma_f32_32x32x16_bf16 v[128:143], a[196:199], v[116:119], v[128:143]
ds_read_b128 a[200:203], v29 offset:0
v_and_b32 v217, v17, v121
v_bfi_b32 v193, v17, 0, v121
v_and_b32 v218, v18, v122
v_bfi_b32 v194, v18, 0, v122
v_and_b32 v219, v19, v123
v_bfi_b32 v195, v19, 0, v123
v_and_b32 v220, v20, v124
v_bfi_b32 v196, v20, 0, v124
v_and_b32 v221, v21, v125
v_bfi_b32 v197, v21, 0, v125
v_and_b32 v222, v22, v126
v_bfi_b32 v198, v22, 0, v126
v_and_b32 v223, v23, v127
v_bfi_b32 v199, v23, 0, v127
v_accvgpr_read_b32 v200, a80
v_mov_b32 v203, 0x7f7fffff
v_cmp_nle_f32 vcc, s98, v200
v_rcp_f32 v201, v200
v_cmp_nge_f32 s[20:21], s99, v200
s_or_b64 s[100:101], s[20:21], vcc
v_mul_f32 v144, v144, v201
v_mul_f32 v145, v145, v201
v_mul_f32 v146, v146, v201
v_mul_f32 v147, v147, v201
v_mul_f32 v148, v148, v201
v_mul_f32 v149, v149, v201
v_mul_f32 v150, v150, v201
v_mul_f32 v151, v151, v201
v_mul_f32 v152, v152, v201
v_mfma_f32_32x32x16_bf16 a[64:79], a[208:211], v[116:119], a[64:79]
ds_read_b128 a[204:207], v29 offset:1024
v_mul_f32 v153, v153, v201
v_mul_f32 v154, v154, v201
v_mul_f32 v155, v155, v201
v_mul_f32 v156, v156, v201
v_mul_f32 v157, v157, v201
v_mul_f32 v158, v158, v201
v_mul_f32 v159, v159, v201
v_max3_f32 v202, abs(v144), abs(v145), abs(v146)
v_max3_f32 v202, v202, abs(v147), abs(v148)
v_max3_f32 v202, v202, abs(v149), abs(v150)
v_max3_f32 v202, v202, abs(v151), abs(v152)
v_max3_f32 v202, v202, abs(v153), abs(v154)
v_max3_f32 v202, v202, abs(v155), abs(v156)
v_max3_f32 v202, v202, abs(v157), abs(v158)
v_max_f32 v202, v202, abs(v159)
v_cvt_pk_bf16_f32 v204, v144, v145
v_cvt_pk_bf16_f32 v205, v146, v147
v_cvt_pk_bf16_f32 v206, v152, v153
v_cvt_pk_bf16_f32 v207, v154, v155
v_cvt_pk_bf16_f32 v208, v148, v149
v_cvt_pk_bf16_f32 v209, v150, v151
v_cvt_pk_bf16_f32 v210, v156, v157
v_cvt_pk_bf16_f32 v211, v158, v159
v_cmp_nle_f32 vcc, v202, v203
s_add_u32 s21, s97, 131072
s_or_b64 s[100:101], s[100:101], vcc
buffer_store_dwordx4 v[204:207], v30, s[12:15], s21 offen sc1
buffer_store_dwordx4 v[208:211], v30, s[12:15], s21 offen offset:512 sc1
s_cmp_lg_u64 s[100:101], 0
s_cselect_b32 s96, 1, s96
s_waitcnt lgkmcnt(3)
v_mfma_f32_32x32x16_bf16 v[128:143], a[184:187], v[216:219], v[128:143]
v_mfma_f32_32x32x16_bf16 a[64:79], a[208:211], v[120:123], a[64:79]
s_waitcnt lgkmcnt(2)
v_mfma_f32_32x32x16_bf16 v[128:143], a[188:191], v[220:223], v[128:143]
v_mfma_f32_32x32x16_bf16 a[64:79], a[208:211], v[124:127], a[64:79]
s_waitcnt lgkmcnt(1)
v_mfma_f32_32x32x16_bf16 v[128:143], a[200:203], v[192:195], v[128:143]
s_waitcnt lgkmcnt(0)
v_mfma_f32_32x32x16_bf16 v[128:143], a[204:207], v[196:199], v[128:143]
s_nop 7
s_nop 3
v_accvgpr_read_b32 v200, a64
v_mov_b32 v203, 0x7f7fffff
v_cmp_nle_f32 vcc, s98, v200
v_rcp_f32 v201, v200
v_cmp_nge_f32 s[20:21], s99, v200
s_or_b64 s[100:101], s[20:21], vcc
v_mul_f32 v128, v128, v201
v_mul_f32 v129, v129, v201
v_mul_f32 v130, v130, v201
v_mul_f32 v131, v131, v201
v_mul_f32 v132, v132, v201
v_mul_f32 v133, v133, v201
v_mul_f32 v134, v134, v201
v_mul_f32 v135, v135, v201
v_mul_f32 v136, v136, v201
v_mul_f32 v137, v137, v201
v_mul_f32 v138, v138, v201
v_mul_f32 v139, v139, v201
v_mul_f32 v140, v140, v201
v_mul_f32 v141, v141, v201
v_mul_f32 v142, v142, v201
v_mul_f32 v143, v143, v201
v_max3_f32 v202, abs(v128), abs(v129), abs(v130)
v_max3_f32 v202, v202, abs(v131), abs(v132)
v_max3_f32 v202, v202, abs(v133), abs(v134)
v_max3_f32 v202, v202, abs(v135), abs(v136)
v_max3_f32 v202, v202, abs(v137), abs(v138)
v_max3_f32 v202, v202, abs(v139), abs(v140)
v_max3_f32 v202, v202, abs(v141), abs(v142)
v_max_f32 v202, v202, abs(v143)
v_cvt_pk_bf16_f32 v204, v128, v129
v_cvt_pk_bf16_f32 v205, v130, v131
v_cvt_pk_bf16_f32 v206, v136, v137
v_cvt_pk_bf16_f32 v207, v138, v139
v_cvt_pk_bf16_f32 v208, v132, v133
v_cvt_pk_bf16_f32 v209, v134, v135
v_cvt_pk_bf16_f32 v210, v140, v141
v_cvt_pk_bf16_f32 v211, v142, v143
v_cmp_nle_f32 vcc, v202, v203
s_add_u32 s21, s97, 0
s_or_b64 s[100:101], s[100:101], vcc
buffer_store_dwordx4 v[204:207], v30, s[12:15], s21 offen sc1
buffer_store_dwordx4 v[208:211], v30, s[12:15], s21 offen offset:512 sc1
s_cmp_lg_u64 s[100:101], 0
s_cselect_b32 s96, 1, s96
s_cmp_eq_u32 s96, 0
s_cbranch_scc1 .LB_end
s_waitcnt vmcnt(0)
s_mov_b32 s16, 0
v_and_b32 v2, 31, v0
v_lshrrev_b32 v3, 5, v0
v_lshlrev_b32 v3, 2, v3
.LFB_slot:
s_lshr_b32 s17, s46, 1
s_lshl_b32 s18, s16, 1
s_add_u32 s17, s17, s18
s_lshl_b32 s18, s16, 12
v_add_u32 v4, s18, v31
ds_read_b128 a[128:131], v4
ds_read_b128 a[132:135], v4 offset:1024
s_lshl_b32 s18, s17, 5
s_add_u32 s18, s18, 256
v_add_u32 v5, s18, v2
v_mov_b32 v6, 4048155338
s_mov_b32 s19, 0
.LFB_pass:
s_mov_b32 s18, 0
.LFB_blk:
s_add_u32 s20, s17, 8
s_sub_u32 s20, s20, s18
s_cmp_lg_u32 s44, 0
s_cbranch_scc1 .LFB_ok
s_cmp_lt_u32 s20, 8
s_cbranch_scc1 .LFB_next
.LFB_ok:
s_lshr_b32 s21, s46, 1
s_sub_u32 s21, s20, s21
s_lshl_b32 s21, s21, 11
v_add_u32 v7, s21, v28
v_add_u32 v8, s21, v29
ds_read_b128 a[160:163], v7
ds_read_b128 a[164:167], v7 offset:1024
ds_read_b128 a[184:187], v8
ds_read_b128 a[188:191], v8 offset:1024
s_waitcnt lgkmcnt(0)
v_mfma_f32_32x32x16_bf16 v[64:79], a[160:163], a[128:131], 0
v_mfma_f32_32x32x16_bf16 v[64:79], a[164:167], a[132:135], v[64:79]
s_lshl_b32 s21, s20, 5
v_add_u32 v9, s21, v3
v_sub_u32 v9, v5, v9
s_nop 7
s_nop 3

v_subrev_u32 v10, 0, v9
v_cmp_gt_u32 vcc, 0x100, v10
v_mov_b32 v11, 4048155338
s_nop 0
v_cndmask_b32 v64, v11, v64, vcc
v_subrev_u32 v10, 1, v9
v_cmp_gt_u32 vcc, 0x100, v10
v_mov_b32 v11, 4048155338
s_nop 0
v_cndmask_b32 v65, v11, v65, vcc
v_subrev_u32 v10, 2, v9
v_cmp_gt_u32 vcc, 0x100, v10
v_mov_b32 v11, 4048155338
s_nop 0
v_cndmask_b32 v66, v11, v66, vcc
v_subrev_u32 v10, 3, v9
v_cmp_gt_u32 vcc, 0x100, v10
v_mov_b32 v11, 4048155338
s_nop 0
v_cndmask_b32 v67, v11, v67, vcc
v_subrev_u32 v10, 8, v9
v_cmp_gt_u32 vcc, 0x100, v10
v_mov_b32 v11, 4048155338
s_nop 0
v_cndmask_b32 v68, v11, v68, vcc
v_subrev_u32 v10, 9, v9
v_cmp_gt_u32 vcc, 0x100, v10
v_mov_b32 v11, 4048155338
s_nop 0
v_cndmask_b32 v69, v11, v69, vcc
v_subrev_u32 v10, 10, v9
v_cmp_gt_u32 vcc, 0x100, v10
v_mov_b32 v11, 4048155338
s_nop 0
v_cndmask_b32 v70, v11, v70, vcc
v_subrev_u32 v10, 11, v9
v_cmp_gt_u32 vcc, 0x100, v10
v_mov_b32 v11, 4048155338
s_nop 0
v_cndmask_b32 v71, v11, v71, vcc
v_subrev_u32 v10, 16, v9
v_cmp_gt_u32 vcc, 0x100, v10
v_mov_b32 v11, 4048155338
s_nop 0
v_cndmask_b32 v72, v11, v72, vcc
v_subrev_u32 v10, 17, v9
v_cmp_gt_u32 vcc, 0x100, v10
v_mov_b32 v11, 4048155338
s_nop 0
v_cndmask_b32 v73, v11, v73, vcc
v_subrev_u32 v10, 18, v9
v_cmp_gt_u32 vcc, 0x100, v10
v_mov_b32 v11, 4048155338
s_nop 0
v_cndmask_b32 v74, v11, v74, vcc
v_subrev_u32 v10, 19, v9
v_cmp_gt_u32 vcc, 0x100, v10
v_mov_b32 v11, 4048155338
s_nop 0
v_cndmask_b32 v75, v11, v75, vcc
v_subrev_u32 v10, 24, v9
v_cmp_gt_u32 vcc, 0x100, v10
v_mov_b32 v11, 4048155338
s_nop 0
v_cndmask_b32 v76, v11, v76, vcc
v_subrev_u32 v10, 25, v9
v_cmp_gt_u32 vcc, 0x100, v10
v_mov_b32 v11, 4048155338
s_nop 0
v_cndmask_b32 v77, v11, v77, vcc
v_subrev_u32 v10, 26, v9
v_cmp_gt_u32 vcc, 0x100, v10
v_mov_b32 v11, 4048155338
s_nop 0
v_cndmask_b32 v78, v11, v78, vcc
v_subrev_u32 v10, 27, v9
v_cmp_gt_u32 vcc, 0x100, v10
v_mov_b32 v11, 4048155338
s_nop 0
v_cndmask_b32 v79, v11, v79, vcc
s_cmp_eq_u32 s19, 1
s_cbranch_scc1 .LFB_p2
v_max_f32 v6, v6, v64
v_max_f32 v6, v6, v65
v_max_f32 v6, v6, v66
v_max_f32 v6, v6, v67
v_max_f32 v6, v6, v68
v_max_f32 v6, v6, v69
v_max_f32 v6, v6, v70
v_max_f32 v6, v6, v71
v_max_f32 v6, v6, v72
v_max_f32 v6, v6, v73
v_max_f32 v6, v6, v74
v_max_f32 v6, v6, v75
v_max_f32 v6, v6, v76
v_max_f32 v6, v6, v77
v_max_f32 v6, v6, v78
v_max_f32 v6, v6, v79
s_branch .LFB_next
.LFB_p2:
v_sub_f32 v64, v64, v6
v_sub_f32 v65, v65, v6
v_sub_f32 v66, v66, v6
v_sub_f32 v67, v67, v6
v_sub_f32 v68, v68, v6
v_sub_f32 v69, v69, v6
v_sub_f32 v70, v70, v6
v_sub_f32 v71, v71, v6
v_sub_f32 v72, v72, v6
v_sub_f32 v73, v73, v6
v_sub_f32 v74, v74, v6
v_sub_f32 v75, v75, v6
v_sub_f32 v76, v76, v6
v_sub_f32 v77, v77, v6
v_sub_f32 v78, v78, v6
v_sub_f32 v79, v79, v6
v_exp_f32 v64, v64
v_exp_f32 v65, v65
v_exp_f32 v66, v66
v_exp_f32 v67, v67
v_exp_f32 v68, v68
v_exp_f32 v69, v69
v_exp_f32 v70, v70
v_exp_f32 v71, v71
v_exp_f32 v72, v72
v_exp_f32 v73, v73
v_exp_f32 v74, v74
v_exp_f32 v75, v75
v_exp_f32 v76, v76
v_exp_f32 v77, v77
v_exp_f32 v78, v78
v_exp_f32 v79, v79
s_nop 0
v_cvt_pk_bf16_f32 v112, v64, v65
v_cvt_pk_bf16_f32 v113, v66, v67
v_cvt_pk_bf16_f32 v114, v68, v69
v_cvt_pk_bf16_f32 v115, v70, v71
v_cvt_pk_bf16_f32 v116, v72, v73
v_cvt_pk_bf16_f32 v117, v74, v75
v_cvt_pk_bf16_f32 v118, v76, v77
v_cvt_pk_bf16_f32 v119, v78, v79
s_nop 1
v_mfma_f32_32x32x16_bf16 v[128:143], a[184:187], v[112:115], v[128:143]
v_mfma_f32_32x32x16_bf16 v[208:223], a[208:211], v[112:115], v[208:223]
v_mfma_f32_32x32x16_bf16 v[128:143], a[188:191], v[116:119], v[128:143]
v_mfma_f32_32x32x16_bf16 v[208:223], a[208:211], v[116:119], v[208:223]
s_nop 7
s_nop 7
.LFB_next:
s_add_u32 s18, s18, 1
s_cmp_le_u32 s18, 8
s_cbranch_scc1 .LFB_blk
s_cmp_eq_u32 s19, 1
s_cbranch_scc1 .LFB_fin
v_mov_b32 v7, v6
s_nop 1
v_permlane32_swap_b32 v6, v7
s_nop 1
v_max_f32 v6, v6, v7
v_mov_b32 v128, 0
v_mov_b32 v208, 0
v_mov_b32 v129, 0
v_mov_b32 v209, 0
v_mov_b32 v130, 0
v_mov_b32 v210, 0
v_mov_b32 v131, 0
v_mov_b32 v211, 0
v_mov_b32 v132, 0
v_mov_b32 v212, 0
v_mov_b32 v133, 0
v_mov_b32 v213, 0
v_mov_b32 v134, 0
v_mov_b32 v214, 0
v_mov_b32 v135, 0
v_mov_b32 v215, 0
v_mov_b32 v136, 0
v_mov_b32 v216, 0
v_mov_b32 v137, 0
v_mov_b32 v217, 0
v_mov_b32 v138, 0
v_mov_b32 v218, 0
v_mov_b32 v139, 0
v_mov_b32 v219, 0
v_mov_b32 v140, 0
v_mov_b32 v220, 0
v_mov_b32 v141, 0
v_mov_b32 v221, 0
v_mov_b32 v142, 0
v_mov_b32 v222, 0
v_mov_b32 v143, 0
v_mov_b32 v223, 0
s_mov_b32 s19, 1
s_branch .LFB_pass
.LFB_fin:
v_rcp_f32 v209, v208
s_nop 0
v_mul_f32 v128, v128, v209
v_mul_f32 v129, v129, v209
v_mul_f32 v130, v130, v209
v_mul_f32 v131, v131, v209
v_mul_f32 v132, v132, v209
v_mul_f32 v133, v133, v209
v_mul_f32 v134, v134, v209
v_mul_f32 v135, v135, v209
v_mul_f32 v136, v136, v209
v_mul_f32 v137, v137, v209
v_mul_f32 v138, v138, v209
v_mul_f32 v139, v139, v209
v_mul_f32 v140, v140, v209
v_mul_f32 v141, v141, v209
v_mul_f32 v142, v142, v209
v_mul_f32 v143, v143, v209
v_cvt_pk_bf16_f32 v212, v128, v129
v_cvt_pk_bf16_f32 v213, v130, v131
v_cvt_pk_bf16_f32 v214, v136, v137
v_cvt_pk_bf16_f32 v215, v138, v139
v_cvt_pk_bf16_f32 v216, v132, v133
v_cvt_pk_bf16_f32 v217, v134, v135
v_cvt_pk_bf16_f32 v218, v140, v141
v_cvt_pk_bf16_f32 v219, v142, v143
s_lshl_b32 s21, s16, 17
s_add_u32 s21, s21, s97
buffer_store_dwordx4 v[212:215], v30, s[12:15], s21 offen sc1
buffer_store_dwordx4 v[216:219], v30, s[12:15], s21 offen offset:512 sc1
s_add_u32 s16, s16, 1
s_cmp_lt_u32 s16, 4
s_cbranch_scc1 .LFB_slot

.LB_end:
.Lph3:
s_mul_i32 s16, s43, 24
s_add_u32 s16, s16, 16
s_load_dwordx2 s[20:21], s[0:1], s16
s_load_dwordx2 s[24:25], s[0:1], 48
s_mov_b32 s22, s12
s_mov_b32 s23, s13
s_lshl_b32 s36, s44, 1
s_lshr_b32 s16, s45, 3
s_add_u32 s36, s36, s16
s_and_b32 s37, s45, 7
s_mov_b32 s26, 0x800000
s_mov_b32 s27, 0x20000
v_accvgpr_read_b32 v40, a252
v_accvgpr_read_b32 v41, a253
s_waitcnt vmcnt(0)
s_barrier

s_cmp_lg_u32 s46, 0
s_cbranch_scc1 .Lo_nosig
v_readlane_b32 s16, v40, s45
v_readlane_b32 s17, v41, s45
s_lshl_b32 s18, s43, 3
s_add_u32 s18, s18, s44
s_lshl_b32 s18, s18, 2
s_add_u32 s18, s18, 192
s_add_u32 s16, s16, 1
v_mov_b32 v42, s16
v_mov_b32 v43, 1
s_mov_b64 exec, 1
buffer_store_dword v42, off, s[12:15], s17 sc1
buffer_atomic_add v43, off, s[60:63], s18
s_mov_b64 exec, -1
.Lo_nosig:

s_mov_b32 s28, 0
s_mov_b32 s32, 7168
s_mov_b32 s29, 30720
s_mov_b32 s33, 14336
s_mov_b32 s30, 30720
s_mov_b32 s34, 21504
s_lshl_b32 s40, s46, 12
v_lshlrev_b32 v20, 4, v0
s_lshl_b32 s16, s46, 16
v_add_u32 v2, s16, v20
v_lshrrev_b32 v21, 4, v0
v_and_b32 v22, 15, v0
v_lshlrev_b32 v23, 1, v21
v_xor_b32 v23, v22, v23
v_lshlrev_b32 v23, 4, v23
s_lshl_b32 s16, s46, 4
v_add_u32 v24, s16, v21
v_lshlrev_b32 v24, 11, v24
v_add_u32 v3, v24, v23
v_xor_b32 v4, 128, v3
s_lshr_b32 s16, s46, 1
s_lshl_b32 s16, s16, 13
v_add_u32 v5, s16, v20
v_add_u32 v15, 0x10000, v5
v_bfe_u32 v22, v0, 2, 2
v_lshlrev_b32 v23, 2, v21
v_add_u32 v23, v23, v22
v_and_b32 v24, 7, v23
v_lshlrev_b32 v23, 8, v23
v_and_b32 v25, 3, v0
v_lshlrev_b32 v25, 3, v25
v_add_u32 v23, v23, v25
v_add_u32 v23, 0x4000, v23
s_and_b32 s16, s46, 1
s_lshl_b32 s16, s16, 2

s_add_u32 s17, s16, 0
v_xor_b32 v25, s17, v24
v_lshlrev_b32 v25, 5, v25
v_add_u32 v6, v23, v25
v_add_u32 v16, 0x10000, v6
s_add_u32 s17, s16, 1
v_xor_b32 v25, s17, v24
v_lshlrev_b32 v25, 5, v25
v_add_u32 v7, v23, v25
v_add_u32 v17, 0x10000, v7
s_add_u32 s17, s16, 2
v_xor_b32 v25, s17, v24
v_lshlrev_b32 v25, 5, v25
v_add_u32 v8, v23, v25
v_add_u32 v18, 0x10000, v8
s_add_u32 s17, s16, 3
v_xor_b32 v25, s17, v24
v_lshlrev_b32 v25, 5, v25
v_add_u32 v9, v23, v25
v_add_u32 v19, 0x10000, v9
s_waitcnt lgkmcnt(0)
s_lshl_b32 s16, s43, 22
s_lshl_b32 s17, s36, 18
s_add_u32 s16, s16, s17
s_add_u32 s16, s16, 33554432
s_add_u32 s4, s22, s16
s_addc_u32 s5, s23, 0
s_mov_b32 s6, 0x40000
s_mov_b32 s7, 0x20000
s_lshl_b32 s16, s37, 8
s_add_u32 s8, s20, s16
s_addc_u32 s9, s21, 0
s_sub_u32 s10, 0x200000, s16
s_mov_b32 s11, 0x20000

s_add_u32 m0, s40, 16384
s_nop 0
buffer_load_dwordx4 v3, s[8:11], 0 offen lds
buffer_load_dwordx4 v4, s[8:11], s32 offen offset:1024 lds
buffer_load_dwordx4 v3, s[8:11], s33 offen offset:2048 lds
buffer_load_dwordx4 v4, s[8:11], s34 offen offset:3072 lds
s_add_u32 s8, s8, 131072
s_addc_u32 s9, s9, 0
s_sub_u32 s10, s10, 131072
s_add_u32 m0, s40, 49152
s_nop 0
buffer_load_dwordx4 v3, s[8:11], 0 offen lds
buffer_load_dwordx4 v4, s[8:11], s32 offen offset:1024 lds
buffer_load_dwordx4 v3, s[8:11], s33 offen offset:2048 lds
buffer_load_dwordx4 v4, s[8:11], s34 offen offset:3072 lds
s_add_u32 s8, s8, 131072
s_addc_u32 s9, s9, 0
s_sub_u32 s10, s10, 131072
s_add_u32 m0, s40, 81920
s_nop 0
buffer_load_dwordx4 v3, s[8:11], 0 offen lds
buffer_load_dwordx4 v4, s[8:11], s32 offen offset:1024 lds
buffer_load_dwordx4 v3, s[8:11], s33 offen offset:2048 lds
buffer_load_dwordx4 v4, s[8:11], s34 offen offset:3072 lds
s_add_u32 s8, s8, 131072
s_addc_u32 s9, s9, 0
s_sub_u32 s10, s10, 131072
s_add_u32 m0, s40, 114688
s_nop 0
buffer_load_dwordx4 v3, s[8:11], 0 offen lds
buffer_load_dwordx4 v4, s[8:11], s32 offen offset:1024 lds
buffer_load_dwordx4 v3, s[8:11], s33 offen offset:2048 lds
buffer_load_dwordx4 v4, s[8:11], s34 offen offset:3072 lds
s_add_u32 s8, s8, 131072
s_addc_u32 s9, s9, 0
s_sub_u32 s10, s10, 131072
v_mov_b32 v64, 0
v_mov_b32 v65, 0
v_mov_b32 v66, 0
v_mov_b32 v67, 0
v_mov_b32 v68, 0
v_mov_b32 v69, 0
v_mov_b32 v70, 0
v_mov_b32 v71, 0
v_mov_b32 v72, 0
v_mov_b32 v73, 0
v_mov_b32 v74, 0
v_mov_b32 v75, 0
v_mov_b32 v76, 0
v_mov_b32 v77, 0
v_mov_b32 v78, 0
v_mov_b32 v79, 0
v_mov_b32 v80, 0
v_mov_b32 v81, 0
v_mov_b32 v82, 0
v_mov_b32 v83, 0
v_mov_b32 v84, 0
v_mov_b32 v85, 0
v_mov_b32 v86, 0
v_mov_b32 v87, 0
v_mov_b32 v88, 0
v_mov_b32 v89, 0
v_mov_b32 v90, 0
v_mov_b32 v91, 0
v_mov_b32 v92, 0
v_mov_b32 v93, 0
v_mov_b32 v94, 0
v_mov_b32 v95, 0
v_mov_b32 v96, 0
v_mov_b32 v97, 0
v_mov_b32 v98, 0
v_mov_b32 v99, 0
v_mov_b32 v100, 0
v_mov_b32 v101, 0
v_mov_b32 v102, 0
v_mov_b32 v103, 0
v_mov_b32 v104, 0
v_mov_b32 v105, 0
v_mov_b32 v106, 0
v_mov_b32 v107, 0
v_mov_b32 v108, 0
v_mov_b32 v109, 0
v_mov_b32 v110, 0
v_mov_b32 v111, 0
v_mov_b32 v112, 0
v_mov_b32 v113, 0
v_mov_b32 v114, 0
v_mov_b32 v115, 0
v_mov_b32 v116, 0
v_mov_b32 v117, 0
v_mov_b32 v118, 0
v_mov_b32 v119, 0
v_mov_b32 v120, 0
v_mov_b32 v121, 0
v_mov_b32 v122, 0
v_mov_b32 v123, 0
v_mov_b32 v124, 0
v_mov_b32 v125, 0
v_mov_b32 v126, 0
v_mov_b32 v127, 0
s_lshl_b32 s18, s43, 3
s_add_u32 s18, s18, s44
s_lshl_b32 s18, s18, 2
s_add_u32 s18, s18, 192
s_mov_b32 s17, 0
.Lo_poll:
buffer_load_dword v42, v41, s[12:15], 0 offen sc1
s_waitcnt vmcnt(0)
v_cmp_ne_u32 vcc, v42, v40
s_nop 1
s_and_b32 s16, vcc_lo, 0xffff
s_cmp_eq_u32 s16, 0xffff
s_cbranch_scc1 .Lo_poll_end
s_add_u32 s17, s17, 1
s_and_b32 s16, s17, 15
s_cmp_lg_u32 s16, 0
s_cbranch_scc1 .Lo_poll
buffer_load_dword v42, off, s[60:63], s18 sc1
s_waitcnt vmcnt(0)
v_readfirstlane_b32 s16, v42
s_nop 0
s_cmp_ge_u32 s16, 16
s_cbranch_scc1 .Lo_poll_end
s_cmp_lt_u32 s17, 200000
s_cbranch_scc1 .Lo_poll
.Lo_poll_end:

s_add_u32 m0, s40, 0
s_nop 0
buffer_load_dwordx4 v2, s[4:7], 0 offen sc1 lds
buffer_load_dwordx4 v2, s[4:7], s28 offen offset:1024 sc1 lds
buffer_load_dwordx4 v2, s[4:7], s29 offen offset:2048 sc1 lds
buffer_load_dwordx4 v2, s[4:7], s30 offen offset:3072 sc1 lds
s_add_u32 s4, s4, 2048
s_addc_u32 s5, s5, 0
s_sub_u32 s6, s6, 2048
s_add_u32 m0, s40, 32768
s_nop 0
buffer_load_dwordx4 v2, s[4:7], 0 offen sc1 lds
buffer_load_dwordx4 v2, s[4:7], s28 offen offset:1024 sc1 lds
buffer_load_dwordx4 v2, s[4:7], s29 offen offset:2048 sc1 lds
buffer_load_dwordx4 v2, s[4:7], s30 offen offset:3072 sc1 lds
s_add_u32 s4, s4, 2048
s_addc_u32 s5, s5, 0
s_sub_u32 s6, s6, 2048
s_add_u32 m0, s40, 65536
s_nop 0
buffer_load_dwordx4 v2, s[4:7], 0 offen sc1 lds
buffer_load_dwordx4 v2, s[4:7], s28 offen offset:1024 sc1 lds
buffer_load_dwordx4 v2, s[4:7], s29 offen offset:2048 sc1 lds
buffer_load_dwordx4 v2, s[4:7], s30 offen offset:3072 sc1 lds
s_add_u32 s4, s4, 2048
s_addc_u32 s5, s5, 0
s_sub_u32 s6, s6, 2048
s_add_u32 m0, s40, 98304
s_nop 0
buffer_load_dwordx4 v2, s[4:7], 0 offen sc1 lds
buffer_load_dwordx4 v2, s[4:7], s28 offen offset:1024 sc1 lds
buffer_load_dwordx4 v2, s[4:7], s29 offen offset:2048 sc1 lds
buffer_load_dwordx4 v2, s[4:7], s30 offen offset:3072 sc1 lds
s_add_u32 s4, s4, 2048
s_addc_u32 s5, s5, 0
s_sub_u32 s6, s6, 2048
s_waitcnt vmcnt(12)
s_barrier
ds_read_b64_tr_b16 a[16:17], v6 offset:0
ds_read_b64_tr_b16 a[18:19], v6 offset:4096
ds_read_b128 a[0:3], v5 offset:0
ds_read_b128 a[4:7], v5 offset:2048
ds_read_b128 a[8:11], v5 offset:4096
ds_read_b128 a[12:15], v5 offset:6144
ds_read_b64_tr_b16 a[20:21], v7 offset:0
ds_read_b64_tr_b16 a[22:23], v7 offset:4096
ds_read_b64_tr_b16 a[24:25], v8 offset:0
ds_read_b64_tr_b16 a[26:27], v8 offset:4096
ds_read_b64_tr_b16 a[28:29], v9 offset:0
ds_read_b64_tr_b16 a[30:31], v9 offset:4096
s_mov_b32 s41, 0
s_waitcnt lgkmcnt(9)
v_mfma_f32_16x16x32_bf16 v[64:67], a[16:19], a[0:3], v[64:67]
ds_read_b64_tr_b16 a[48:49], v6 offset:8192
s_waitcnt lgkmcnt(9)
v_mfma_f32_16x16x32_bf16 v[80:83], a[16:19], a[4:7], v[80:83]
ds_read_b64_tr_b16 a[50:51], v6 offset:12288
s_waitcnt lgkmcnt(9)
v_mfma_f32_16x16x32_bf16 v[96:99], a[16:19], a[8:11], v[96:99]
ds_read_b128 a[32:35], v5 offset:1024
s_waitcnt lgkmcnt(9)
v_mfma_f32_16x16x32_bf16 v[112:115], a[16:19], a[12:15], v[112:115]
ds_read_b128 a[36:39], v5 offset:3072
s_waitcnt lgkmcnt(8)
v_mfma_f32_16x16x32_bf16 v[68:71], a[20:23], a[0:3], v[68:71]
ds_read_b128 a[40:43], v5 offset:5120
v_mfma_f32_16x16x32_bf16 v[84:87], a[20:23], a[4:7], v[84:87]
ds_read_b128 a[44:47], v5 offset:7168
v_mfma_f32_16x16x32_bf16 v[100:103], a[20:23], a[8:11], v[100:103]
ds_read_b64_tr_b16 a[52:53], v7 offset:8192
v_mfma_f32_16x16x32_bf16 v[116:119], a[20:23], a[12:15], v[116:119]
ds_read_b64_tr_b16 a[54:55], v7 offset:12288
s_waitcnt lgkmcnt(10)
v_mfma_f32_16x16x32_bf16 v[72:75], a[24:27], a[0:3], v[72:75]
ds_read_b64_tr_b16 a[56:57], v8 offset:8192
v_mfma_f32_16x16x32_bf16 v[88:91], a[24:27], a[4:7], v[88:91]
ds_read_b64_tr_b16 a[58:59], v8 offset:12288
v_mfma_f32_16x16x32_bf16 v[104:107], a[24:27], a[8:11], v[104:107]
ds_read_b64_tr_b16 a[60:61], v9 offset:8192
v_mfma_f32_16x16x32_bf16 v[120:123], a[24:27], a[12:15], v[120:123]
ds_read_b64_tr_b16 a[62:63], v9 offset:12288
s_waitcnt lgkmcnt(12)
v_mfma_f32_16x16x32_bf16 v[76:79], a[28:31], a[0:3], v[76:79]
v_mfma_f32_16x16x32_bf16 v[92:95], a[28:31], a[4:7], v[92:95]
v_mfma_f32_16x16x32_bf16 v[108:111], a[28:31], a[8:11], v[108:111]
v_mfma_f32_16x16x32_bf16 v[124:127], a[28:31], a[12:15], v[124:127]
s_waitcnt lgkmcnt(0)
v_mfma_f32_16x16x32_bf16 v[64:67], a[48:51], a[32:35], v[64:67]
s_waitcnt vmcnt(8)
s_barrier
v_mfma_f32_16x16x32_bf16 v[80:83], a[48:51], a[36:39], v[80:83]
s_add_u32 m0, s40, 0
ds_read_b64_tr_b16 a[16:17], v6 offset:32768
buffer_load_dwordx4 v2, s[4:7], 0 offen sc1 lds
v_mfma_f32_16x16x32_bf16 v[96:99], a[48:51], a[40:43], v[96:99]
ds_read_b64_tr_b16 a[18:19], v6 offset:36864
v_mfma_f32_16x16x32_bf16 v[112:115], a[48:51], a[44:47], v[112:115]
ds_read_b128 a[0:3], v5 offset:32768
v_mfma_f32_16x16x32_bf16 v[68:71], a[52:55], a[32:35], v[68:71]
ds_read_b128 a[4:7], v5 offset:34816
v_mfma_f32_16x16x32_bf16 v[84:87], a[52:55], a[36:39], v[84:87]
ds_read_b128 a[8:11], v5 offset:36864
buffer_load_dwordx4 v2, s[4:7], s28 offen offset:1024 sc1 lds
v_mfma_f32_16x16x32_bf16 v[100:103], a[52:55], a[40:43], v[100:103]
ds_read_b128 a[12:15], v5 offset:38912
v_mfma_f32_16x16x32_bf16 v[116:119], a[52:55], a[44:47], v[116:119]
ds_read_b64_tr_b16 a[20:21], v7 offset:32768
v_mfma_f32_16x16x32_bf16 v[72:75], a[56:59], a[32:35], v[72:75]
ds_read_b64_tr_b16 a[22:23], v7 offset:36864
v_mfma_f32_16x16x32_bf16 v[88:91], a[56:59], a[36:39], v[88:91]
ds_read_b64_tr_b16 a[24:25], v8 offset:32768
buffer_load_dwordx4 v2, s[4:7], s29 offen offset:2048 sc1 lds
v_mfma_f32_16x16x32_bf16 v[104:107], a[56:59], a[40:43], v[104:107]
ds_read_b64_tr_b16 a[26:27], v8 offset:36864
v_mfma_f32_16x16x32_bf16 v[120:123], a[56:59], a[44:47], v[120:123]
ds_read_b64_tr_b16 a[28:29], v9 offset:32768
v_mfma_f32_16x16x32_bf16 v[76:79], a[60:63], a[32:35], v[76:79]
ds_read_b64_tr_b16 a[30:31], v9 offset:36864
v_mfma_f32_16x16x32_bf16 v[92:95], a[60:63], a[36:39], v[92:95]
buffer_load_dwordx4 v2, s[4:7], s30 offen offset:3072 sc1 lds
v_mfma_f32_16x16x32_bf16 v[108:111], a[60:63], a[40:43], v[108:111]
s_add_u32 s4, s4, 2048
s_addc_u32 s5, s5, 0
v_mfma_f32_16x16x32_bf16 v[124:127], a[60:63], a[44:47], v[124:127]
s_sub_u32 s6, s6, 2048
s_waitcnt lgkmcnt(9)
v_mfma_f32_16x16x32_bf16 v[64:67], a[16:19], a[0:3], v[64:67]
ds_read_b64_tr_b16 a[48:49], v6 offset:40960
s_waitcnt lgkmcnt(9)
v_mfma_f32_16x16x32_bf16 v[80:83], a[16:19], a[4:7], v[80:83]
s_add_u32 m0, s40, 16384
ds_read_b64_tr_b16 a[50:51], v6 offset:45056
buffer_load_dwordx4 v3, s[8:11], 0 offen lds
s_waitcnt lgkmcnt(9)
v_mfma_f32_16x16x32_bf16 v[96:99], a[16:19], a[8:11], v[96:99]
ds_read_b128 a[32:35], v5 offset:33792
s_waitcnt lgkmcnt(9)
v_mfma_f32_16x16x32_bf16 v[112:115], a[16:19], a[12:15], v[112:115]
ds_read_b128 a[36:39], v5 offset:35840
s_waitcnt lgkmcnt(8)
v_mfma_f32_16x16x32_bf16 v[68:71], a[20:23], a[0:3], v[68:71]
ds_read_b128 a[40:43], v5 offset:37888
v_mfma_f32_16x16x32_bf16 v[84:87], a[20:23], a[4:7], v[84:87]
ds_read_b128 a[44:47], v5 offset:39936
buffer_load_dwordx4 v4, s[8:11], s32 offen offset:1024 lds
v_mfma_f32_16x16x32_bf16 v[100:103], a[20:23], a[8:11], v[100:103]
ds_read_b64_tr_b16 a[52:53], v7 offset:40960
v_mfma_f32_16x16x32_bf16 v[116:119], a[20:23], a[12:15], v[116:119]
ds_read_b64_tr_b16 a[54:55], v7 offset:45056
s_waitcnt lgkmcnt(10)
v_mfma_f32_16x16x32_bf16 v[72:75], a[24:27], a[0:3], v[72:75]
ds_read_b64_tr_b16 a[56:57], v8 offset:40960
v_mfma_f32_16x16x32_bf16 v[88:91], a[24:27], a[4:7], v[88:91]
ds_read_b64_tr_b16 a[58:59], v8 offset:45056
buffer_load_dwordx4 v3, s[8:11], s33 offen offset:2048 lds
v_mfma_f32_16x16x32_bf16 v[104:107], a[24:27], a[8:11], v[104:107]
ds_read_b64_tr_b16 a[60:61], v9 offset:40960
v_mfma_f32_16x16x32_bf16 v[120:123], a[24:27], a[12:15], v[120:123]
ds_read_b64_tr_b16 a[62:63], v9 offset:45056
s_waitcnt lgkmcnt(12)
v_mfma_f32_16x16x32_bf16 v[76:79], a[28:31], a[0:3], v[76:79]
v_mfma_f32_16x16x32_bf16 v[92:95], a[28:31], a[4:7], v[92:95]
buffer_load_dwordx4 v4, s[8:11], s34 offen offset:3072 lds
v_mfma_f32_16x16x32_bf16 v[108:111], a[28:31], a[8:11], v[108:111]
s_add_u32 s8, s8, 131072
s_addc_u32 s9, s9, 0
v_mfma_f32_16x16x32_bf16 v[124:127], a[28:31], a[12:15], v[124:127]
s_sub_u32 s10, s10, 131072
s_waitcnt lgkmcnt(0)
v_mfma_f32_16x16x32_bf16 v[64:67], a[48:51], a[32:35], v[64:67]
s_waitcnt vmcnt(12)
s_barrier
v_mfma_f32_16x16x32_bf16 v[80:83], a[48:51], a[36:39], v[80:83]
s_add_u32 m0, s40, 32768
ds_read_b64_tr_b16 a[16:17], v16 offset:0
buffer_load_dwordx4 v2, s[4:7], 0 offen sc1 lds
v_mfma_f32_16x16x32_bf16 v[96:99], a[48:51], a[40:43], v[96:99]
ds_read_b64_tr_b16 a[18:19], v16 offset:4096
v_mfma_f32_16x16x32_bf16 v[112:115], a[48:51], a[44:47], v[112:115]
ds_read_b128 a[0:3], v15 offset:0
v_mfma_f32_16x16x32_bf16 v[68:71], a[52:55], a[32:35], v[68:71]
ds_read_b128 a[4:7], v15 offset:2048
v_mfma_f32_16x16x32_bf16 v[84:87], a[52:55], a[36:39], v[84:87]
ds_read_b128 a[8:11], v15 offset:4096
buffer_load_dwordx4 v2, s[4:7], s28 offen offset:1024 sc1 lds
v_mfma_f32_16x16x32_bf16 v[100:103], a[52:55], a[40:43], v[100:103]
ds_read_b128 a[12:15], v15 offset:6144
v_mfma_f32_16x16x32_bf16 v[116:119], a[52:55], a[44:47], v[116:119]
ds_read_b64_tr_b16 a[20:21], v17 offset:0
v_mfma_f32_16x16x32_bf16 v[72:75], a[56:59], a[32:35], v[72:75]
ds_read_b64_tr_b16 a[22:23], v17 offset:4096
v_mfma_f32_16x16x32_bf16 v[88:91], a[56:59], a[36:39], v[88:91]
ds_read_b64_tr_b16 a[24:25], v18 offset:0
buffer_load_dwordx4 v2, s[4:7], s29 offen offset:2048 sc1 lds
v_mfma_f32_16x16x32_bf16 v[104:107], a[56:59], a[40:43], v[104:107]
ds_read_b64_tr_b16 a[26:27], v18 offset:4096
v_mfma_f32_16x16x32_bf16 v[120:123], a[56:59], a[44:47], v[120:123]
ds_read_b64_tr_b16 a[28:29], v19 offset:0
v_mfma_f32_16x16x32_bf16 v[76:79], a[60:63], a[32:35], v[76:79]
ds_read_b64_tr_b16 a[30:31], v19 offset:4096
v_mfma_f32_16x16x32_bf16 v[92:95], a[60:63], a[36:39], v[92:95]
buffer_load_dwordx4 v2, s[4:7], s30 offen offset:3072 sc1 lds
v_mfma_f32_16x16x32_bf16 v[108:111], a[60:63], a[40:43], v[108:111]
s_add_u32 s4, s4, 2048
s_addc_u32 s5, s5, 0
v_mfma_f32_16x16x32_bf16 v[124:127], a[60:63], a[44:47], v[124:127]
s_sub_u32 s6, s6, 2048
.p2align 6
.Lp3_loop:
s_waitcnt lgkmcnt(9)
v_mfma_f32_16x16x32_bf16 v[64:67], a[16:19], a[0:3], v[64:67]
ds_read_b64_tr_b16 a[48:49], v16 offset:8192
s_waitcnt lgkmcnt(9)
v_mfma_f32_16x16x32_bf16 v[80:83], a[16:19], a[4:7], v[80:83]
s_add_u32 m0, s40, 49152
ds_read_b64_tr_b16 a[50:51], v16 offset:12288
buffer_load_dwordx4 v3, s[8:11], 0 offen lds
s_waitcnt lgkmcnt(9)
v_mfma_f32_16x16x32_bf16 v[96:99], a[16:19], a[8:11], v[96:99]
ds_read_b128 a[32:35], v15 offset:1024
s_waitcnt lgkmcnt(9)
v_mfma_f32_16x16x32_bf16 v[112:115], a[16:19], a[12:15], v[112:115]
ds_read_b128 a[36:39], v15 offset:3072
s_waitcnt lgkmcnt(8)
v_mfma_f32_16x16x32_bf16 v[68:71], a[20:23], a[0:3], v[68:71]
ds_read_b128 a[40:43], v15 offset:5120
v_mfma_f32_16x16x32_bf16 v[84:87], a[20:23], a[4:7], v[84:87]
ds_read_b128 a[44:47], v15 offset:7168
buffer_load_dwordx4 v4, s[8:11], s32 offen offset:1024 lds
v_mfma_f32_16x16x32_bf16 v[100:103], a[20:23], a[8:11], v[100:103]
ds_read_b64_tr_b16 a[52:53], v17 offset:8192
v_mfma_f32_16x16x32_bf16 v[116:119], a[20:23], a[12:15], v[116:119]
ds_read_b64_tr_b16 a[54:55], v17 offset:12288
s_waitcnt lgkmcnt(10)
v_mfma_f32_16x16x32_bf16 v[72:75], a[24:27], a[0:3], v[72:75]
ds_read_b64_tr_b16 a[56:57], v18 offset:8192
v_mfma_f32_16x16x32_bf16 v[88:91], a[24:27], a[4:7], v[88:91]
ds_read_b64_tr_b16 a[58:59], v18 offset:12288
buffer_load_dwordx4 v3, s[8:11], s33 offen offset:2048 lds
v_mfma_f32_16x16x32_bf16 v[104:107], a[24:27], a[8:11], v[104:107]
ds_read_b64_tr_b16 a[60:61], v19 offset:8192
v_mfma_f32_16x16x32_bf16 v[120:123], a[24:27], a[12:15], v[120:123]
ds_read_b64_tr_b16 a[62:63], v19 offset:12288
s_waitcnt lgkmcnt(12)
v_mfma_f32_16x16x32_bf16 v[76:79], a[28:31], a[0:3], v[76:79]
v_mfma_f32_16x16x32_bf16 v[92:95], a[28:31], a[4:7], v[92:95]
buffer_load_dwordx4 v4, s[8:11], s34 offen offset:3072 lds
v_mfma_f32_16x16x32_bf16 v[108:111], a[28:31], a[8:11], v[108:111]
s_add_u32 s8, s8, 131072
s_addc_u32 s9, s9, 0
v_mfma_f32_16x16x32_bf16 v[124:127], a[28:31], a[12:15], v[124:127]
s_sub_u32 s10, s10, 131072
s_waitcnt lgkmcnt(0)
v_mfma_f32_16x16x32_bf16 v[64:67], a[48:51], a[32:35], v[64:67]
s_waitcnt vmcnt(16)
s_barrier
v_mfma_f32_16x16x32_bf16 v[80:83], a[48:51], a[36:39], v[80:83]
s_add_u32 m0, s40, 65536
ds_read_b64_tr_b16 a[16:17], v16 offset:32768
buffer_load_dwordx4 v2, s[4:7], 0 offen sc1 lds
v_mfma_f32_16x16x32_bf16 v[96:99], a[48:51], a[40:43], v[96:99]
ds_read_b64_tr_b16 a[18:19], v16 offset:36864
v_mfma_f32_16x16x32_bf16 v[112:115], a[48:51], a[44:47], v[112:115]
ds_read_b128 a[0:3], v15 offset:32768
v_mfma_f32_16x16x32_bf16 v[68:71], a[52:55], a[32:35], v[68:71]
ds_read_b128 a[4:7], v15 offset:34816
v_mfma_f32_16x16x32_bf16 v[84:87], a[52:55], a[36:39], v[84:87]
ds_read_b128 a[8:11], v15 offset:36864
buffer_load_dwordx4 v2, s[4:7], s28 offen offset:1024 sc1 lds
v_mfma_f32_16x16x32_bf16 v[100:103], a[52:55], a[40:43], v[100:103]
ds_read_b128 a[12:15], v15 offset:38912
v_mfma_f32_16x16x32_bf16 v[116:119], a[52:55], a[44:47], v[116:119]
ds_read_b64_tr_b16 a[20:21], v17 offset:32768
v_mfma_f32_16x16x32_bf16 v[72:75], a[56:59], a[32:35], v[72:75]
ds_read_b64_tr_b16 a[22:23], v17 offset:36864
v_mfma_f32_16x16x32_bf16 v[88:91], a[56:59], a[36:39], v[88:91]
ds_read_b64_tr_b16 a[24:25], v18 offset:32768
buffer_load_dwordx4 v2, s[4:7], s29 offen offset:2048 sc1 lds
v_mfma_f32_16x16x32_bf16 v[104:107], a[56:59], a[40:43], v[104:107]
ds_read_b64_tr_b16 a[26:27], v18 offset:36864
v_mfma_f32_16x16x32_bf16 v[120:123], a[56:59], a[44:47], v[120:123]
ds_read_b64_tr_b16 a[28:29], v19 offset:32768
v_mfma_f32_16x16x32_bf16 v[76:79], a[60:63], a[32:35], v[76:79]
ds_read_b64_tr_b16 a[30:31], v19 offset:36864
v_mfma_f32_16x16x32_bf16 v[92:95], a[60:63], a[36:39], v[92:95]
buffer_load_dwordx4 v2, s[4:7], s30 offen offset:3072 sc1 lds
v_mfma_f32_16x16x32_bf16 v[108:111], a[60:63], a[40:43], v[108:111]
s_add_u32 s4, s4, 2048
s_addc_u32 s5, s5, 0
v_mfma_f32_16x16x32_bf16 v[124:127], a[60:63], a[44:47], v[124:127]
s_sub_u32 s6, s6, 2048
s_waitcnt lgkmcnt(9)
v_mfma_f32_16x16x32_bf16 v[64:67], a[16:19], a[0:3], v[64:67]
ds_read_b64_tr_b16 a[48:49], v16 offset:40960
s_waitcnt lgkmcnt(9)
v_mfma_f32_16x16x32_bf16 v[80:83], a[16:19], a[4:7], v[80:83]
s_add_u32 m0, s40, 81920
ds_read_b64_tr_b16 a[50:51], v16 offset:45056
buffer_load_dwordx4 v3, s[8:11], 0 offen lds
s_waitcnt lgkmcnt(9)
v_mfma_f32_16x16x32_bf16 v[96:99], a[16:19], a[8:11], v[96:99]
ds_read_b128 a[32:35], v15 offset:33792
s_waitcnt lgkmcnt(9)
v_mfma_f32_16x16x32_bf16 v[112:115], a[16:19], a[12:15], v[112:115]
ds_read_b128 a[36:39], v15 offset:35840
s_waitcnt lgkmcnt(8)
v_mfma_f32_16x16x32_bf16 v[68:71], a[20:23], a[0:3], v[68:71]
ds_read_b128 a[40:43], v15 offset:37888
v_mfma_f32_16x16x32_bf16 v[84:87], a[20:23], a[4:7], v[84:87]
ds_read_b128 a[44:47], v15 offset:39936
buffer_load_dwordx4 v4, s[8:11], s32 offen offset:1024 lds
v_mfma_f32_16x16x32_bf16 v[100:103], a[20:23], a[8:11], v[100:103]
ds_read_b64_tr_b16 a[52:53], v17 offset:40960
v_mfma_f32_16x16x32_bf16 v[116:119], a[20:23], a[12:15], v[116:119]
ds_read_b64_tr_b16 a[54:55], v17 offset:45056
s_waitcnt lgkmcnt(10)
v_mfma_f32_16x16x32_bf16 v[72:75], a[24:27], a[0:3], v[72:75]
ds_read_b64_tr_b16 a[56:57], v18 offset:40960
v_mfma_f32_16x16x32_bf16 v[88:91], a[24:27], a[4:7], v[88:91]
ds_read_b64_tr_b16 a[58:59], v18 offset:45056
buffer_load_dwordx4 v3, s[8:11], s33 offen offset:2048 lds
v_mfma_f32_16x16x32_bf16 v[104:107], a[24:27], a[8:11], v[104:107]
ds_read_b64_tr_b16 a[60:61], v19 offset:40960
v_mfma_f32_16x16x32_bf16 v[120:123], a[24:27], a[12:15], v[120:123]
ds_read_b64_tr_b16 a[62:63], v19 offset:45056
s_waitcnt lgkmcnt(12)
v_mfma_f32_16x16x32_bf16 v[76:79], a[28:31], a[0:3], v[76:79]
v_mfma_f32_16x16x32_bf16 v[92:95], a[28:31], a[4:7], v[92:95]
buffer_load_dwordx4 v4, s[8:11], s34 offen offset:3072 lds
v_mfma_f32_16x16x32_bf16 v[108:111], a[28:31], a[8:11], v[108:111]
s_add_u32 s8, s8, 131072
s_addc_u32 s9, s9, 0
v_mfma_f32_16x16x32_bf16 v[124:127], a[28:31], a[12:15], v[124:127]
s_sub_u32 s10, s10, 131072
s_waitcnt lgkmcnt(0)
v_mfma_f32_16x16x32_bf16 v[64:67], a[48:51], a[32:35], v[64:67]
s_waitcnt vmcnt(16)
s_barrier
v_mfma_f32_16x16x32_bf16 v[80:83], a[48:51], a[36:39], v[80:83]
s_add_u32 m0, s40, 98304
ds_read_b64_tr_b16 a[16:17], v6 offset:0
buffer_load_dwordx4 v2, s[4:7], 0 offen sc1 lds
v_mfma_f32_16x16x32_bf16 v[96:99], a[48:51], a[40:43], v[96:99]
ds_read_b64_tr_b16 a[18:19], v6 offset:4096
v_mfma_f32_16x16x32_bf16 v[112:115], a[48:51], a[44:47], v[112:115]
ds_read_b128 a[0:3], v5 offset:0
v_mfma_f32_16x16x32_bf16 v[68:71], a[52:55], a[32:35], v[68:71]
ds_read_b128 a[4:7], v5 offset:2048
v_mfma_f32_16x16x32_bf16 v[84:87], a[52:55], a[36:39], v[84:87]
ds_read_b128 a[8:11], v5 offset:4096
buffer_load_dwordx4 v2, s[4:7], s28 offen offset:1024 sc1 lds
v_mfma_f32_16x16x32_bf16 v[100:103], a[52:55], a[40:43], v[100:103]
ds_read_b128 a[12:15], v5 offset:6144
v_mfma_f32_16x16x32_bf16 v[116:119], a[52:55], a[44:47], v[116:119]
ds_read_b64_tr_b16 a[20:21], v7 offset:0
v_mfma_f32_16x16x32_bf16 v[72:75], a[56:59], a[32:35], v[72:75]
ds_read_b64_tr_b16 a[22:23], v7 offset:4096
v_mfma_f32_16x16x32_bf16 v[88:91], a[56:59], a[36:39], v[88:91]
ds_read_b64_tr_b16 a[24:25], v8 offset:0
buffer_load_dwordx4 v2, s[4:7], s29 offen offset:2048 sc1 lds
v_mfma_f32_16x16x32_bf16 v[104:107], a[56:59], a[40:43], v[104:107]
ds_read_b64_tr_b16 a[26:27], v8 offset:4096
v_mfma_f32_16x16x32_bf16 v[120:123], a[56:59], a[44:47], v[120:123]
ds_read_b64_tr_b16 a[28:29], v9 offset:0
v_mfma_f32_16x16x32_bf16 v[76:79], a[60:63], a[32:35], v[76:79]
ds_read_b64_tr_b16 a[30:31], v9 offset:4096
v_mfma_f32_16x16x32_bf16 v[92:95], a[60:63], a[36:39], v[92:95]
buffer_load_dwordx4 v2, s[4:7], s30 offen offset:3072 sc1 lds
v_mfma_f32_16x16x32_bf16 v[108:111], a[60:63], a[40:43], v[108:111]
s_add_u32 s4, s4, 2048
s_addc_u32 s5, s5, 0
v_mfma_f32_16x16x32_bf16 v[124:127], a[60:63], a[44:47], v[124:127]
s_sub_u32 s6, s6, 2048
s_waitcnt lgkmcnt(9)
v_mfma_f32_16x16x32_bf16 v[64:67], a[16:19], a[0:3], v[64:67]
ds_read_b64_tr_b16 a[48:49], v6 offset:8192
s_waitcnt lgkmcnt(9)
v_mfma_f32_16x16x32_bf16 v[80:83], a[16:19], a[4:7], v[80:83]
s_add_u32 m0, s40, 114688
ds_read_b64_tr_b16 a[50:51], v6 offset:12288
buffer_load_dwordx4 v3, s[8:11], 0 offen lds
s_waitcnt lgkmcnt(9)
v_mfma_f32_16x16x32_bf16 v[96:99], a[16:19], a[8:11], v[96:99]
ds_read_b128 a[32:35], v5 offset:1024
s_waitcnt lgkmcnt(9)
v_mfma_f32_16x16x32_bf16 v[112:115], a[16:19], a[12:15], v[112:115]
ds_read_b128 a[36:39], v5 offset:3072
s_waitcnt lgkmcnt(8)
v_mfma_f32_16x16x32_bf16 v[68:71], a[20:23], a[0:3], v[68:71]
ds_read_b128 a[40:43], v5 offset:5120
v_mfma_f32_16x16x32_bf16 v[84:87], a[20:23], a[4:7], v[84:87]
ds_read_b128 a[44:47], v5 offset:7168
buffer_load_dwordx4 v4, s[8:11], s32 offen offset:1024 lds
v_mfma_f32_16x16x32_bf16 v[100:103], a[20:23], a[8:11], v[100:103]
ds_read_b64_tr_b16 a[52:53], v7 offset:8192
v_mfma_f32_16x16x32_bf16 v[116:119], a[20:23], a[12:15], v[116:119]
ds_read_b64_tr_b16 a[54:55], v7 offset:12288
s_waitcnt lgkmcnt(10)
v_mfma_f32_16x16x32_bf16 v[72:75], a[24:27], a[0:3], v[72:75]
ds_read_b64_tr_b16 a[56:57], v8 offset:8192
v_mfma_f32_16x16x32_bf16 v[88:91], a[24:27], a[4:7], v[88:91]
ds_read_b64_tr_b16 a[58:59], v8 offset:12288
buffer_load_dwordx4 v3, s[8:11], s33 offen offset:2048 lds
v_mfma_f32_16x16x32_bf16 v[104:107], a[24:27], a[8:11], v[104:107]
ds_read_b64_tr_b16 a[60:61], v9 offset:8192
v_mfma_f32_16x16x32_bf16 v[120:123], a[24:27], a[12:15], v[120:123]
ds_read_b64_tr_b16 a[62:63], v9 offset:12288
s_waitcnt lgkmcnt(12)
v_mfma_f32_16x16x32_bf16 v[76:79], a[28:31], a[0:3], v[76:79]
v_mfma_f32_16x16x32_bf16 v[92:95], a[28:31], a[4:7], v[92:95]
buffer_load_dwordx4 v4, s[8:11], s34 offen offset:3072 lds
v_mfma_f32_16x16x32_bf16 v[108:111], a[28:31], a[8:11], v[108:111]
s_add_u32 s8, s8, 131072
s_addc_u32 s9, s9, 0
v_mfma_f32_16x16x32_bf16 v[124:127], a[28:31], a[12:15], v[124:127]
s_sub_u32 s10, s10, 131072
s_waitcnt lgkmcnt(0)
v_mfma_f32_16x16x32_bf16 v[64:67], a[48:51], a[32:35], v[64:67]
s_waitcnt vmcnt(16)
s_barrier
v_mfma_f32_16x16x32_bf16 v[80:83], a[48:51], a[36:39], v[80:83]
s_add_u32 m0, s40, 0
ds_read_b64_tr_b16 a[16:17], v6 offset:32768
buffer_load_dwordx4 v2, s[4:7], 0 offen sc1 lds
v_mfma_f32_16x16x32_bf16 v[96:99], a[48:51], a[40:43], v[96:99]
ds_read_b64_tr_b16 a[18:19], v6 offset:36864
v_mfma_f32_16x16x32_bf16 v[112:115], a[48:51], a[44:47], v[112:115]
ds_read_b128 a[0:3], v5 offset:32768
v_mfma_f32_16x16x32_bf16 v[68:71], a[52:55], a[32:35], v[68:71]
ds_read_b128 a[4:7], v5 offset:34816
v_mfma_f32_16x16x32_bf16 v[84:87], a[52:55], a[36:39], v[84:87]
ds_read_b128 a[8:11], v5 offset:36864
buffer_load_dwordx4 v2, s[4:7], s28 offen offset:1024 sc1 lds
v_mfma_f32_16x16x32_bf16 v[100:103], a[52:55], a[40:43], v[100:103]
ds_read_b128 a[12:15], v5 offset:38912
v_mfma_f32_16x16x32_bf16 v[116:119], a[52:55], a[44:47], v[116:119]
ds_read_b64_tr_b16 a[20:21], v7 offset:32768
v_mfma_f32_16x16x32_bf16 v[72:75], a[56:59], a[32:35], v[72:75]
ds_read_b64_tr_b16 a[22:23], v7 offset:36864
v_mfma_f32_16x16x32_bf16 v[88:91], a[56:59], a[36:39], v[88:91]
ds_read_b64_tr_b16 a[24:25], v8 offset:32768
buffer_load_dwordx4 v2, s[4:7], s29 offen offset:2048 sc1 lds
v_mfma_f32_16x16x32_bf16 v[104:107], a[56:59], a[40:43], v[104:107]
ds_read_b64_tr_b16 a[26:27], v8 offset:36864
v_mfma_f32_16x16x32_bf16 v[120:123], a[56:59], a[44:47], v[120:123]
ds_read_b64_tr_b16 a[28:29], v9 offset:32768
v_mfma_f32_16x16x32_bf16 v[76:79], a[60:63], a[32:35], v[76:79]
ds_read_b64_tr_b16 a[30:31], v9 offset:36864
v_mfma_f32_16x16x32_bf16 v[92:95], a[60:63], a[36:39], v[92:95]
buffer_load_dwordx4 v2, s[4:7], s30 offen offset:3072 sc1 lds
v_mfma_f32_16x16x32_bf16 v[108:111], a[60:63], a[40:43], v[108:111]
s_add_u32 s4, s4, 2048
s_addc_u32 s5, s5, 0
v_mfma_f32_16x16x32_bf16 v[124:127], a[60:63], a[44:47], v[124:127]
s_sub_u32 s6, s6, 2048
s_waitcnt lgkmcnt(9)
v_mfma_f32_16x16x32_bf16 v[64:67], a[16:19], a[0:3], v[64:67]
ds_read_b64_tr_b16 a[48:49], v6 offset:40960
s_waitcnt lgkmcnt(9)
v_mfma_f32_16x16x32_bf16 v[80:83], a[16:19], a[4:7], v[80:83]
s_add_u32 m0, s40, 16384
ds_read_b64_tr_b16 a[50:51], v6 offset:45056
buffer_load_dwordx4 v3, s[8:11], 0 offen lds
s_waitcnt lgkmcnt(9)
v_mfma_f32_16x16x32_bf16 v[96:99], a[16:19], a[8:11], v[96:99]
ds_read_b128 a[32:35], v5 offset:33792
s_waitcnt lgkmcnt(9)
v_mfma_f32_16x16x32_bf16 v[112:115], a[16:19], a[12:15], v[112:115]
ds_read_b128 a[36:39], v5 offset:35840
s_waitcnt lgkmcnt(8)
v_mfma_f32_16x16x32_bf16 v[68:71], a[20:23], a[0:3], v[68:71]
ds_read_b128 a[40:43], v5 offset:37888
v_mfma_f32_16x16x32_bf16 v[84:87], a[20:23], a[4:7], v[84:87]
ds_read_b128 a[44:47], v5 offset:39936
buffer_load_dwordx4 v4, s[8:11], s32 offen offset:1024 lds
v_mfma_f32_16x16x32_bf16 v[100:103], a[20:23], a[8:11], v[100:103]
ds_read_b64_tr_b16 a[52:53], v7 offset:40960
v_mfma_f32_16x16x32_bf16 v[116:119], a[20:23], a[12:15], v[116:119]
ds_read_b64_tr_b16 a[54:55], v7 offset:45056
s_waitcnt lgkmcnt(10)
v_mfma_f32_16x16x32_bf16 v[72:75], a[24:27], a[0:3], v[72:75]
ds_read_b64_tr_b16 a[56:57], v8 offset:40960
v_mfma_f32_16x16x32_bf16 v[88:91], a[24:27], a[4:7], v[88:91]
ds_read_b64_tr_b16 a[58:59], v8 offset:45056
buffer_load_dwordx4 v3, s[8:11], s33 offen offset:2048 lds
v_mfma_f32_16x16x32_bf16 v[104:107], a[24:27], a[8:11], v[104:107]
ds_read_b64_tr_b16 a[60:61], v9 offset:40960
v_mfma_f32_16x16x32_bf16 v[120:123], a[24:27], a[12:15], v[120:123]
ds_read_b64_tr_b16 a[62:63], v9 offset:45056
s_waitcnt lgkmcnt(12)
v_mfma_f32_16x16x32_bf16 v[76:79], a[28:31], a[0:3], v[76:79]
v_mfma_f32_16x16x32_bf16 v[92:95], a[28:31], a[4:7], v[92:95]
buffer_load_dwordx4 v4, s[8:11], s34 offen offset:3072 lds
v_mfma_f32_16x16x32_bf16 v[108:111], a[28:31], a[8:11], v[108:111]
s_add_u32 s8, s8, 131072
s_addc_u32 s9, s9, 0
v_mfma_f32_16x16x32_bf16 v[124:127], a[28:31], a[12:15], v[124:127]
s_sub_u32 s10, s10, 131072
s_waitcnt lgkmcnt(0)
v_mfma_f32_16x16x32_bf16 v[64:67], a[48:51], a[32:35], v[64:67]
s_waitcnt vmcnt(16)
s_barrier
v_mfma_f32_16x16x32_bf16 v[80:83], a[48:51], a[36:39], v[80:83]
s_add_u32 m0, s40, 32768
ds_read_b64_tr_b16 a[16:17], v16 offset:0
buffer_load_dwordx4 v2, s[4:7], 0 offen sc1 lds
v_mfma_f32_16x16x32_bf16 v[96:99], a[48:51], a[40:43], v[96:99]
ds_read_b64_tr_b16 a[18:19], v16 offset:4096
v_mfma_f32_16x16x32_bf16 v[112:115], a[48:51], a[44:47], v[112:115]
ds_read_b128 a[0:3], v15 offset:0
v_mfma_f32_16x16x32_bf16 v[68:71], a[52:55], a[32:35], v[68:71]
ds_read_b128 a[4:7], v15 offset:2048
v_mfma_f32_16x16x32_bf16 v[84:87], a[52:55], a[36:39], v[84:87]
ds_read_b128 a[8:11], v15 offset:4096
buffer_load_dwordx4 v2, s[4:7], s28 offen offset:1024 sc1 lds
v_mfma_f32_16x16x32_bf16 v[100:103], a[52:55], a[40:43], v[100:103]
ds_read_b128 a[12:15], v15 offset:6144
v_mfma_f32_16x16x32_bf16 v[116:119], a[52:55], a[44:47], v[116:119]
ds_read_b64_tr_b16 a[20:21], v17 offset:0
v_mfma_f32_16x16x32_bf16 v[72:75], a[56:59], a[32:35], v[72:75]
ds_read_b64_tr_b16 a[22:23], v17 offset:4096
v_mfma_f32_16x16x32_bf16 v[88:91], a[56:59], a[36:39], v[88:91]
ds_read_b64_tr_b16 a[24:25], v18 offset:0
buffer_load_dwordx4 v2, s[4:7], s29 offen offset:2048 sc1 lds
v_mfma_f32_16x16x32_bf16 v[104:107], a[56:59], a[40:43], v[104:107]
ds_read_b64_tr_b16 a[26:27], v18 offset:4096
v_mfma_f32_16x16x32_bf16 v[120:123], a[56:59], a[44:47], v[120:123]
ds_read_b64_tr_b16 a[28:29], v19 offset:0
v_mfma_f32_16x16x32_bf16 v[76:79], a[60:63], a[32:35], v[76:79]
ds_read_b64_tr_b16 a[30:31], v19 offset:4096
v_mfma_f32_16x16x32_bf16 v[92:95], a[60:63], a[36:39], v[92:95]
buffer_load_dwordx4 v2, s[4:7], s30 offen offset:3072 sc1 lds
v_mfma_f32_16x16x32_bf16 v[108:111], a[60:63], a[40:43], v[108:111]
s_add_u32 s4, s4, 2048
s_addc_u32 s5, s5, 0
v_mfma_f32_16x16x32_bf16 v[124:127], a[60:63], a[44:47], v[124:127]
s_sub_u32 s6, s6, 2048
s_add_u32 s41, s41, 1
s_cmp_lt_u32 s41, 2
s_cbranch_scc1 .Lp3_loop
s_waitcnt lgkmcnt(9)
v_mfma_f32_16x16x32_bf16 v[64:67], a[16:19], a[0:3], v[64:67]
ds_read_b64_tr_b16 a[48:49], v16 offset:8192
s_waitcnt lgkmcnt(9)
v_mfma_f32_16x16x32_bf16 v[80:83], a[16:19], a[4:7], v[80:83]
s_add_u32 m0, s40, 49152
ds_read_b64_tr_b16 a[50:51], v16 offset:12288
buffer_load_dwordx4 v3, s[8:11], 0 offen lds
s_waitcnt lgkmcnt(9)
v_mfma_f32_16x16x32_bf16 v[96:99], a[16:19], a[8:11], v[96:99]
ds_read_b128 a[32:35], v15 offset:1024
s_waitcnt lgkmcnt(9)
v_mfma_f32_16x16x32_bf16 v[112:115], a[16:19], a[12:15], v[112:115]
ds_read_b128 a[36:39], v15 offset:3072
s_waitcnt lgkmcnt(8)
v_mfma_f32_16x16x32_bf16 v[68:71], a[20:23], a[0:3], v[68:71]
ds_read_b128 a[40:43], v15 offset:5120
v_mfma_f32_16x16x32_bf16 v[84:87], a[20:23], a[4:7], v[84:87]
ds_read_b128 a[44:47], v15 offset:7168
buffer_load_dwordx4 v4, s[8:11], s32 offen offset:1024 lds
v_mfma_f32_16x16x32_bf16 v[100:103], a[20:23], a[8:11], v[100:103]
ds_read_b64_tr_b16 a[52:53], v17 offset:8192
v_mfma_f32_16x16x32_bf16 v[116:119], a[20:23], a[12:15], v[116:119]
ds_read_b64_tr_b16 a[54:55], v17 offset:12288
s_waitcnt lgkmcnt(10)
v_mfma_f32_16x16x32_bf16 v[72:75], a[24:27], a[0:3], v[72:75]
ds_read_b64_tr_b16 a[56:57], v18 offset:8192
v_mfma_f32_16x16x32_bf16 v[88:91], a[24:27], a[4:7], v[88:91]
ds_read_b64_tr_b16 a[58:59], v18 offset:12288
buffer_load_dwordx4 v3, s[8:11], s33 offen offset:2048 lds
v_mfma_f32_16x16x32_bf16 v[104:107], a[24:27], a[8:11], v[104:107]
ds_read_b64_tr_b16 a[60:61], v19 offset:8192
v_mfma_f32_16x16x32_bf16 v[120:123], a[24:27], a[12:15], v[120:123]
ds_read_b64_tr_b16 a[62:63], v19 offset:12288
s_waitcnt lgkmcnt(12)
v_mfma_f32_16x16x32_bf16 v[76:79], a[28:31], a[0:3], v[76:79]
v_mfma_f32_16x16x32_bf16 v[92:95], a[28:31], a[4:7], v[92:95]
buffer_load_dwordx4 v4, s[8:11], s34 offen offset:3072 lds
v_mfma_f32_16x16x32_bf16 v[108:111], a[28:31], a[8:11], v[108:111]
s_add_u32 s8, s8, 131072
s_addc_u32 s9, s9, 0
v_mfma_f32_16x16x32_bf16 v[124:127], a[28:31], a[12:15], v[124:127]
s_sub_u32 s10, s10, 131072
s_waitcnt lgkmcnt(0)
v_mfma_f32_16x16x32_bf16 v[64:67], a[48:51], a[32:35], v[64:67]
s_waitcnt vmcnt(16)
s_barrier
v_mfma_f32_16x16x32_bf16 v[80:83], a[48:51], a[36:39], v[80:83]
s_add_u32 m0, s40, 65536
ds_read_b64_tr_b16 a[16:17], v16 offset:32768
buffer_load_dwordx4 v2, s[4:7], 0 offen sc1 lds
v_mfma_f32_16x16x32_bf16 v[96:99], a[48:51], a[40:43], v[96:99]
ds_read_b64_tr_b16 a[18:19], v16 offset:36864
v_mfma_f32_16x16x32_bf16 v[112:115], a[48:51], a[44:47], v[112:115]
ds_read_b128 a[0:3], v15 offset:32768
v_mfma_f32_16x16x32_bf16 v[68:71], a[52:55], a[32:35], v[68:71]
ds_read_b128 a[4:7], v15 offset:34816
v_mfma_f32_16x16x32_bf16 v[84:87], a[52:55], a[36:39], v[84:87]
ds_read_b128 a[8:11], v15 offset:36864
buffer_load_dwordx4 v2, s[4:7], s28 offen offset:1024 sc1 lds
v_mfma_f32_16x16x32_bf16 v[100:103], a[52:55], a[40:43], v[100:103]
ds_read_b128 a[12:15], v15 offset:38912
v_mfma_f32_16x16x32_bf16 v[116:119], a[52:55], a[44:47], v[116:119]
ds_read_b64_tr_b16 a[20:21], v17 offset:32768
v_mfma_f32_16x16x32_bf16 v[72:75], a[56:59], a[32:35], v[72:75]
ds_read_b64_tr_b16 a[22:23], v17 offset:36864
v_mfma_f32_16x16x32_bf16 v[88:91], a[56:59], a[36:39], v[88:91]
ds_read_b64_tr_b16 a[24:25], v18 offset:32768
buffer_load_dwordx4 v2, s[4:7], s29 offen offset:2048 sc1 lds
v_mfma_f32_16x16x32_bf16 v[104:107], a[56:59], a[40:43], v[104:107]
ds_read_b64_tr_b16 a[26:27], v18 offset:36864
v_mfma_f32_16x16x32_bf16 v[120:123], a[56:59], a[44:47], v[120:123]
ds_read_b64_tr_b16 a[28:29], v19 offset:32768
v_mfma_f32_16x16x32_bf16 v[76:79], a[60:63], a[32:35], v[76:79]
ds_read_b64_tr_b16 a[30:31], v19 offset:36864
v_mfma_f32_16x16x32_bf16 v[92:95], a[60:63], a[36:39], v[92:95]
buffer_load_dwordx4 v2, s[4:7], s30 offen offset:3072 sc1 lds
v_mfma_f32_16x16x32_bf16 v[108:111], a[60:63], a[40:43], v[108:111]
s_add_u32 s4, s4, 2048
s_addc_u32 s5, s5, 0
v_mfma_f32_16x16x32_bf16 v[124:127], a[60:63], a[44:47], v[124:127]
s_sub_u32 s6, s6, 2048
s_waitcnt lgkmcnt(9)
v_mfma_f32_16x16x32_bf16 v[64:67], a[16:19], a[0:3], v[64:67]
ds_read_b64_tr_b16 a[48:49], v16 offset:40960
s_waitcnt lgkmcnt(9)
v_mfma_f32_16x16x32_bf16 v[80:83], a[16:19], a[4:7], v[80:83]
s_add_u32 m0, s40, 81920
ds_read_b64_tr_b16 a[50:51], v16 offset:45056
buffer_load_dwordx4 v3, s[8:11], 0 offen lds
s_waitcnt lgkmcnt(9)
v_mfma_f32_16x16x32_bf16 v[96:99], a[16:19], a[8:11], v[96:99]
ds_read_b128 a[32:35], v15 offset:33792
s_waitcnt lgkmcnt(9)
v_mfma_f32_16x16x32_bf16 v[112:115], a[16:19], a[12:15], v[112:115]
ds_read_b128 a[36:39], v15 offset:35840
s_waitcnt lgkmcnt(8)
v_mfma_f32_16x16x32_bf16 v[68:71], a[20:23], a[0:3], v[68:71]
ds_read_b128 a[40:43], v15 offset:37888
v_mfma_f32_16x16x32_bf16 v[84:87], a[20:23], a[4:7], v[84:87]
ds_read_b128 a[44:47], v15 offset:39936
buffer_load_dwordx4 v4, s[8:11], s32 offen offset:1024 lds
v_mfma_f32_16x16x32_bf16 v[100:103], a[20:23], a[8:11], v[100:103]
ds_read_b64_tr_b16 a[52:53], v17 offset:40960
v_mfma_f32_16x16x32_bf16 v[116:119], a[20:23], a[12:15], v[116:119]
ds_read_b64_tr_b16 a[54:55], v17 offset:45056
s_waitcnt lgkmcnt(10)
v_mfma_f32_16x16x32_bf16 v[72:75], a[24:27], a[0:3], v[72:75]
ds_read_b64_tr_b16 a[56:57], v18 offset:40960
v_mfma_f32_16x16x32_bf16 v[88:91], a[24:27], a[4:7], v[88:91]
ds_read_b64_tr_b16 a[58:59], v18 offset:45056
buffer_load_dwordx4 v3, s[8:11], s33 offen offset:2048 lds
v_mfma_f32_16x16x32_bf16 v[104:107], a[24:27], a[8:11], v[104:107]
ds_read_b64_tr_b16 a[60:61], v19 offset:40960
v_mfma_f32_16x16x32_bf16 v[120:123], a[24:27], a[12:15], v[120:123]
ds_read_b64_tr_b16 a[62:63], v19 offset:45056
s_waitcnt lgkmcnt(12)
v_mfma_f32_16x16x32_bf16 v[76:79], a[28:31], a[0:3], v[76:79]
v_mfma_f32_16x16x32_bf16 v[92:95], a[28:31], a[4:7], v[92:95]
buffer_load_dwordx4 v4, s[8:11], s34 offen offset:3072 lds
v_mfma_f32_16x16x32_bf16 v[108:111], a[28:31], a[8:11], v[108:111]
s_add_u32 s8, s8, 131072
s_addc_u32 s9, s9, 0
v_mfma_f32_16x16x32_bf16 v[124:127], a[28:31], a[12:15], v[124:127]
s_sub_u32 s10, s10, 131072
s_waitcnt lgkmcnt(0)
v_mfma_f32_16x16x32_bf16 v[64:67], a[48:51], a[32:35], v[64:67]
s_waitcnt vmcnt(16)
s_barrier
v_mfma_f32_16x16x32_bf16 v[80:83], a[48:51], a[36:39], v[80:83]
s_add_u32 m0, s40, 98304
ds_read_b64_tr_b16 a[16:17], v6 offset:0
buffer_load_dwordx4 v2, s[4:7], 0 offen sc1 lds
v_mfma_f32_16x16x32_bf16 v[96:99], a[48:51], a[40:43], v[96:99]
ds_read_b64_tr_b16 a[18:19], v6 offset:4096
v_mfma_f32_16x16x32_bf16 v[112:115], a[48:51], a[44:47], v[112:115]
ds_read_b128 a[0:3], v5 offset:0
v_mfma_f32_16x16x32_bf16 v[68:71], a[52:55], a[32:35], v[68:71]
ds_read_b128 a[4:7], v5 offset:2048
v_mfma_f32_16x16x32_bf16 v[84:87], a[52:55], a[36:39], v[84:87]
ds_read_b128 a[8:11], v5 offset:4096
buffer_load_dwordx4 v2, s[4:7], s28 offen offset:1024 sc1 lds
v_mfma_f32_16x16x32_bf16 v[100:103], a[52:55], a[40:43], v[100:103]
ds_read_b128 a[12:15], v5 offset:6144
v_mfma_f32_16x16x32_bf16 v[116:119], a[52:55], a[44:47], v[116:119]
ds_read_b64_tr_b16 a[20:21], v7 offset:0
v_mfma_f32_16x16x32_bf16 v[72:75], a[56:59], a[32:35], v[72:75]
ds_read_b64_tr_b16 a[22:23], v7 offset:4096
v_mfma_f32_16x16x32_bf16 v[88:91], a[56:59], a[36:39], v[88:91]
ds_read_b64_tr_b16 a[24:25], v8 offset:0
buffer_load_dwordx4 v2, s[4:7], s29 offen offset:2048 sc1 lds
v_mfma_f32_16x16x32_bf16 v[104:107], a[56:59], a[40:43], v[104:107]
ds_read_b64_tr_b16 a[26:27], v8 offset:4096
v_mfma_f32_16x16x32_bf16 v[120:123], a[56:59], a[44:47], v[120:123]
ds_read_b64_tr_b16 a[28:29], v9 offset:0
v_mfma_f32_16x16x32_bf16 v[76:79], a[60:63], a[32:35], v[76:79]
ds_read_b64_tr_b16 a[30:31], v9 offset:4096
v_mfma_f32_16x16x32_bf16 v[92:95], a[60:63], a[36:39], v[92:95]
buffer_load_dwordx4 v2, s[4:7], s30 offen offset:3072 sc1 lds
v_mfma_f32_16x16x32_bf16 v[108:111], a[60:63], a[40:43], v[108:111]
s_add_u32 s4, s4, 2048
s_addc_u32 s5, s5, 0
v_mfma_f32_16x16x32_bf16 v[124:127], a[60:63], a[44:47], v[124:127]
s_sub_u32 s6, s6, 2048
s_waitcnt lgkmcnt(9)
v_mfma_f32_16x16x32_bf16 v[64:67], a[16:19], a[0:3], v[64:67]
ds_read_b64_tr_b16 a[48:49], v6 offset:8192
s_waitcnt lgkmcnt(9)
v_mfma_f32_16x16x32_bf16 v[80:83], a[16:19], a[4:7], v[80:83]
s_add_u32 m0, s40, 114688
ds_read_b64_tr_b16 a[50:51], v6 offset:12288
buffer_load_dwordx4 v3, s[8:11], 0 offen lds
s_waitcnt lgkmcnt(9)
v_mfma_f32_16x16x32_bf16 v[96:99], a[16:19], a[8:11], v[96:99]
ds_read_b128 a[32:35], v5 offset:1024
s_waitcnt lgkmcnt(9)
v_mfma_f32_16x16x32_bf16 v[112:115], a[16:19], a[12:15], v[112:115]
ds_read_b128 a[36:39], v5 offset:3072
s_waitcnt lgkmcnt(8)
v_mfma_f32_16x16x32_bf16 v[68:71], a[20:23], a[0:3], v[68:71]
ds_read_b128 a[40:43], v5 offset:5120
v_mfma_f32_16x16x32_bf16 v[84:87], a[20:23], a[4:7], v[84:87]
ds_read_b128 a[44:47], v5 offset:7168
buffer_load_dwordx4 v4, s[8:11], s32 offen offset:1024 lds
v_mfma_f32_16x16x32_bf16 v[100:103], a[20:23], a[8:11], v[100:103]
ds_read_b64_tr_b16 a[52:53], v7 offset:8192
v_mfma_f32_16x16x32_bf16 v[116:119], a[20:23], a[12:15], v[116:119]
ds_read_b64_tr_b16 a[54:55], v7 offset:12288
s_waitcnt lgkmcnt(10)
v_mfma_f32_16x16x32_bf16 v[72:75], a[24:27], a[0:3], v[72:75]
ds_read_b64_tr_b16 a[56:57], v8 offset:8192
v_mfma_f32_16x16x32_bf16 v[88:91], a[24:27], a[4:7], v[88:91]
ds_read_b64_tr_b16 a[58:59], v8 offset:12288
buffer_load_dwordx4 v3, s[8:11], s33 offen offset:2048 lds
v_mfma_f32_16x16x32_bf16 v[104:107], a[24:27], a[8:11], v[104:107]
ds_read_b64_tr_b16 a[60:61], v9 offset:8192
v_mfma_f32_16x16x32_bf16 v[120:123], a[24:27], a[12:15], v[120:123]
ds_read_b64_tr_b16 a[62:63], v9 offset:12288
s_waitcnt lgkmcnt(12)
v_mfma_f32_16x16x32_bf16 v[76:79], a[28:31], a[0:3], v[76:79]
v_mfma_f32_16x16x32_bf16 v[92:95], a[28:31], a[4:7], v[92:95]
buffer_load_dwordx4 v4, s[8:11], s34 offen offset:3072 lds
v_mfma_f32_16x16x32_bf16 v[108:111], a[28:31], a[8:11], v[108:111]
s_add_u32 s8, s8, 131072
s_addc_u32 s9, s9, 0
v_mfma_f32_16x16x32_bf16 v[124:127], a[28:31], a[12:15], v[124:127]
s_sub_u32 s10, s10, 131072
s_waitcnt lgkmcnt(0)
v_mfma_f32_16x16x32_bf16 v[64:67], a[48:51], a[32:35], v[64:67]
s_waitcnt vmcnt(16)
s_barrier
v_mfma_f32_16x16x32_bf16 v[80:83], a[48:51], a[36:39], v[80:83]
ds_read_b64_tr_b16 a[16:17], v6 offset:32768
v_mfma_f32_16x16x32_bf16 v[96:99], a[48:51], a[40:43], v[96:99]
ds_read_b64_tr_b16 a[18:19], v6 offset:36864
v_mfma_f32_16x16x32_bf16 v[112:115], a[48:51], a[44:47], v[112:115]
ds_read_b128 a[0:3], v5 offset:32768
v_mfma_f32_16x16x32_bf16 v[68:71], a[52:55], a[32:35], v[68:71]
ds_read_b128 a[4:7], v5 offset:34816
v_mfma_f32_16x16x32_bf16 v[84:87], a[52:55], a[36:39], v[84:87]
ds_read_b128 a[8:11], v5 offset:36864
v_mfma_f32_16x16x32_bf16 v[100:103], a[52:55], a[40:43], v[100:103]
ds_read_b128 a[12:15], v5 offset:38912
v_mfma_f32_16x16x32_bf16 v[116:119], a[52:55], a[44:47], v[116:119]
ds_read_b64_tr_b16 a[20:21], v7 offset:32768
v_mfma_f32_16x16x32_bf16 v[72:75], a[56:59], a[32:35], v[72:75]
ds_read_b64_tr_b16 a[22:23], v7 offset:36864
v_mfma_f32_16x16x32_bf16 v[88:91], a[56:59], a[36:39], v[88:91]
ds_read_b64_tr_b16 a[24:25], v8 offset:32768
v_mfma_f32_16x16x32_bf16 v[104:107], a[56:59], a[40:43], v[104:107]
ds_read_b64_tr_b16 a[26:27], v8 offset:36864
v_mfma_f32_16x16x32_bf16 v[120:123], a[56:59], a[44:47], v[120:123]
ds_read_b64_tr_b16 a[28:29], v9 offset:32768
v_mfma_f32_16x16x32_bf16 v[76:79], a[60:63], a[32:35], v[76:79]
ds_read_b64_tr_b16 a[30:31], v9 offset:36864
v_mfma_f32_16x16x32_bf16 v[92:95], a[60:63], a[36:39], v[92:95]
v_mfma_f32_16x16x32_bf16 v[108:111], a[60:63], a[40:43], v[108:111]
v_mfma_f32_16x16x32_bf16 v[124:127], a[60:63], a[44:47], v[124:127]
s_waitcnt lgkmcnt(9)
v_mfma_f32_16x16x32_bf16 v[64:67], a[16:19], a[0:3], v[64:67]
ds_read_b64_tr_b16 a[48:49], v6 offset:40960
s_waitcnt lgkmcnt(9)
v_mfma_f32_16x16x32_bf16 v[80:83], a[16:19], a[4:7], v[80:83]
ds_read_b64_tr_b16 a[50:51], v6 offset:45056
s_waitcnt lgkmcnt(9)
v_mfma_f32_16x16x32_bf16 v[96:99], a[16:19], a[8:11], v[96:99]
ds_read_b128 a[32:35], v5 offset:33792
s_waitcnt lgkmcnt(9)
v_mfma_f32_16x16x32_bf16 v[112:115], a[16:19], a[12:15], v[112:115]
ds_read_b128 a[36:39], v5 offset:35840
s_waitcnt lgkmcnt(8)
v_mfma_f32_16x16x32_bf16 v[68:71], a[20:23], a[0:3], v[68:71]
ds_read_b128 a[40:43], v5 offset:37888
v_mfma_f32_16x16x32_bf16 v[84:87], a[20:23], a[4:7], v[84:87]
ds_read_b128 a[44:47], v5 offset:39936
v_mfma_f32_16x16x32_bf16 v[100:103], a[20:23], a[8:11], v[100:103]
ds_read_b64_tr_b16 a[52:53], v7 offset:40960
v_mfma_f32_16x16x32_bf16 v[116:119], a[20:23], a[12:15], v[116:119]
ds_read_b64_tr_b16 a[54:55], v7 offset:45056
s_waitcnt lgkmcnt(10)
v_mfma_f32_16x16x32_bf16 v[72:75], a[24:27], a[0:3], v[72:75]
ds_read_b64_tr_b16 a[56:57], v8 offset:40960
v_mfma_f32_16x16x32_bf16 v[88:91], a[24:27], a[4:7], v[88:91]
ds_read_b64_tr_b16 a[58:59], v8 offset:45056
v_mfma_f32_16x16x32_bf16 v[104:107], a[24:27], a[8:11], v[104:107]
ds_read_b64_tr_b16 a[60:61], v9 offset:40960
v_mfma_f32_16x16x32_bf16 v[120:123], a[24:27], a[12:15], v[120:123]
ds_read_b64_tr_b16 a[62:63], v9 offset:45056
s_waitcnt lgkmcnt(12)
v_mfma_f32_16x16x32_bf16 v[76:79], a[28:31], a[0:3], v[76:79]
v_mfma_f32_16x16x32_bf16 v[92:95], a[28:31], a[4:7], v[92:95]
v_mfma_f32_16x16x32_bf16 v[108:111], a[28:31], a[8:11], v[108:111]
v_mfma_f32_16x16x32_bf16 v[124:127], a[28:31], a[12:15], v[124:127]
s_waitcnt lgkmcnt(0)
v_mfma_f32_16x16x32_bf16 v[64:67], a[48:51], a[32:35], v[64:67]
s_waitcnt vmcnt(8)
s_barrier
v_mfma_f32_16x16x32_bf16 v[80:83], a[48:51], a[36:39], v[80:83]
ds_read_b64_tr_b16 a[16:17], v16 offset:0
v_mfma_f32_16x16x32_bf16 v[96:99], a[48:51], a[40:43], v[96:99]
ds_read_b64_tr_b16 a[18:19], v16 offset:4096
v_mfma_f32_16x16x32_bf16 v[112:115], a[48:51], a[44:47], v[112:115]
ds_read_b128 a[0:3], v15 offset:0
v_mfma_f32_16x16x32_bf16 v[68:71], a[52:55], a[32:35], v[68:71]
ds_read_b128 a[4:7], v15 offset:2048
v_mfma_f32_16x16x32_bf16 v[84:87], a[52:55], a[36:39], v[84:87]
ds_read_b128 a[8:11], v15 offset:4096
v_mfma_f32_16x16x32_bf16 v[100:103], a[52:55], a[40:43], v[100:103]
ds_read_b128 a[12:15], v15 offset:6144
v_mfma_f32_16x16x32_bf16 v[116:119], a[52:55], a[44:47], v[116:119]
ds_read_b64_tr_b16 a[20:21], v17 offset:0
v_mfma_f32_16x16x32_bf16 v[72:75], a[56:59], a[32:35], v[72:75]
ds_read_b64_tr_b16 a[22:23], v17 offset:4096
v_mfma_f32_16x16x32_bf16 v[88:91], a[56:59], a[36:39], v[88:91]
ds_read_b64_tr_b16 a[24:25], v18 offset:0
v_mfma_f32_16x16x32_bf16 v[104:107], a[56:59], a[40:43], v[104:107]
ds_read_b64_tr_b16 a[26:27], v18 offset:4096
v_mfma_f32_16x16x32_bf16 v[120:123], a[56:59], a[44:47], v[120:123]
ds_read_b64_tr_b16 a[28:29], v19 offset:0
v_mfma_f32_16x16x32_bf16 v[76:79], a[60:63], a[32:35], v[76:79]
ds_read_b64_tr_b16 a[30:31], v19 offset:4096
v_mfma_f32_16x16x32_bf16 v[92:95], a[60:63], a[36:39], v[92:95]
v_mfma_f32_16x16x32_bf16 v[108:111], a[60:63], a[40:43], v[108:111]
v_mfma_f32_16x16x32_bf16 v[124:127], a[60:63], a[44:47], v[124:127]
s_waitcnt lgkmcnt(9)
v_mfma_f32_16x16x32_bf16 v[64:67], a[16:19], a[0:3], v[64:67]
ds_read_b64_tr_b16 a[48:49], v16 offset:8192
s_waitcnt lgkmcnt(9)
v_mfma_f32_16x16x32_bf16 v[80:83], a[16:19], a[4:7], v[80:83]
ds_read_b64_tr_b16 a[50:51], v16 offset:12288
s_waitcnt lgkmcnt(9)
v_mfma_f32_16x16x32_bf16 v[96:99], a[16:19], a[8:11], v[96:99]
ds_read_b128 a[32:35], v15 offset:1024
s_waitcnt lgkmcnt(9)
v_mfma_f32_16x16x32_bf16 v[112:115], a[16:19], a[12:15], v[112:115]
ds_read_b128 a[36:39], v15 offset:3072
s_waitcnt lgkmcnt(8)
v_mfma_f32_16x16x32_bf16 v[68:71], a[20:23], a[0:3], v[68:71]
ds_read_b128 a[40:43], v15 offset:5120
v_mfma_f32_16x16x32_bf16 v[84:87], a[20:23], a[4:7], v[84:87]
ds_read_b128 a[44:47], v15 offset:7168
v_mfma_f32_16x16x32_bf16 v[100:103], a[20:23], a[8:11], v[100:103]
ds_read_b64_tr_b16 a[52:53], v17 offset:8192
v_mfma_f32_16x16x32_bf16 v[116:119], a[20:23], a[12:15], v[116:119]
ds_read_b64_tr_b16 a[54:55], v17 offset:12288
s_waitcnt lgkmcnt(10)
v_mfma_f32_16x16x32_bf16 v[72:75], a[24:27], a[0:3], v[72:75]
ds_read_b64_tr_b16 a[56:57], v18 offset:8192
v_mfma_f32_16x16x32_bf16 v[88:91], a[24:27], a[4:7], v[88:91]
ds_read_b64_tr_b16 a[58:59], v18 offset:12288
v_mfma_f32_16x16x32_bf16 v[104:107], a[24:27], a[8:11], v[104:107]
ds_read_b64_tr_b16 a[60:61], v19 offset:8192
v_mfma_f32_16x16x32_bf16 v[120:123], a[24:27], a[12:15], v[120:123]
ds_read_b64_tr_b16 a[62:63], v19 offset:12288
s_waitcnt lgkmcnt(12)
v_mfma_f32_16x16x32_bf16 v[76:79], a[28:31], a[0:3], v[76:79]
v_mfma_f32_16x16x32_bf16 v[92:95], a[28:31], a[4:7], v[92:95]
v_mfma_f32_16x16x32_bf16 v[108:111], a[28:31], a[8:11], v[108:111]
v_mfma_f32_16x16x32_bf16 v[124:127], a[28:31], a[12:15], v[124:127]
s_waitcnt lgkmcnt(0)
v_mfma_f32_16x16x32_bf16 v[64:67], a[48:51], a[32:35], v[64:67]
s_waitcnt vmcnt(0)
s_barrier
v_mfma_f32_16x16x32_bf16 v[80:83], a[48:51], a[36:39], v[80:83]
ds_read_b64_tr_b16 a[16:17], v16 offset:32768
v_mfma_f32_16x16x32_bf16 v[96:99], a[48:51], a[40:43], v[96:99]
ds_read_b64_tr_b16 a[18:19], v16 offset:36864
v_mfma_f32_16x16x32_bf16 v[112:115], a[48:51], a[44:47], v[112:115]
ds_read_b128 a[0:3], v15 offset:32768
v_mfma_f32_16x16x32_bf16 v[68:71], a[52:55], a[32:35], v[68:71]
ds_read_b128 a[4:7], v15 offset:34816
v_mfma_f32_16x16x32_bf16 v[84:87], a[52:55], a[36:39], v[84:87]
ds_read_b128 a[8:11], v15 offset:36864
v_mfma_f32_16x16x32_bf16 v[100:103], a[52:55], a[40:43], v[100:103]
ds_read_b128 a[12:15], v15 offset:38912
v_mfma_f32_16x16x32_bf16 v[116:119], a[52:55], a[44:47], v[116:119]
ds_read_b64_tr_b16 a[20:21], v17 offset:32768
v_mfma_f32_16x16x32_bf16 v[72:75], a[56:59], a[32:35], v[72:75]
ds_read_b64_tr_b16 a[22:23], v17 offset:36864
v_mfma_f32_16x16x32_bf16 v[88:91], a[56:59], a[36:39], v[88:91]
ds_read_b64_tr_b16 a[24:25], v18 offset:32768
v_mfma_f32_16x16x32_bf16 v[104:107], a[56:59], a[40:43], v[104:107]
ds_read_b64_tr_b16 a[26:27], v18 offset:36864
v_mfma_f32_16x16x32_bf16 v[120:123], a[56:59], a[44:47], v[120:123]
ds_read_b64_tr_b16 a[28:29], v19 offset:32768
v_mfma_f32_16x16x32_bf16 v[76:79], a[60:63], a[32:35], v[76:79]
ds_read_b64_tr_b16 a[30:31], v19 offset:36864
v_mfma_f32_16x16x32_bf16 v[92:95], a[60:63], a[36:39], v[92:95]
v_mfma_f32_16x16x32_bf16 v[108:111], a[60:63], a[40:43], v[108:111]
v_mfma_f32_16x16x32_bf16 v[124:127], a[60:63], a[44:47], v[124:127]
s_waitcnt lgkmcnt(9)
v_mfma_f32_16x16x32_bf16 v[64:67], a[16:19], a[0:3], v[64:67]
ds_read_b64_tr_b16 a[48:49], v16 offset:40960
s_waitcnt lgkmcnt(9)
v_mfma_f32_16x16x32_bf16 v[80:83], a[16:19], a[4:7], v[80:83]
ds_read_b64_tr_b16 a[50:51], v16 offset:45056
s_waitcnt lgkmcnt(9)
v_mfma_f32_16x16x32_bf16 v[96:99], a[16:19], a[8:11], v[96:99]
ds_read_b128 a[32:35], v15 offset:33792
s_waitcnt lgkmcnt(9)
v_mfma_f32_16x16x32_bf16 v[112:115], a[16:19], a[12:15], v[112:115]
ds_read_b128 a[36:39], v15 offset:35840
s_waitcnt lgkmcnt(8)
v_mfma_f32_16x16x32_bf16 v[68:71], a[20:23], a[0:3], v[68:71]
ds_read_b128 a[40:43], v15 offset:37888
v_mfma_f32_16x16x32_bf16 v[84:87], a[20:23], a[4:7], v[84:87]
ds_read_b128 a[44:47], v15 offset:39936
v_mfma_f32_16x16x32_bf16 v[100:103], a[20:23], a[8:11], v[100:103]
ds_read_b64_tr_b16 a[52:53], v17 offset:40960
v_mfma_f32_16x16x32_bf16 v[116:119], a[20:23], a[12:15], v[116:119]
ds_read_b64_tr_b16 a[54:55], v17 offset:45056
s_waitcnt lgkmcnt(10)
v_mfma_f32_16x16x32_bf16 v[72:75], a[24:27], a[0:3], v[72:75]
ds_read_b64_tr_b16 a[56:57], v18 offset:40960
v_mfma_f32_16x16x32_bf16 v[88:91], a[24:27], a[4:7], v[88:91]
ds_read_b64_tr_b16 a[58:59], v18 offset:45056
v_mfma_f32_16x16x32_bf16 v[104:107], a[24:27], a[8:11], v[104:107]
ds_read_b64_tr_b16 a[60:61], v19 offset:40960
v_mfma_f32_16x16x32_bf16 v[120:123], a[24:27], a[12:15], v[120:123]
ds_read_b64_tr_b16 a[62:63], v19 offset:45056
s_waitcnt lgkmcnt(12)
v_mfma_f32_16x16x32_bf16 v[76:79], a[28:31], a[0:3], v[76:79]
v_mfma_f32_16x16x32_bf16 v[92:95], a[28:31], a[4:7], v[92:95]
v_mfma_f32_16x16x32_bf16 v[108:111], a[28:31], a[8:11], v[108:111]
v_mfma_f32_16x16x32_bf16 v[124:127], a[28:31], a[12:15], v[124:127]
s_waitcnt lgkmcnt(9)
v_mfma_f32_16x16x32_bf16 v[64:67], a[48:51], a[32:35], v[64:67]
s_waitcnt lgkmcnt(8)
v_mfma_f32_16x16x32_bf16 v[80:83], a[48:51], a[36:39], v[80:83]
s_waitcnt lgkmcnt(7)
v_mfma_f32_16x16x32_bf16 v[96:99], a[48:51], a[40:43], v[96:99]
s_waitcnt lgkmcnt(6)
v_mfma_f32_16x16x32_bf16 v[112:115], a[48:51], a[44:47], v[112:115]
s_waitcnt lgkmcnt(4)
v_mfma_f32_16x16x32_bf16 v[68:71], a[52:55], a[32:35], v[68:71]
v_mfma_f32_16x16x32_bf16 v[84:87], a[52:55], a[36:39], v[84:87]
v_mfma_f32_16x16x32_bf16 v[100:103], a[52:55], a[40:43], v[100:103]
v_mfma_f32_16x16x32_bf16 v[116:119], a[52:55], a[44:47], v[116:119]
s_waitcnt lgkmcnt(2)
v_mfma_f32_16x16x32_bf16 v[72:75], a[56:59], a[32:35], v[72:75]
v_mfma_f32_16x16x32_bf16 v[88:91], a[56:59], a[36:39], v[88:91]
v_mfma_f32_16x16x32_bf16 v[104:107], a[56:59], a[40:43], v[104:107]
v_mfma_f32_16x16x32_bf16 v[120:123], a[56:59], a[44:47], v[120:123]
s_waitcnt lgkmcnt(0)
v_mfma_f32_16x16x32_bf16 v[76:79], a[60:63], a[32:35], v[76:79]
v_mfma_f32_16x16x32_bf16 v[92:95], a[60:63], a[36:39], v[92:95]
v_mfma_f32_16x16x32_bf16 v[108:111], a[60:63], a[40:43], v[108:111]
v_mfma_f32_16x16x32_bf16 v[124:127], a[60:63], a[44:47], v[124:127]
s_nop 7
s_nop 7
v_and_b32 v20, 15, v0
s_lshl_b32 s16, s36, 7
s_lshr_b32 s17, s46, 1
s_lshl_b32 s17, s17, 6
s_add_u32 s16, s16, s17
v_add_u32 v20, s16, v20
v_lshlrev_b32 v20, 12, v20
v_lshrrev_b32 v21, 4, v0
v_and_b32 v22, 1, v21
v_lshlrev_b32 v22, 5, v22
v_lshrrev_b32 v21, 1, v21
v_lshlrev_b32 v21, 4, v21
v_add_u32 v20, v20, v22
v_add_u32 v20, v20, v21
s_lshl_b32 s16, s43, 11
s_lshl_b32 s17, s37, 8
s_add_u32 s16, s16, s17
s_and_b32 s17, s46, 1
s_lshl_b32 s17, s17, 7
s_add_u32 s16, s16, s17
v_add_u32 v20, s16, v20

v_and_b32 v21, 8, v0
v_lshlrev_b32 v22, 12, v21
v_sub_u32 v20, v20, v22
v_lshlrev_b32 v21, 3, v21
v_add_u32 v20, v20, v21
v_add_u32 v21, 0x8000, v20
s_mov_b32 s18, 0x00ff00ff
s_mov_b32 s19, 0x00ff00ff
s_mov_b32 s20, 0xff00ff00
s_mov_b32 s21, 0xff00ff00

v_cvt_pk_bf16_f32 v24, v64, v65
v_cvt_pk_bf16_f32 v25, v66, v67
v_cvt_pk_bf16_f32 v26, v68, v69
v_cvt_pk_bf16_f32 v27, v70, v71
v_cvt_pk_bf16_f32 v28, v72, v73
v_cvt_pk_bf16_f32 v29, v74, v75
v_cvt_pk_bf16_f32 v30, v76, v77
v_cvt_pk_bf16_f32 v31, v78, v79
s_mov_b32 s17, 0
s_mov_b64 vcc, s[18:19]
v_permlane16_swap_b32 v24, v26
v_permlane16_swap_b32 v25, v27
v_permlane16_swap_b32 v28, v30
v_permlane16_swap_b32 v29, v31
s_nop 1
v_cndmask_b32_dpp v32, v28, v24, vcc row_ror:8 row_mask:0xf bank_mask:0xf
v_cndmask_b32_dpp v33, v29, v25, vcc row_ror:8 row_mask:0xf bank_mask:0xf
v_cndmask_b32_dpp v34, v30, v26, vcc row_ror:8 row_mask:0xf bank_mask:0xf
v_cndmask_b32_dpp v35, v31, v27, vcc row_ror:8 row_mask:0xf bank_mask:0xf
s_mov_b64 vcc, s[20:21]
buffer_store_dwordx4 v[32:35], v20, s[24:27], s17 offen sc1
v_cndmask_b32_dpp v36, v24, v28, vcc row_ror:8 row_mask:0xf bank_mask:0xf
v_cndmask_b32_dpp v37, v25, v29, vcc row_ror:8 row_mask:0xf bank_mask:0xf
v_cndmask_b32_dpp v38, v26, v30, vcc row_ror:8 row_mask:0xf bank_mask:0xf
v_cndmask_b32_dpp v39, v27, v31, vcc row_ror:8 row_mask:0xf bank_mask:0xf
buffer_store_dwordx4 v[36:39], v21, s[24:27], s17 offen sc1
v_cvt_pk_bf16_f32 v40, v80, v81
v_cvt_pk_bf16_f32 v41, v82, v83
v_cvt_pk_bf16_f32 v42, v84, v85
v_cvt_pk_bf16_f32 v43, v86, v87
v_cvt_pk_bf16_f32 v44, v88, v89
v_cvt_pk_bf16_f32 v45, v90, v91
v_cvt_pk_bf16_f32 v46, v92, v93
v_cvt_pk_bf16_f32 v47, v94, v95
s_mov_b32 s17, 65536
s_mov_b64 vcc, s[18:19]
v_permlane16_swap_b32 v40, v42
v_permlane16_swap_b32 v41, v43
v_permlane16_swap_b32 v44, v46
v_permlane16_swap_b32 v45, v47
s_nop 1
v_cndmask_b32_dpp v48, v44, v40, vcc row_ror:8 row_mask:0xf bank_mask:0xf
v_cndmask_b32_dpp v49, v45, v41, vcc row_ror:8 row_mask:0xf bank_mask:0xf
v_cndmask_b32_dpp v50, v46, v42, vcc row_ror:8 row_mask:0xf bank_mask:0xf
v_cndmask_b32_dpp v51, v47, v43, vcc row_ror:8 row_mask:0xf bank_mask:0xf
s_mov_b64 vcc, s[20:21]
buffer_store_dwordx4 v[48:51], v20, s[24:27], s17 offen sc1
v_cndmask_b32_dpp v52, v40, v44, vcc row_ror:8 row_mask:0xf bank_mask:0xf
v_cndmask_b32_dpp v53, v41, v45, vcc row_ror:8 row_mask:0xf bank_mask:0xf
v_cndmask_b32_dpp v54, v42, v46, vcc row_ror:8 row_mask:0xf bank_mask:0xf
v_cndmask_b32_dpp v55, v43, v47, vcc row_ror:8 row_mask:0xf bank_mask:0xf
buffer_store_dwordx4 v[52:55], v21, s[24:27], s17 offen sc1
v_cvt_pk_bf16_f32 v24, v96, v97
v_cvt_pk_bf16_f32 v25, v98, v99
v_cvt_pk_bf16_f32 v26, v100, v101
v_cvt_pk_bf16_f32 v27, v102, v103
v_cvt_pk_bf16_f32 v28, v104, v105
v_cvt_pk_bf16_f32 v29, v106, v107
v_cvt_pk_bf16_f32 v30, v108, v109
v_cvt_pk_bf16_f32 v31, v110, v111
s_mov_b32 s17, 131072
s_mov_b64 vcc, s[18:19]
v_permlane16_swap_b32 v24, v26
v_permlane16_swap_b32 v25, v27
v_permlane16_swap_b32 v28, v30
v_permlane16_swap_b32 v29, v31
s_nop 1
v_cndmask_b32_dpp v32, v28, v24, vcc row_ror:8 row_mask:0xf bank_mask:0xf
v_cndmask_b32_dpp v33, v29, v25, vcc row_ror:8 row_mask:0xf bank_mask:0xf
v_cndmask_b32_dpp v34, v30, v26, vcc row_ror:8 row_mask:0xf bank_mask:0xf
v_cndmask_b32_dpp v35, v31, v27, vcc row_ror:8 row_mask:0xf bank_mask:0xf
s_mov_b64 vcc, s[20:21]
buffer_store_dwordx4 v[32:35], v20, s[24:27], s17 offen sc1
v_cndmask_b32_dpp v36, v24, v28, vcc row_ror:8 row_mask:0xf bank_mask:0xf
v_cndmask_b32_dpp v37, v25, v29, vcc row_ror:8 row_mask:0xf bank_mask:0xf
v_cndmask_b32_dpp v38, v26, v30, vcc row_ror:8 row_mask:0xf bank_mask:0xf
v_cndmask_b32_dpp v39, v27, v31, vcc row_ror:8 row_mask:0xf bank_mask:0xf
buffer_store_dwordx4 v[36:39], v21, s[24:27], s17 offen sc1
v_cvt_pk_bf16_f32 v40, v112, v113
v_cvt_pk_bf16_f32 v41, v114, v115
v_cvt_pk_bf16_f32 v42, v116, v117
v_cvt_pk_bf16_f32 v43, v118, v119
v_cvt_pk_bf16_f32 v44, v120, v121
v_cvt_pk_bf16_f32 v45, v122, v123
v_cvt_pk_bf16_f32 v46, v124, v125
v_cvt_pk_bf16_f32 v47, v126, v127
s_mov_b32 s17, 196608
s_mov_b64 vcc, s[18:19]
v_permlane16_swap_b32 v40, v42
v_permlane16_swap_b32 v41, v43
v_permlane16_swap_b32 v44, v46
v_permlane16_swap_b32 v45, v47
s_nop 1
v_cndmask_b32_dpp v48, v44, v40, vcc row_ror:8 row_mask:0xf bank_mask:0xf
v_cndmask_b32_dpp v49, v45, v41, vcc row_ror:8 row_mask:0xf bank_mask:0xf
v_cndmask_b32_dpp v50, v46, v42, vcc row_ror:8 row_mask:0xf bank_mask:0xf
v_cndmask_b32_dpp v51, v47, v43, vcc row_ror:8 row_mask:0xf bank_mask:0xf
s_mov_b64 vcc, s[20:21]
buffer_store_dwordx4 v[48:51], v20, s[24:27], s17 offen sc1
v_cndmask_b32_dpp v52, v40, v44, vcc row_ror:8 row_mask:0xf bank_mask:0xf
v_cndmask_b32_dpp v53, v41, v45, vcc row_ror:8 row_mask:0xf bank_mask:0xf
v_cndmask_b32_dpp v54, v42, v46, vcc row_ror:8 row_mask:0xf bank_mask:0xf
v_cndmask_b32_dpp v55, v43, v47, vcc row_ror:8 row_mask:0xf bank_mask:0xf
buffer_store_dwordx4 v[52:55], v21, s[24:27], s17 offen sc1
.Lconcat_heads__linear_attn_block__sliding_block__prompt_kernel_fin:
.Lconcat_heads__linear_attn_block__sliding_block__prompt_kernel_done:
s_endpgm
.Lk1_text_end:
.Lall_text_end:

.section .rodata,"a"
.p2align 6
.amdhsa_kernel concat_heads__linear_attn_block__sliding_block__prompt_kernel
  .amdhsa_next_free_vgpr 512
  .amdhsa_next_free_sgpr 102
  .amdhsa_accum_offset 256
  .amdhsa_group_segment_fixed_size 0
  .amdhsa_kernarg_size 72
  .amdhsa_user_sgpr_count 2
  .amdhsa_user_sgpr_kernarg_segment_ptr 1
  .amdhsa_system_sgpr_workgroup_id_x 1
  .amdhsa_float_denorm_mode_32 3
  .amdhsa_float_denorm_mode_16_64 3
.end_amdhsa_kernel
```
